```python
import torch

def _softmax(x, axis=-1):
    return torch.softmax(x, dim=axis)
def _gelu(x):
    return torch.nn.functional.gelu(x, approximate="tanh")
def _silu(x):
    return torch.nn.functional.silu(x)
def _sigmoid(x):
    return torch.sigmoid(x)
def _layernorm(x, axis=-1, eps=1e-5):
    m = x.mean(dim=axis, keepdim=True)
    v = x.var(dim=axis, keepdim=True, unbiased=False)
    return (x - m) / torch.sqrt(v + eps)
def _scatter_add(tgt, idx, src, axis=0):
    return tgt.clone().index_add_(axis, idx, src)
def _segment_sum(src, seg, n):
    out = torch.zeros((n,) + src.shape[1:], dtype=src.dtype)
    return out.index_add_(0, seg, src)
def _pad(x, pw):
    flat = tuple(v for pair in reversed(pw) for v in pair)
    return torch.nn.functional.pad(x, flat)

kernel_name = 'gated_mix__softmax_full_mha__sliding_local_dilated__prompt'

def setup_inputs():

    _w = (lambda a: (lambda t: t.to(torch.bfloat16) if t.is_floating_point() else t)(torch.as_tensor(a)))
    def _A_setup():
        B, S, D = 1, 2048, 640
        return {
            "x": _w((lambda *s: torch.randn(*s, dtype=torch.bfloat16) * 0.05)(B, S, D)),
            "wqkv": _w((lambda *s: torch.randn(*s, dtype=torch.bfloat16) * 1.6)(D, 3 * D)),
            "wo": _w((lambda *s: torch.randn(*s, dtype=torch.bfloat16) * 0.1)(D, D)),
        }
    _A_in = _A_setup()

    def _B_setup():
        B, S, D = 1, 2048, 640
        return {
            "x": _w((lambda *s: torch.randn(*s, dtype=torch.bfloat16) * 0.05)(B, S, D)),
            "wqkv": _w((lambda *s: torch.randn(*s, dtype=torch.bfloat16) * 1.6)(D, 3 * D)),
            "wo": _w((lambda *s: torch.randn(*s, dtype=torch.bfloat16) * 0.05)(D, D)),
        }
    _B_in = _B_setup()

    return {
        "A_x": _A_in["x"],
        "A_wqkv": _A_in["wqkv"],
        "A_wo": _A_in["wo"],
        "B_x": _B_in["x"],
        "B_wqkv": _B_in["wqkv"],
        "B_wo": _B_in["wo"],
        "gate_w": _w((lambda *s: torch.randn(*s, dtype=torch.bfloat16) * 0.05)(640) * 16.0),
    }

def reference(A_x, A_wqkv, A_wo, B_x, B_wqkv, B_wo, gate_w):
    def _A_ref(x, wqkv, wo):
        B, S, D = x.shape
        H = 32; Dh = D // H
        qkv = (lambda x, *d: x.permute(*d))((x @ wqkv).reshape(B, S, 3, H, Dh), 2, 0, 3, 1, 4)
        q, k, v = qkv[0], qkv[1], qkv[2]
        scale = Dh ** -0.5
        scores = torch.einsum("bhqd,bhkd->bhqk", q, k) * scale
        p = _softmax(scores, axis=-1)
        o = torch.einsum("bhqk,bhkd->bhqd", p, v)
        return (lambda x, *d: x.permute(*d))(o, 0, 2, 1, 3).reshape(B, S, D) @ wo

    def _B_ref(x, wqkv, wo):
        B, S, D = x.shape
        H = 32; Dh = D // H
        W, dil = 8, 2
        qkv = (lambda x, *d: x.permute(*d))((x @ wqkv).reshape(B, S, 3, H, Dh), 2, 0, 3, 1, 4)
        q, k, v = qkv[0], qkv[1], qkv[2]
        scale = Dh ** -0.5
        pos = torch.arange(S)
        off = torch.arange(W) * dil
        idx = pos[:, None] - off[None, :]
        mask = idx >= 0
        idx_c = torch.where(mask, idx, 0).reshape(-1)
        kg = k[:, :, idx_c, :].reshape(B, H, S, W, Dh)
        vg = v[:, :, idx_c, :].reshape(B, H, S, W, Dh)
        logits = torch.einsum("bhsd,bhswd->bhsw", q, kg) * scale
        logits = torch.where(mask[None, None, :, :], logits, -1e9)
        attn = _softmax(logits, axis=-1)
        o = torch.einsum("bhsw,bhswd->bhsd", attn, vg)
        return (lambda x, *d: x.permute(*d))(o, 0, 2, 1, 3).reshape(B, S, D) @ wo

    x = A_x
    g = _sigmoid((x * gate_w).sum(-1, keepdims=True))
    a = _A_ref(x, A_wqkv, A_wo)
    b = _B_ref(x, B_wqkv, B_wo)
    return g * a + (1 - g) * b
```

```asm
; @launch grid=(256,1,1) block=(512,1,1) lds=163840
.amdgcn_target "amdgcn-amd-amdhsa--gfx950"
.text
.globl gated_mix__softmax_full_mha__sliding_local_dilated__prompt_kernel
.p2align 8
.type gated_mix__softmax_full_mha__sliding_local_dilated__prompt_kernel,@function
gated_mix__softmax_full_mha__sliding_local_dilated__prompt_kernel:
    s_cmp_ge_u32 s2, 256
    s_cbranch_scc1 L_end
    s_load_dwordx4 s[4:7], s[0:1], 0
    s_load_dwordx2 s[92:93], s[0:1], 32
    s_load_dwordx2 s[94:95], s[0:1], 72
    s_load_dwordx4 s[44:47], s[0:1], 56
    v_lshrrev_b32 v20, 6, v0
    v_and_b32 v1, 63, v0
    v_readfirstlane_b32 s16, v20
    v_and_b32 v2, 31, v1
    v_lshrrev_b32 v3, 5, v1
    v_lshlrev_b32 v16, 4, v1
    s_and_b32 s32, s2, 7
    s_lshr_b32 s33, s2, 3
    s_and_b32 s72, s32, 1
    s_lshl_b32 s72, s72, 3
    s_and_b32 s34, s33, 7
    s_add_u32 s72, s72, s34
    s_lshr_b32 s73, s32, 1
    s_lshl_b32 s73, s73, 2
    s_lshr_b32 s34, s33, 3
    s_add_u32 s73, s73, s34
    s_and_b32 s83, s16, 3
    s_and_b32 s74, s83, 1
    s_lshr_b32 s75, s83, 1
    s_mul_i32 s76, s72, 163840
    s_lshl_b32 s77, s73, 8
    s_lshl_b32 s78, s83, 10
    s_mul_hi_u32 s32, s73, 0x33333334
    s_mul_i32 s32, s32, 5
    s_sub_u32 s79, s73, s32
    v_lshrrev_b32 v20, 3, v1
    s_lshl_b32 s32, s83, 3
    v_add_u32 v20, s32, v20
    v_lshrrev_b32 v21, 1, v20
    v_xor_b32 v21, v21, v1
    v_and_b32 v21, 7, v21
    v_lshlrev_b32 v21, 4, v21
    v_mul_u32_u24 v22, 1280, v20
    v_add_u32 v242, v22, v21
    v_lshrrev_b32 v20, 4, v1
    v_lshlrev_b32 v21, 2, v20
    v_xor_b32 v21, v21, v1
    v_and_b32 v21, 15, v21
    v_lshlrev_b32 v21, 4, v21
    s_lshl_b32 s32, s83, 2
    v_add_u32 v20, s32, v20
    v_mul_u32_u24 v20, 3840, v20
    v_add_u32 v243, v20, v21
    s_waitcnt lgkmcnt(0)
    s_mov_b32 s60, s4
    s_and_b32 s61, s5, 0xffff
    s_mov_b32 s62, 2621440
    s_mov_b32 s63, 0x20000
    s_mov_b32 s64, s6
    s_and_b32 s65, s7, 0xffff
    s_mov_b32 s66, 2457600
    s_mov_b32 s67, 0x20000
    s_mov_b32 s68, s92
    s_and_b32 s69, s93, 0xffff
    s_mov_b32 s70, 2457600
    s_mov_b32 s71, 0x20000
    s_mov_b32 s8, s94
    s_and_b32 s9, s95, 0xffff
    s_mov_b32 s10, 24209408
    s_mov_b32 s11, 0x20000
    s_mov_b32 s12, s44
    s_and_b32 s13, s45, 0xffff
    s_mov_b32 s14, 2621440
    s_mov_b32 s15, 0x20000
    s_mov_b32 s44, s46
    s_and_b32 s45, s47, 0xffff
    s_mov_b32 s46, 256
    s_mov_b32 s47, 0x20000
    s_cmp_eq_u32 s73, 15
    s_cbranch_scc1 L_nodma
    s_cmp_lt_u32 s16, 4
    s_cbranch_scc1 L_nodma
    s_add_u32 m0, s78, 0
    s_add_u32 s32, s76, 0
    buffer_load_dwordx4 v242, s[60:63], s32 offen lds
    s_add_u32 m0, s78, 4096
    s_add_u32 s32, s76, 40960
    buffer_load_dwordx4 v242, s[60:63], s32 offen lds
    s_add_u32 m0, s78, 8192
    s_add_u32 s32, s76, 81920
    buffer_load_dwordx4 v242, s[60:63], s32 offen lds
    s_add_u32 m0, s78, 12288
    s_add_u32 s32, s76, 122880
    buffer_load_dwordx4 v242, s[60:63], s32 offen lds
    s_add_u32 m0, s78, 16384
    s_add_u32 s32, s77, 0
    buffer_load_dwordx4 v243, s[64:67], s32 offen lds
    s_add_u32 m0, s78, 20480
    s_add_u32 s32, s77, 61440
    buffer_load_dwordx4 v243, s[64:67], s32 offen lds
    s_add_u32 m0, s78, 24576
    s_add_u32 s32, s77, 122880
    buffer_load_dwordx4 v243, s[64:67], s32 offen lds
    s_add_u32 m0, s78, 28672
    s_add_u32 s32, s77, 184320
    buffer_load_dwordx4 v243, s[64:67], s32 offen lds
    s_add_u32 m0, s78, 32768
    s_add_u32 s32, s76, 128
    buffer_load_dwordx4 v242, s[60:63], s32 offen lds
    s_add_u32 m0, s78, 36864
    s_add_u32 s32, s76, 41088
    buffer_load_dwordx4 v242, s[60:63], s32 offen lds
    s_add_u32 m0, s78, 40960
    s_add_u32 s32, s76, 82048
    buffer_load_dwordx4 v242, s[60:63], s32 offen lds
    s_add_u32 m0, s78, 45056
    s_add_u32 s32, s76, 123008
    buffer_load_dwordx4 v242, s[60:63], s32 offen lds
    s_add_u32 m0, s78, 49152
    s_add_u32 s32, s77, 245760
    buffer_load_dwordx4 v243, s[64:67], s32 offen lds
    s_add_u32 m0, s78, 53248
    s_add_u32 s32, s77, 307200
    buffer_load_dwordx4 v243, s[64:67], s32 offen lds
    s_add_u32 m0, s78, 57344
    s_add_u32 s32, s77, 368640
    buffer_load_dwordx4 v243, s[64:67], s32 offen lds
    s_add_u32 m0, s78, 61440
    s_add_u32 s32, s77, 430080
    buffer_load_dwordx4 v243, s[64:67], s32 offen lds
    s_add_u32 m0, s78, 65536
    s_add_u32 s32, s76, 256
    buffer_load_dwordx4 v242, s[60:63], s32 offen lds
    s_add_u32 m0, s78, 69632
    s_add_u32 s32, s76, 41216
    buffer_load_dwordx4 v242, s[60:63], s32 offen lds
    s_add_u32 m0, s78, 73728
    s_add_u32 s32, s76, 82176
    buffer_load_dwordx4 v242, s[60:63], s32 offen lds
    s_add_u32 m0, s78, 77824
    s_add_u32 s32, s76, 123136
    buffer_load_dwordx4 v242, s[60:63], s32 offen lds
    s_add_u32 m0, s78, 81920
    s_add_u32 s32, s77, 491520
    buffer_load_dwordx4 v243, s[64:67], s32 offen lds
    s_add_u32 m0, s78, 86016
    s_add_u32 s32, s77, 552960
    buffer_load_dwordx4 v243, s[64:67], s32 offen lds
    s_add_u32 m0, s78, 90112
    s_add_u32 s32, s77, 614400
    buffer_load_dwordx4 v243, s[64:67], s32 offen lds
    s_add_u32 m0, s78, 94208
    s_add_u32 s32, s77, 675840
    buffer_load_dwordx4 v243, s[64:67], s32 offen lds
    s_cmp_ge_u32 s73, 10
    s_cbranch_scc1 L_g1n
    s_branch L_g1t
L_nodma:
    s_or_b32 s32, s2, s16
    s_cmp_lg_u32 s32, 0
    s_cbranch_scc1 L_nonce_done
    s_memrealtime s[36:37]
    s_waitcnt lgkmcnt(0)
    s_or_b32 s32, s36, 1
    v_mov_b32 v20, s32
    v_mov_b32 v21, 0
    s_mov_b64 exec, 1
    buffer_store_dword v20, v21, s[44:47], 0 offen sc1
    s_mov_b64 exec, -1
L_nonce_done:
    s_cmp_lg_u32 s16, 2
    s_cbranch_scc1 L_tp3_w
    v_mul_u32_u24 v20, 86, v1
    v_lshrrev_b32 v20, 8, v20
    v_mul_u32_u24 v21, 3, v20
    v_sub_u32 v21, v1, v21
    v_min_u32 v20, 7, v20
    v_mul_u32_u24 v20, 1280, v20
    v_lshl_add_u32 v20, v21, 7, v20
    s_mul_i32 s32, s2, 10240
    s_add_u32 s32, s32, 0
    buffer_load_dword v189, v20, s[60:63], s32 offen
L_tp3_w:
    s_cmp_lg_u32 s16, 3
    s_cbranch_scc1 L_tp3_done
    v_min_u32 v20, 22, v1
    v_lshlrev_b32 v20, 7, v20
    s_mul_i32 s32, s2, 2880
    s_and_b32 s32, s32, 0xffffff80
    s_add_u32 s32, s32, 0
    buffer_load_dword v190, v20, s[64:67], s32 offen
L_tp3_done:
    v_lshrrev_b32 v22, 1, v2
    v_and_b32 v22, 7, v22
    v_xor_b32 v22, v22, v3
    v_lshlrev_b32 v22, 4, v22
    s_lshl_b32 s32, s74, 6
    v_add_u32 v23, s32, v2
    v_lshl_add_u32 v106, v23, 7, v22
    v_xor_b32 v109, 32, v106
    v_xor_b32 v112, 64, v106
    v_xor_b32 v115, 96, v106
    v_add_u32 v107, 0x10000, v106
    v_add_u32 v108, 0x20000, v106
    v_add_u32 v110, 0x10000, v109
    v_add_u32 v111, 0x20000, v109
    v_add_u32 v113, 0x10000, v112
    v_add_u32 v114, 0x20000, v112
    v_add_u32 v116, 0x10000, v115
    v_add_u32 v117, 0x20000, v115
    v_bfe_u32 v22, v1, 2, 2
    v_lshl_add_u32 v23, v3, 3, v22
    v_lshlrev_b32 v23, 8, v23
    v_bfe_u32 v24, v1, 4, 1
    v_lshlrev_b32 v24, 5, v24
    v_add_u32 v23, v23, v24
    v_and_b32 v24, 3, v1
    v_lshlrev_b32 v24, 3, v24
    v_add_u32 v23, v23, v24
    s_lshl_b32 s32, s75, 1
    s_add_u32 s32, s32, 0
    v_xor_b32 v24, s32, v22
    v_lshl_add_u32 v118, v24, 6, v23
    v_add_u32 v119, 0x10000, v118
    v_add_u32 v120, 0x20000, v118
    s_lshl_b32 s32, s75, 1
    s_add_u32 s32, s32, 1
    v_xor_b32 v24, s32, v22
    v_lshl_add_u32 v121, v24, 6, v23
    v_add_u32 v122, 0x10000, v121
    v_add_u32 v123, 0x20000, v121
    s_cmp_lg_u32 s16, 0
    s_cbranch_scc1 L_tp0_w
    v_mul_u32_u24 v20, 86, v1
    v_lshrrev_b32 v20, 8, v20
    v_mul_u32_u24 v21, 3, v20
    v_sub_u32 v21, v1, v21
    v_min_u32 v20, 7, v20
    v_mul_u32_u24 v20, 1280, v20
    v_lshl_add_u32 v20, v21, 7, v20
    s_mul_i32 s32, s2, 10240
    s_add_u32 s32, s32, 384
    buffer_load_dword v189, v20, s[60:63], s32 offen
L_tp0_w:
    s_cmp_lg_u32 s16, 1
    s_cbranch_scc1 L_tp0_done
    v_min_u32 v20, 22, v1
    v_lshlrev_b32 v20, 7, v20
    s_mul_i32 s32, s2, 2880
    s_and_b32 s32, s32, 0xffffff80
    s_add_u32 s32, s32, 737280
    buffer_load_dword v190, v20, s[64:67], s32 offen
L_tp0_done:
    s_lshl_b32 s91, s73, 4
    s_add_u32 s91, s91, s72
    s_lshl_b32 s91, s91, 2
    s_and_b32 s32, s2, 7
    s_lshl_b32 s32, s32, 2
    s_lshr_b32 s33, s2, 3
    s_and_b32 s33, s33, 3
    s_add_u32 s18, s32, s33
    s_lshr_b32 s19, s2, 5
    s_lshr_b32 s32, s18, 1
    s_mul_i32 s32, s32, 5
    s_add_u32 s43, s32, 2
    s_and_b32 s33, s18, 1
    s_mul_i32 s33, s33, 3
    s_add_u32 s20, s32, s33
    s_mul_i32 s57, s18, 81920
    s_mul_i32 s21, s16, 2816
    s_mul_i32 s22, s16, 2560
    s_lshl_b32 s29, s19, 8
    s_lshl_b32 s32, s16, 5
    s_add_u32 s29, s29, s32
    s_lshl_b32 s31, s19, 2
    s_lshr_b32 s32, s16, 1
    s_add_u32 s31, s31, s32
    s_and_b32 s33, s16, 1
    s_lshl_b32 s30, s31, 6
    s_add_u32 s30, s30, s33
    s_mov_b32 s40, 0xfffff
    s_mov_b32 s41, 0xfffff
    v_lshlrev_b32 v236, 15, v3
    v_lshl_add_u32 v236, v2, 4, v236
    v_lshlrev_b32 v237, 4, v2
    v_lshlrev_b32 v238, 2, v2
    s_lshl_b32 s32, s29, 4
    s_lshl_b32 s88, s20, 15
    s_add_u32 s88, s88, s32
    s_lshl_b32 s89, s43, 15
    s_add_u32 s89, s89, s32
    s_and_b32 s33, s18, 1
    s_lshl_b32 s33, s33, 3
    s_add_u32 s89, s89, s33
    s_lshl_b32 s90, s29, 2
    s_add_u32 s90, s90, 22609920
    s_cmp_lg_u32 s16, 2
    s_cbranch_scc1 L_tp1_w
    v_lshrrev_b32 v20, 2, v1
    v_mul_u32_u24 v21, 4, v20
    v_sub_u32 v21, v1, v21
    v_min_u32 v20, 7, v20
    v_mul_u32_u24 v20, 1280, v20
    v_lshl_add_u32 v20, v21, 7, v20
    s_mul_i32 s32, s2, 10240
    s_add_u32 s32, s32, 768
    buffer_load_dword v189, v20, s[60:63], s32 offen
L_tp1_w:
    s_cmp_lg_u32 s16, 3
    s_cbranch_scc1 L_tp1_done
    v_min_u32 v20, 29, v1
    v_lshlrev_b32 v20, 7, v20
    s_mul_i32 s32, s2, 3840
    s_and_b32 s32, s32, 0xffffff80
    s_add_u32 s32, s32, 1474560
    buffer_load_dword v190, v20, s[64:67], s32 offen
L_tp1_done:
    s_and_b32 s33, s18, 1
    s_lshl_b32 s33, s33, 3
    v_lshlrev_b32 v20, 12, v3
    v_lshl_add_u32 v20, v2, 4, v20
    v_lshlrev_b32 v21, 4, v2
    v_add_u32 v21, s33, v21
    v_mul_u32_u24 v22, 320, v3
    v_lshl_add_u32 v22, v2, 4, v22
    v_add_u32 v23, 90112, v22
    v_cmp_gt_u32 vcc, 20, v2
    v_add_u32 v4, 0, v20
    v_add_u32 v8, 0, v21
    v_add_u32 v24, 12288, v22
    v_cndmask_b32 v12, v23, v24, vcc
    v_add_u32 v5, 22528, v20
    v_add_u32 v9, 22528, v21
    v_add_u32 v24, 34816, v22
    v_cndmask_b32 v13, v23, v24, vcc
    v_add_u32 v6, 45056, v20
    v_add_u32 v10, 45056, v21
    v_add_u32 v24, 57344, v22
    v_cndmask_b32 v14, v23, v24, vcc
    v_add_u32 v7, 67584, v20
    v_add_u32 v11, 67584, v21
    v_add_u32 v24, 79872, v22
    v_cndmask_b32 v15, v23, v24, vcc
    s_lshl_b32 s34, s20, 15
    s_add_u32 s34, s34, 5242880
    s_lshl_b32 s35, s43, 15
    s_add_u32 s35, s35, 5234688
    s_add_u32 s36, s57, 10473472
    v_add_u32 v20, s21, v16
    v_lshrrev_b32 v21, 12, v20
    v_and_b32 v22, 4095, v20
    v_lshl_add_u32 v22, v21, 15, v22
    v_add_u32 v22, s34, v22
    v_add_u32 v23, s35, v20
    v_add_u32 v24, s36, v20
    v_cmp_eq_u32 vcc, 2, v21
    v_mov_b32 v25, 4096
    v_mov_b32 v26, 10240
    v_cndmask_b32 v22, v22, v23, vcc
    v_cmp_le_u32 vcc, 3, v21
    s_nop 1
    v_cndmask_b32 v244, v22, v24, vcc
    v_cndmask_b32 v247, v25, v26, vcc
    v_add_u32 v20, s21, v16
    v_add_u32 v20, 1024, v20
    v_lshrrev_b32 v21, 12, v20
    v_and_b32 v22, 4095, v20
    v_lshl_add_u32 v22, v21, 15, v22
    v_add_u32 v22, s34, v22
    v_add_u32 v23, s35, v20
    v_add_u32 v24, s36, v20
    v_cmp_eq_u32 vcc, 2, v21
    v_mov_b32 v25, 4096
    v_mov_b32 v26, 10240
    v_cndmask_b32 v22, v22, v23, vcc
    v_cmp_le_u32 vcc, 3, v21
    s_nop 1
    v_cndmask_b32 v245, v22, v24, vcc
    v_cndmask_b32 v248, v25, v26, vcc
    v_add_u32 v20, s21, v16
    v_add_u32 v20, 2048, v20
    v_lshrrev_b32 v21, 12, v20
    v_and_b32 v22, 4095, v20
    v_lshl_add_u32 v22, v21, 15, v22
    v_add_u32 v22, s34, v22
    v_add_u32 v23, s35, v20
    v_add_u32 v24, s36, v20
    v_cmp_eq_u32 vcc, 2, v21
    v_mov_b32 v25, 4096
    v_mov_b32 v26, 10240
    v_cndmask_b32 v22, v22, v23, vcc
    v_cmp_le_u32 vcc, 3, v21
    s_nop 1
    v_cndmask_b32 v246, v22, v24, vcc
    v_cndmask_b32 v249, v25, v26, vcc
    s_lshr_b32 s32, s18, 1
    s_mul_i32 s32, s32, 5
    s_and_b32 s33, s18, 1
    s_lshl_b32 s34, s33, 1
    s_add_u32 s34, s34, s32
    v_add_u32 v20, s34, v3
    v_lshlrev_b32 v20, 15, v20
    v_lshl_add_u32 v252, v2, 4, v20
    v_lshl_add_u32 v253, v2, 5, v20
    s_add_u32 s32, s32, 4
    s_lshl_b32 s32, s32, 15
    s_lshl_b32 s33, s33, 3
    s_add_u32 s32, s32, s33
    v_lshlrev_b32 v20, 4, v2
    v_add_u32 v254, s32, v20
    v_lshlrev_b32 v20, 5, v2
    v_add_u32 v255, s32, v20
    s_mul_i32 s32, s18, 20
    s_add_u32 s33, s32, 19
    s_lshr_b32 s32, s32, 7
    s_lshr_b32 s33, s33, 7
    v_bfe_u32 v20, v1, 4, 1
    s_sub_u32 s34, s33, s32
    v_mul_u32_u24 v21, s34, v20
    v_add_u32 v21, s32, v21
    v_mul_u32_u24 v22, 5, v3
    v_add_u32 v22, 5, v22
    v_add_u32 v22, v22, v21
    v_and_b32 v23, 15, v1
    v_lshl_add_u32 v22, v22, 4, v23
    v_lshlrev_b32 v232, 2, v22
    v_add_u32 v22, 240, v23
    v_lshlrev_b32 v241, 2, v22
    v_and_b32 v24, 1, v1
    s_lshl_b32 s35, s19, 1
    v_add_u32 v24, s35, v24
    v_lshl_add_u32 v24, v21, 4, v24
    v_lshlrev_b32 v233, 2, v24
    v_and_b32 v20, 1, v1
    v_mul_u32_u24 v21, s34, v20
    v_add_u32 v21, s32, v21
    v_bfe_u32 v22, v1, 1, 2
    v_min_u32 v22, 2, v22
    v_mul_u32_u24 v22, 5, v22
    v_add_u32 v21, v21, v22
    s_lshl_b32 s35, s19, 1
    v_bfe_u32 v22, v1, 3, 2
    v_min_u32 v22, 2, v22
    v_add_u32 v22, s35, v22
    v_max_u32 v22, 1, v22
    v_subrev_u32 v22, 1, v22
    v_lshl_add_u32 v21, v21, 4, v22
    v_lshlrev_b32 v234, 2, v21
    v_lshlrev_b32 v220, 15, v3
    v_lshl_add_u32 v220, v2, 4, v220
    v_lshlrev_b32 v221, 4, v2
    v_and_b32 v22, 25, v2
    v_bfe_u32 v23, v2, 1, 1
    v_lshl_or_b32 v22, v23, 2, v22
    v_bfe_u32 v23, v2, 2, 1
    v_lshl_or_b32 v22, v23, 1, v22
    v_lshlrev_b32 v23, 15, v3
    v_lshl_add_u32 v222, v22, 4, v23
    v_lshlrev_b32 v223, 4, v22
    v_mul_u32_u24 v24, 320, v3
    v_lshl_add_u32 v224, v2, 4, v24
    s_and_b32 s33, s16, 1
    s_lshl_b32 s33, s33, 10
    s_lshl_b32 s32, s31, 5
    s_add_u32 s34, s33, s32
    s_lshl_b32 s32, s20, 15
    s_lshl_b32 s33, s43, 15
    s_and_b32 s35, s18, 1
    s_lshl_b32 s35, s35, 3
    s_add_u32 s33, s33, s35
    s_lshl_b32 s35, s34, 4
    s_add_u32 s48, s35, s32
    s_add_u32 s48, s48, 2621440
    s_add_u32 s49, s35, s33
    s_add_u32 s49, s49, 2621440
    s_add_u32 s50, s35, s32
    s_add_u32 s50, s50, 7864320
    s_add_u32 s51, s35, s33
    s_add_u32 s51, s51, 7864320
    s_lshr_b32 s35, s34, 4
    s_mul_i32 s35, s35, 640
    s_add_u32 s52, s35, s57
    s_add_u32 s52, s52, 13107200
    s_cmp_eq_u32 s31, 0
    s_cselect_b32 s35, 0, 32
    s_sub_u32 s34, s34, s35
    s_lshl_b32 s35, s34, 4
    s_add_u32 s53, s35, s32
    s_add_u32 s53, s53, 7864320
    s_add_u32 s54, s35, s33
    s_add_u32 s54, s54, 7864320
    s_lshr_b32 s35, s34, 4
    s_mul_i32 s35, s35, 640
    s_add_u32 s55, s35, s57
    s_add_u32 s55, s55, 13107200
    s_lshl_b32 s56, s30, 2
    s_add_u32 s56, s56, 22609920
    s_lshr_b32 s33, s18, 3
    s_lshl_b32 s32, s19, 2
    s_add_u32 s33, s33, s32
    s_and_b32 s34, s18, 7
    s_and_b32 s35, s16, 3
    s_lshr_b32 s28, s16, 2
    s_lshl_b32 s25, s33, 8
    s_mul_i32 s23, s16, 20480
    s_mul_i32 s32, s34, 1280
    s_add_u32 s23, s23, s32
    s_add_u32 s23, s23, 20971520
    s_lshl_b32 s33, s33, 6
    s_lshl_b32 s35, s35, 4
    s_add_u32 s33, s33, s35
    s_mul_i32 s27, s33, 1280
    s_mul_i32 s32, s34, 160
    s_add_u32 s27, s27, s32
    s_lshl_b32 s24, s33, 4
    s_mul_i32 s32, s28, 1310720
    s_add_u32 s24, s24, s32
    s_add_u32 s24, s24, 15728640
    s_lshl_b32 s26, s31, 6
    s_lshl_b32 s32, s18, 1
    s_add_u32 s26, s26, s32
    s_and_b32 s32, s16, 1
    s_add_u32 s26, s26, s32
    s_lshl_b32 s26, s26, 2
    v_lshlrev_b32 v231, 2, v1
    v_mov_b32 v225, v16
    v_add_u32 v20, 1024, v16
    v_add_u32 v21, 9984, v16
    v_cmp_gt_u32 vcc, 16, v1
    v_add_u32 v227, 11008, v16
    v_lshrrev_b32 v22, 4, v1
    v_cndmask_b32 v226, v21, v20, vcc
    v_and_b32 v23, 15, v1
    v_lshlrev_b32 v24, 15, v22
    v_lshl_add_u32 v228, v23, 4, v24
    v_mul_u32_u24 v24, 1280, v22
    v_lshl_add_u32 v229, v23, 4, v24
    v_mul_u32_u24 v24, 1280, v23
    v_lshl_add_u32 v230, v22, 3, v24
    s_cmp_ge_u32 s16, 2
    s_cbranch_scc1 L_tp2_done
    s_lshl_b32 s33, s16, 6
    v_add_u32 v20, s33, v1
    v_min_u32 v20, 74, v20
    v_lshlrev_b32 v20, 7, v20
    s_mul_i32 s32, s2, 9600
    buffer_load_dword v191, v20, s[68:71], s32 offen
L_tp2_done:
    s_cmp_eq_u32 s73, 15
    s_cbranch_scc1 L_spare
    s_cmp_ge_u32 s73, 10
    s_cbranch_scc1 L_vtile
    s_barrier
    ds_read_b128 v[28:31], v106 offset:0
    ds_read_b128 v[32:35], v106 offset:4096
    ds_read_b64_tr_b16 v[36:37], v118 offset:16384
    ds_read_b64_tr_b16 v[38:39], v118 offset:17408
    ds_read_b64_tr_b16 v[40:41], v121 offset:16384
    ds_read_b64_tr_b16 v[42:43], v121 offset:17408
    ds_read_b128 v[44:47], v109 offset:0
    ds_read_b128 v[48:51], v109 offset:4096
    ds_read_b64_tr_b16 v[52:53], v118 offset:20480
    ds_read_b64_tr_b16 v[54:55], v118 offset:21504
    ds_read_b64_tr_b16 v[56:57], v121 offset:20480
    ds_read_b64_tr_b16 v[58:59], v121 offset:21504
    s_waitcnt lgkmcnt(6)
    v_mfma_f32_32x32x16_bf16 v[124:139], v[36:39], v[28:31], 0
    ds_read_b128 v[60:63], v112 offset:0
    ds_read_b128 v[64:67], v112 offset:4096
    v_mfma_f32_32x32x16_bf16 v[140:155], v[40:43], v[28:31], 0
    ds_read_b64_tr_b16 v[68:69], v118 offset:24576
    ds_read_b64_tr_b16 v[70:71], v118 offset:25600
    v_mfma_f32_32x32x16_bf16 v[156:171], v[36:39], v[32:35], 0
    ds_read_b64_tr_b16 v[72:73], v121 offset:24576
    ds_read_b64_tr_b16 v[74:75], v121 offset:25600
    v_mfma_f32_32x32x16_bf16 v[172:187], v[40:43], v[32:35], 0
    s_waitcnt lgkmcnt(6)
    v_mfma_f32_32x32x16_bf16 v[124:139], v[52:55], v[44:47], v[124:139]
    ds_read_b128 v[28:31], v115 offset:0
    ds_read_b128 v[32:35], v115 offset:4096
    v_mfma_f32_32x32x16_bf16 v[140:155], v[56:59], v[44:47], v[140:155]
    ds_read_b64_tr_b16 v[36:37], v118 offset:28672
    ds_read_b64_tr_b16 v[38:39], v118 offset:29696
    v_mfma_f32_32x32x16_bf16 v[156:171], v[52:55], v[48:51], v[156:171]
    ds_read_b64_tr_b16 v[40:41], v121 offset:28672
    ds_read_b64_tr_b16 v[42:43], v121 offset:29696
    v_mfma_f32_32x32x16_bf16 v[172:187], v[56:59], v[48:51], v[172:187]
    s_barrier
    s_waitcnt lgkmcnt(6)
    v_mfma_f32_32x32x16_bf16 v[124:139], v[68:71], v[60:63], v[124:139]
    ds_read_b128 v[44:47], v106 offset:32768
    ds_read_b128 v[48:51], v106 offset:36864
    v_mfma_f32_32x32x16_bf16 v[140:155], v[72:75], v[60:63], v[140:155]
    ds_read_b64_tr_b16 v[52:53], v118 offset:49152
    ds_read_b64_tr_b16 v[54:55], v118 offset:50176
    v_mfma_f32_32x32x16_bf16 v[156:171], v[68:71], v[64:67], v[156:171]
    ds_read_b64_tr_b16 v[56:57], v121 offset:49152
    ds_read_b64_tr_b16 v[58:59], v121 offset:50176
    v_mfma_f32_32x32x16_bf16 v[172:187], v[72:75], v[64:67], v[172:187]
    s_waitcnt lgkmcnt(6)
    v_mfma_f32_32x32x16_bf16 v[124:139], v[36:39], v[28:31], v[124:139]
    ds_read_b128 v[60:63], v109 offset:32768
    ds_read_b128 v[64:67], v109 offset:36864
    v_mfma_f32_32x32x16_bf16 v[140:155], v[40:43], v[28:31], v[140:155]
    ds_read_b64_tr_b16 v[68:69], v118 offset:53248
    ds_read_b64_tr_b16 v[70:71], v118 offset:54272
    v_mfma_f32_32x32x16_bf16 v[156:171], v[36:39], v[32:35], v[156:171]
    ds_read_b64_tr_b16 v[72:73], v121 offset:53248
    ds_read_b64_tr_b16 v[74:75], v121 offset:54272
    v_mfma_f32_32x32x16_bf16 v[172:187], v[40:43], v[32:35], v[172:187]
    s_waitcnt lgkmcnt(6)
    v_mfma_f32_32x32x16_bf16 v[124:139], v[52:55], v[44:47], v[124:139]
    ds_read_b128 v[28:31], v112 offset:32768
    ds_read_b128 v[32:35], v112 offset:36864
    v_mfma_f32_32x32x16_bf16 v[140:155], v[56:59], v[44:47], v[140:155]
    ds_read_b64_tr_b16 v[36:37], v118 offset:57344
    ds_read_b64_tr_b16 v[38:39], v118 offset:58368
    v_mfma_f32_32x32x16_bf16 v[156:171], v[52:55], v[48:51], v[156:171]
    ds_read_b64_tr_b16 v[40:41], v121 offset:57344
    ds_read_b64_tr_b16 v[42:43], v121 offset:58368
    v_mfma_f32_32x32x16_bf16 v[172:187], v[56:59], v[48:51], v[172:187]
    s_waitcnt lgkmcnt(6)
    v_mfma_f32_32x32x16_bf16 v[124:139], v[68:71], v[60:63], v[124:139]
    ds_read_b128 v[44:47], v115 offset:32768
    ds_read_b128 v[48:51], v115 offset:36864
    v_mfma_f32_32x32x16_bf16 v[140:155], v[72:75], v[60:63], v[140:155]
    ds_read_b64_tr_b16 v[52:53], v118 offset:61440
    ds_read_b64_tr_b16 v[54:55], v118 offset:62464
    v_mfma_f32_32x32x16_bf16 v[156:171], v[68:71], v[64:67], v[156:171]
    ds_read_b64_tr_b16 v[56:57], v121 offset:61440
    ds_read_b64_tr_b16 v[58:59], v121 offset:62464
    v_mfma_f32_32x32x16_bf16 v[172:187], v[72:75], v[64:67], v[172:187]
    s_barrier
    s_waitcnt lgkmcnt(6)
    v_mfma_f32_32x32x16_bf16 v[124:139], v[36:39], v[28:31], v[124:139]
    ds_read_b128 v[60:63], v107 offset:0
    ds_read_b128 v[64:67], v107 offset:4096
    v_mfma_f32_32x32x16_bf16 v[140:155], v[40:43], v[28:31], v[140:155]
    ds_read_b64_tr_b16 v[68:69], v119 offset:16384
    ds_read_b64_tr_b16 v[70:71], v119 offset:17408
    v_mfma_f32_32x32x16_bf16 v[156:171], v[36:39], v[32:35], v[156:171]
    ds_read_b64_tr_b16 v[72:73], v122 offset:16384
    ds_read_b64_tr_b16 v[74:75], v122 offset:17408
    v_mfma_f32_32x32x16_bf16 v[172:187], v[40:43], v[32:35], v[172:187]
    s_waitcnt lgkmcnt(6)
    v_mfma_f32_32x32x16_bf16 v[124:139], v[52:55], v[44:47], v[124:139]
    ds_read_b128 v[28:31], v110 offset:0
    ds_read_b128 v[32:35], v110 offset:4096
    v_mfma_f32_32x32x16_bf16 v[140:155], v[56:59], v[44:47], v[140:155]
    ds_read_b64_tr_b16 v[36:37], v119 offset:20480
    ds_read_b64_tr_b16 v[38:39], v119 offset:21504
    v_mfma_f32_32x32x16_bf16 v[156:171], v[52:55], v[48:51], v[156:171]
    ds_read_b64_tr_b16 v[40:41], v122 offset:20480
    ds_read_b64_tr_b16 v[42:43], v122 offset:21504
    v_mfma_f32_32x32x16_bf16 v[172:187], v[56:59], v[48:51], v[172:187]
    s_waitcnt lgkmcnt(6)
    v_mfma_f32_32x32x16_bf16 v[124:139], v[68:71], v[60:63], v[124:139]
    ds_read_b128 v[44:47], v113 offset:0
    ds_read_b128 v[48:51], v113 offset:4096
    v_mfma_f32_32x32x16_bf16 v[140:155], v[72:75], v[60:63], v[140:155]
    ds_read_b64_tr_b16 v[52:53], v119 offset:24576
    ds_read_b64_tr_b16 v[54:55], v119 offset:25600
    v_mfma_f32_32x32x16_bf16 v[156:171], v[68:71], v[64:67], v[156:171]
    ds_read_b64_tr_b16 v[56:57], v122 offset:24576
    ds_read_b64_tr_b16 v[58:59], v122 offset:25600
    v_mfma_f32_32x32x16_bf16 v[172:187], v[72:75], v[64:67], v[172:187]
    s_waitcnt lgkmcnt(6)
    v_mfma_f32_32x32x16_bf16 v[124:139], v[36:39], v[28:31], v[124:139]
    ds_read_b128 v[60:63], v116 offset:0
    ds_read_b128 v[64:67], v116 offset:4096
    v_mfma_f32_32x32x16_bf16 v[140:155], v[40:43], v[28:31], v[140:155]
    ds_read_b64_tr_b16 v[68:69], v119 offset:28672
    ds_read_b64_tr_b16 v[70:71], v119 offset:29696
    v_mfma_f32_32x32x16_bf16 v[156:171], v[36:39], v[32:35], v[156:171]
    ds_read_b64_tr_b16 v[72:73], v122 offset:28672
    ds_read_b64_tr_b16 v[74:75], v122 offset:29696
    v_mfma_f32_32x32x16_bf16 v[172:187], v[40:43], v[32:35], v[172:187]
    s_barrier
    s_waitcnt lgkmcnt(6)
    v_mfma_f32_32x32x16_bf16 v[124:139], v[52:55], v[44:47], v[124:139]
    ds_read_b128 v[28:31], v107 offset:32768
    ds_read_b128 v[32:35], v107 offset:36864
    v_mfma_f32_32x32x16_bf16 v[140:155], v[56:59], v[44:47], v[140:155]
    ds_read_b64_tr_b16 v[36:37], v119 offset:49152
    ds_read_b64_tr_b16 v[38:39], v119 offset:50176
    v_mfma_f32_32x32x16_bf16 v[156:171], v[52:55], v[48:51], v[156:171]
    ds_read_b64_tr_b16 v[40:41], v122 offset:49152
    ds_read_b64_tr_b16 v[42:43], v122 offset:50176
    v_mfma_f32_32x32x16_bf16 v[172:187], v[56:59], v[48:51], v[172:187]
    s_waitcnt lgkmcnt(6)
    v_mfma_f32_32x32x16_bf16 v[124:139], v[68:71], v[60:63], v[124:139]
    ds_read_b128 v[44:47], v110 offset:32768
    ds_read_b128 v[48:51], v110 offset:36864
    v_mfma_f32_32x32x16_bf16 v[140:155], v[72:75], v[60:63], v[140:155]
    ds_read_b64_tr_b16 v[52:53], v119 offset:53248
    ds_read_b64_tr_b16 v[54:55], v119 offset:54272
    v_mfma_f32_32x32x16_bf16 v[156:171], v[68:71], v[64:67], v[156:171]
    ds_read_b64_tr_b16 v[56:57], v122 offset:53248
    ds_read_b64_tr_b16 v[58:59], v122 offset:54272
    v_mfma_f32_32x32x16_bf16 v[172:187], v[72:75], v[64:67], v[172:187]
    s_waitcnt lgkmcnt(6)
    v_mfma_f32_32x32x16_bf16 v[124:139], v[36:39], v[28:31], v[124:139]
    ds_read_b128 v[60:63], v113 offset:32768
    ds_read_b128 v[64:67], v113 offset:36864
    v_mfma_f32_32x32x16_bf16 v[140:155], v[40:43], v[28:31], v[140:155]
    ds_read_b64_tr_b16 v[68:69], v119 offset:57344
    ds_read_b64_tr_b16 v[70:71], v119 offset:58368
    v_mfma_f32_32x32x16_bf16 v[156:171], v[36:39], v[32:35], v[156:171]
    ds_read_b64_tr_b16 v[72:73], v122 offset:57344
    ds_read_b64_tr_b16 v[74:75], v122 offset:58368
    v_mfma_f32_32x32x16_bf16 v[172:187], v[40:43], v[32:35], v[172:187]
    s_waitcnt lgkmcnt(6)
    v_mfma_f32_32x32x16_bf16 v[124:139], v[52:55], v[44:47], v[124:139]
    ds_read_b128 v[28:31], v116 offset:32768
    ds_read_b128 v[32:35], v116 offset:36864
    v_mfma_f32_32x32x16_bf16 v[140:155], v[56:59], v[44:47], v[140:155]
    ds_read_b64_tr_b16 v[36:37], v119 offset:61440
    ds_read_b64_tr_b16 v[38:39], v119 offset:62464
    v_mfma_f32_32x32x16_bf16 v[156:171], v[52:55], v[48:51], v[156:171]
    ds_read_b64_tr_b16 v[40:41], v122 offset:61440
    ds_read_b64_tr_b16 v[42:43], v122 offset:62464
    v_mfma_f32_32x32x16_bf16 v[172:187], v[56:59], v[48:51], v[172:187]
    s_barrier
    s_waitcnt lgkmcnt(6)
    v_mfma_f32_32x32x16_bf16 v[124:139], v[68:71], v[60:63], v[124:139]
    ds_read_b128 v[44:47], v108 offset:0
    ds_read_b128 v[48:51], v108 offset:4096
    v_mfma_f32_32x32x16_bf16 v[140:155], v[72:75], v[60:63], v[140:155]
    ds_read_b64_tr_b16 v[52:53], v120 offset:16384
    ds_read_b64_tr_b16 v[54:55], v120 offset:17408
    v_mfma_f32_32x32x16_bf16 v[156:171], v[68:71], v[64:67], v[156:171]
    ds_read_b64_tr_b16 v[56:57], v123 offset:16384
    ds_read_b64_tr_b16 v[58:59], v123 offset:17408
    v_mfma_f32_32x32x16_bf16 v[172:187], v[72:75], v[64:67], v[172:187]
    s_waitcnt lgkmcnt(6)
    v_mfma_f32_32x32x16_bf16 v[124:139], v[36:39], v[28:31], v[124:139]
    ds_read_b128 v[60:63], v111 offset:0
    ds_read_b128 v[64:67], v111 offset:4096
    v_mfma_f32_32x32x16_bf16 v[140:155], v[40:43], v[28:31], v[140:155]
    ds_read_b64_tr_b16 v[68:69], v120 offset:20480
    ds_read_b64_tr_b16 v[70:71], v120 offset:21504
    v_mfma_f32_32x32x16_bf16 v[156:171], v[36:39], v[32:35], v[156:171]
    ds_read_b64_tr_b16 v[72:73], v123 offset:20480
    ds_read_b64_tr_b16 v[74:75], v123 offset:21504
    v_mfma_f32_32x32x16_bf16 v[172:187], v[40:43], v[32:35], v[172:187]
    s_waitcnt lgkmcnt(6)
    v_mfma_f32_32x32x16_bf16 v[124:139], v[52:55], v[44:47], v[124:139]
    ds_read_b128 v[28:31], v114 offset:0
    ds_read_b128 v[32:35], v114 offset:4096
    v_mfma_f32_32x32x16_bf16 v[140:155], v[56:59], v[44:47], v[140:155]
    ds_read_b64_tr_b16 v[36:37], v120 offset:24576
    ds_read_b64_tr_b16 v[38:39], v120 offset:25600
    v_mfma_f32_32x32x16_bf16 v[156:171], v[52:55], v[48:51], v[156:171]
    ds_read_b64_tr_b16 v[40:41], v123 offset:24576
    ds_read_b64_tr_b16 v[42:43], v123 offset:25600
    v_mfma_f32_32x32x16_bf16 v[172:187], v[56:59], v[48:51], v[172:187]
    s_waitcnt lgkmcnt(6)
    v_mfma_f32_32x32x16_bf16 v[124:139], v[68:71], v[60:63], v[124:139]
    ds_read_b128 v[44:47], v117 offset:0
    ds_read_b128 v[48:51], v117 offset:4096
    v_mfma_f32_32x32x16_bf16 v[140:155], v[72:75], v[60:63], v[140:155]
    ds_read_b64_tr_b16 v[52:53], v120 offset:28672
    ds_read_b64_tr_b16 v[54:55], v120 offset:29696
    v_mfma_f32_32x32x16_bf16 v[156:171], v[68:71], v[64:67], v[156:171]
    ds_read_b64_tr_b16 v[56:57], v123 offset:28672
    ds_read_b64_tr_b16 v[58:59], v123 offset:29696
    v_mfma_f32_32x32x16_bf16 v[172:187], v[72:75], v[64:67], v[172:187]
    s_barrier
    s_waitcnt lgkmcnt(6)
    v_mfma_f32_32x32x16_bf16 v[124:139], v[36:39], v[28:31], v[124:139]
    ds_read_b128 v[60:63], v106 offset:0
    ds_read_b128 v[64:67], v106 offset:4096
    v_mfma_f32_32x32x16_bf16 v[140:155], v[40:43], v[28:31], v[140:155]
    ds_read_b64_tr_b16 v[68:69], v118 offset:16384
    ds_read_b64_tr_b16 v[70:71], v118 offset:17408
    v_mfma_f32_32x32x16_bf16 v[156:171], v[36:39], v[32:35], v[156:171]
    ds_read_b64_tr_b16 v[72:73], v121 offset:16384
    ds_read_b64_tr_b16 v[74:75], v121 offset:17408
    v_mfma_f32_32x32x16_bf16 v[172:187], v[40:43], v[32:35], v[172:187]
    s_waitcnt lgkmcnt(6)
    v_mfma_f32_32x32x16_bf16 v[124:139], v[52:55], v[44:47], v[124:139]
    ds_read_b128 v[28:31], v109 offset:0
    ds_read_b128 v[32:35], v109 offset:4096
    v_mfma_f32_32x32x16_bf16 v[140:155], v[56:59], v[44:47], v[140:155]
    ds_read_b64_tr_b16 v[36:37], v118 offset:20480
    ds_read_b64_tr_b16 v[38:39], v118 offset:21504
    v_mfma_f32_32x32x16_bf16 v[156:171], v[52:55], v[48:51], v[156:171]
    ds_read_b64_tr_b16 v[40:41], v121 offset:20480
    ds_read_b64_tr_b16 v[42:43], v121 offset:21504
    v_mfma_f32_32x32x16_bf16 v[172:187], v[56:59], v[48:51], v[172:187]
    s_waitcnt lgkmcnt(6)
    v_mfma_f32_32x32x16_bf16 v[124:139], v[68:71], v[60:63], v[124:139]
    ds_read_b128 v[44:47], v112 offset:0
    ds_read_b128 v[48:51], v112 offset:4096
    v_mfma_f32_32x32x16_bf16 v[140:155], v[72:75], v[60:63], v[140:155]
    ds_read_b64_tr_b16 v[52:53], v118 offset:24576
    ds_read_b64_tr_b16 v[54:55], v118 offset:25600
    v_mfma_f32_32x32x16_bf16 v[156:171], v[68:71], v[64:67], v[156:171]
    ds_read_b64_tr_b16 v[56:57], v121 offset:24576
    ds_read_b64_tr_b16 v[58:59], v121 offset:25600
    v_mfma_f32_32x32x16_bf16 v[172:187], v[72:75], v[64:67], v[172:187]
    s_waitcnt lgkmcnt(6)
    v_mfma_f32_32x32x16_bf16 v[124:139], v[36:39], v[28:31], v[124:139]
    ds_read_b128 v[60:63], v115 offset:0
    ds_read_b128 v[64:67], v115 offset:4096
    v_mfma_f32_32x32x16_bf16 v[140:155], v[40:43], v[28:31], v[140:155]
    ds_read_b64_tr_b16 v[68:69], v118 offset:28672
    ds_read_b64_tr_b16 v[70:71], v118 offset:29696
    v_mfma_f32_32x32x16_bf16 v[156:171], v[36:39], v[32:35], v[156:171]
    ds_read_b64_tr_b16 v[72:73], v121 offset:28672
    ds_read_b64_tr_b16 v[74:75], v121 offset:29696
    v_mfma_f32_32x32x16_bf16 v[172:187], v[40:43], v[32:35], v[172:187]
    s_barrier
    v_mov_b32 v20, 0
    buffer_load_dword v19, v20, s[44:47], 0 offen sc1
    s_waitcnt lgkmcnt(6)
    v_mfma_f32_32x32x16_bf16 v[124:139], v[52:55], v[44:47], v[124:139]
    ds_read_b128 v[28:31], v106 offset:32768
    ds_read_b128 v[32:35], v106 offset:36864
    v_mfma_f32_32x32x16_bf16 v[140:155], v[56:59], v[44:47], v[140:155]
    ds_read_b64_tr_b16 v[36:37], v118 offset:49152
    ds_read_b64_tr_b16 v[38:39], v118 offset:50176
    v_mfma_f32_32x32x16_bf16 v[156:171], v[52:55], v[48:51], v[156:171]
    ds_read_b64_tr_b16 v[40:41], v121 offset:49152
    ds_read_b64_tr_b16 v[42:43], v121 offset:50176
    v_mfma_f32_32x32x16_bf16 v[172:187], v[56:59], v[48:51], v[172:187]
    s_waitcnt lgkmcnt(6)
    v_mfma_f32_32x32x16_bf16 v[124:139], v[68:71], v[60:63], v[124:139]
    ds_read_b128 v[44:47], v109 offset:32768
    ds_read_b128 v[48:51], v109 offset:36864
    v_mfma_f32_32x32x16_bf16 v[140:155], v[72:75], v[60:63], v[140:155]
    ds_read_b64_tr_b16 v[52:53], v118 offset:53248
    ds_read_b64_tr_b16 v[54:55], v118 offset:54272
    v_mfma_f32_32x32x16_bf16 v[156:171], v[68:71], v[64:67], v[156:171]
    ds_read_b64_tr_b16 v[56:57], v121 offset:53248
    ds_read_b64_tr_b16 v[58:59], v121 offset:54272
    v_mfma_f32_32x32x16_bf16 v[172:187], v[72:75], v[64:67], v[172:187]
    s_waitcnt lgkmcnt(6)
    v_mfma_f32_32x32x16_bf16 v[124:139], v[36:39], v[28:31], v[124:139]
    ds_read_b128 v[60:63], v112 offset:32768
    ds_read_b128 v[64:67], v112 offset:36864
    v_mfma_f32_32x32x16_bf16 v[140:155], v[40:43], v[28:31], v[140:155]
    ds_read_b64_tr_b16 v[68:69], v118 offset:57344
    ds_read_b64_tr_b16 v[70:71], v118 offset:58368
    v_mfma_f32_32x32x16_bf16 v[156:171], v[36:39], v[32:35], v[156:171]
    ds_read_b64_tr_b16 v[72:73], v121 offset:57344
    ds_read_b64_tr_b16 v[74:75], v121 offset:58368
    v_mfma_f32_32x32x16_bf16 v[172:187], v[40:43], v[32:35], v[172:187]
    s_waitcnt lgkmcnt(6)
    v_mfma_f32_32x32x16_bf16 v[124:139], v[52:55], v[44:47], v[124:139]
    ds_read_b128 v[28:31], v115 offset:32768
    ds_read_b128 v[32:35], v115 offset:36864
    v_mfma_f32_32x32x16_bf16 v[140:155], v[56:59], v[44:47], v[140:155]
    ds_read_b64_tr_b16 v[36:37], v118 offset:61440
    ds_read_b64_tr_b16 v[38:39], v118 offset:62464
    v_mfma_f32_32x32x16_bf16 v[156:171], v[52:55], v[48:51], v[156:171]
    ds_read_b64_tr_b16 v[40:41], v121 offset:61440
    ds_read_b64_tr_b16 v[42:43], v121 offset:62464
    v_mfma_f32_32x32x16_bf16 v[172:187], v[56:59], v[48:51], v[172:187]
    s_barrier
    s_waitcnt lgkmcnt(6)
    v_mfma_f32_32x32x16_bf16 v[124:139], v[68:71], v[60:63], v[124:139]
    ds_read_b128 v[44:47], v107 offset:0
    ds_read_b128 v[48:51], v107 offset:4096
    v_mfma_f32_32x32x16_bf16 v[140:155], v[72:75], v[60:63], v[140:155]
    ds_read_b64_tr_b16 v[52:53], v119 offset:16384
    ds_read_b64_tr_b16 v[54:55], v119 offset:17408
    v_mfma_f32_32x32x16_bf16 v[156:171], v[68:71], v[64:67], v[156:171]
    ds_read_b64_tr_b16 v[56:57], v122 offset:16384
    ds_read_b64_tr_b16 v[58:59], v122 offset:17408
    v_mfma_f32_32x32x16_bf16 v[172:187], v[72:75], v[64:67], v[172:187]
    s_waitcnt lgkmcnt(6)
    v_mfma_f32_32x32x16_bf16 v[124:139], v[36:39], v[28:31], v[124:139]
    ds_read_b128 v[60:63], v110 offset:0
    ds_read_b128 v[64:67], v110 offset:4096
    v_mfma_f32_32x32x16_bf16 v[140:155], v[40:43], v[28:31], v[140:155]
    ds_read_b64_tr_b16 v[68:69], v119 offset:20480
    ds_read_b64_tr_b16 v[70:71], v119 offset:21504
    v_mfma_f32_32x32x16_bf16 v[156:171], v[36:39], v[32:35], v[156:171]
    ds_read_b64_tr_b16 v[72:73], v122 offset:20480
    ds_read_b64_tr_b16 v[74:75], v122 offset:21504
    v_mfma_f32_32x32x16_bf16 v[172:187], v[40:43], v[32:35], v[172:187]
    s_waitcnt lgkmcnt(6)
    v_mfma_f32_32x32x16_bf16 v[124:139], v[52:55], v[44:47], v[124:139]
    ds_read_b128 v[28:31], v113 offset:0
    ds_read_b128 v[32:35], v113 offset:4096
    v_mfma_f32_32x32x16_bf16 v[140:155], v[56:59], v[44:47], v[140:155]
    ds_read_b64_tr_b16 v[36:37], v119 offset:24576
    ds_read_b64_tr_b16 v[38:39], v119 offset:25600
    v_mfma_f32_32x32x16_bf16 v[156:171], v[52:55], v[48:51], v[156:171]
    ds_read_b64_tr_b16 v[40:41], v122 offset:24576
    ds_read_b64_tr_b16 v[42:43], v122 offset:25600
    v_mfma_f32_32x32x16_bf16 v[172:187], v[56:59], v[48:51], v[172:187]
    s_waitcnt lgkmcnt(6)
    v_mfma_f32_32x32x16_bf16 v[124:139], v[68:71], v[60:63], v[124:139]
    ds_read_b128 v[44:47], v116 offset:0
    ds_read_b128 v[48:51], v116 offset:4096
    v_mfma_f32_32x32x16_bf16 v[140:155], v[72:75], v[60:63], v[140:155]
    ds_read_b64_tr_b16 v[52:53], v119 offset:28672
    ds_read_b64_tr_b16 v[54:55], v119 offset:29696
    v_mfma_f32_32x32x16_bf16 v[156:171], v[68:71], v[64:67], v[156:171]
    ds_read_b64_tr_b16 v[56:57], v122 offset:28672
    ds_read_b64_tr_b16 v[58:59], v122 offset:29696
    v_mfma_f32_32x32x16_bf16 v[172:187], v[72:75], v[64:67], v[172:187]
    s_barrier
    s_waitcnt vmcnt(0)
    s_nop 0
    v_readfirstlane_b32 s17, v19
    s_nop 3
    s_cmp_lg_u32 s17, 0
    s_cbranch_scc1 L_nonce0t_ok
    s_mov_b32 s42, 0
L_nonce0t_spin:
    s_sleep 1
    v_mov_b32 v20, 0
    buffer_load_dword v19, v20, s[44:47], 0 offen sc1
    s_add_u32 s42, s42, 1
    s_cmp_ge_u32 s42, 1048576
    s_cbranch_scc1 L_nonce0t_ok
    s_waitcnt vmcnt(0)
    v_readfirstlane_b32 s17, v19
    s_nop 3
    s_cmp_eq_u32 s17, 0
    s_cbranch_scc1 L_nonce0t_spin
L_nonce0t_ok:
    s_waitcnt lgkmcnt(6)
    v_mfma_f32_32x32x16_bf16 v[124:139], v[36:39], v[28:31], v[124:139]
    ds_read_b128 v[60:63], v107 offset:32768
    ds_read_b128 v[64:67], v107 offset:36864
    v_mfma_f32_32x32x16_bf16 v[140:155], v[40:43], v[28:31], v[140:155]
    ds_read_b64_tr_b16 v[68:69], v119 offset:49152
    ds_read_b64_tr_b16 v[70:71], v119 offset:50176
    v_mfma_f32_32x32x16_bf16 v[156:171], v[36:39], v[32:35], v[156:171]
    ds_read_b64_tr_b16 v[72:73], v122 offset:49152
    ds_read_b64_tr_b16 v[74:75], v122 offset:50176
    v_mfma_f32_32x32x16_bf16 v[172:187], v[40:43], v[32:35], v[172:187]
    s_waitcnt lgkmcnt(6)
    v_mfma_f32_32x32x16_bf16 v[124:139], v[52:55], v[44:47], v[124:139]
    ds_read_b128 v[28:31], v110 offset:32768
    ds_read_b128 v[32:35], v110 offset:36864
    v_mfma_f32_32x32x16_bf16 v[140:155], v[56:59], v[44:47], v[140:155]
    ds_read_b64_tr_b16 v[36:37], v119 offset:53248
    ds_read_b64_tr_b16 v[38:39], v119 offset:54272
    v_mfma_f32_32x32x16_bf16 v[156:171], v[52:55], v[48:51], v[156:171]
    ds_read_b64_tr_b16 v[40:41], v122 offset:53248
    ds_read_b64_tr_b16 v[42:43], v122 offset:54272
    v_mfma_f32_32x32x16_bf16 v[172:187], v[56:59], v[48:51], v[172:187]
    s_waitcnt lgkmcnt(6)
    v_mfma_f32_32x32x16_bf16 v[124:139], v[68:71], v[60:63], v[124:139]
    ds_read_b128 v[44:47], v113 offset:32768
    ds_read_b128 v[48:51], v113 offset:36864
    v_mfma_f32_32x32x16_bf16 v[140:155], v[72:75], v[60:63], v[140:155]
    ds_read_b64_tr_b16 v[52:53], v119 offset:57344
    ds_read_b64_tr_b16 v[54:55], v119 offset:58368
    v_mfma_f32_32x32x16_bf16 v[156:171], v[68:71], v[64:67], v[156:171]
    ds_read_b64_tr_b16 v[56:57], v122 offset:57344
    ds_read_b64_tr_b16 v[58:59], v122 offset:58368
    v_mfma_f32_32x32x16_bf16 v[172:187], v[72:75], v[64:67], v[172:187]
    s_waitcnt lgkmcnt(6)
    v_mfma_f32_32x32x16_bf16 v[124:139], v[36:39], v[28:31], v[124:139]
    ds_read_b128 v[60:63], v116 offset:32768
    ds_read_b128 v[64:67], v116 offset:36864
    v_mfma_f32_32x32x16_bf16 v[140:155], v[40:43], v[28:31], v[140:155]
    ds_read_b64_tr_b16 v[68:69], v119 offset:61440
    ds_read_b64_tr_b16 v[70:71], v119 offset:62464
    v_mfma_f32_32x32x16_bf16 v[156:171], v[36:39], v[32:35], v[156:171]
    ds_read_b64_tr_b16 v[72:73], v122 offset:61440
    ds_read_b64_tr_b16 v[74:75], v122 offset:62464
    v_mfma_f32_32x32x16_bf16 v[172:187], v[40:43], v[32:35], v[172:187]
    s_barrier
    s_waitcnt lgkmcnt(6)
    v_mfma_f32_32x32x16_bf16 v[124:139], v[52:55], v[44:47], v[124:139]
    ds_read_b128 v[28:31], v108 offset:0
    ds_read_b128 v[32:35], v108 offset:4096
    v_mfma_f32_32x32x16_bf16 v[140:155], v[56:59], v[44:47], v[140:155]
    ds_read_b64_tr_b16 v[36:37], v120 offset:16384
    ds_read_b64_tr_b16 v[38:39], v120 offset:17408
    v_mfma_f32_32x32x16_bf16 v[156:171], v[52:55], v[48:51], v[156:171]
    ds_read_b64_tr_b16 v[40:41], v123 offset:16384
    ds_read_b64_tr_b16 v[42:43], v123 offset:17408
    v_mfma_f32_32x32x16_bf16 v[172:187], v[56:59], v[48:51], v[172:187]
    s_waitcnt lgkmcnt(6)
    v_mfma_f32_32x32x16_bf16 v[124:139], v[68:71], v[60:63], v[124:139]
    ds_read_b128 v[44:47], v111 offset:0
    ds_read_b128 v[48:51], v111 offset:4096
    v_mfma_f32_32x32x16_bf16 v[140:155], v[72:75], v[60:63], v[140:155]
    ds_read_b64_tr_b16 v[52:53], v120 offset:20480
    ds_read_b64_tr_b16 v[54:55], v120 offset:21504
    v_mfma_f32_32x32x16_bf16 v[156:171], v[68:71], v[64:67], v[156:171]
    ds_read_b64_tr_b16 v[56:57], v123 offset:20480
    ds_read_b64_tr_b16 v[58:59], v123 offset:21504
    v_mfma_f32_32x32x16_bf16 v[172:187], v[72:75], v[64:67], v[172:187]
    s_waitcnt lgkmcnt(6)
    v_mfma_f32_32x32x16_bf16 v[124:139], v[36:39], v[28:31], v[124:139]
    ds_read_b128 v[60:63], v114 offset:0
    ds_read_b128 v[64:67], v114 offset:4096
    v_mfma_f32_32x32x16_bf16 v[140:155], v[40:43], v[28:31], v[140:155]
    ds_read_b64_tr_b16 v[68:69], v120 offset:24576
    ds_read_b64_tr_b16 v[70:71], v120 offset:25600
    v_mfma_f32_32x32x16_bf16 v[156:171], v[36:39], v[32:35], v[156:171]
    ds_read_b64_tr_b16 v[72:73], v123 offset:24576
    ds_read_b64_tr_b16 v[74:75], v123 offset:25600
    v_mfma_f32_32x32x16_bf16 v[172:187], v[40:43], v[32:35], v[172:187]
    s_waitcnt lgkmcnt(6)
    v_mfma_f32_32x32x16_bf16 v[124:139], v[52:55], v[44:47], v[124:139]
    ds_read_b128 v[28:31], v117 offset:0
    ds_read_b128 v[32:35], v117 offset:4096
    v_mfma_f32_32x32x16_bf16 v[140:155], v[56:59], v[44:47], v[140:155]
    ds_read_b64_tr_b16 v[36:37], v120 offset:28672
    ds_read_b64_tr_b16 v[38:39], v120 offset:29696
    v_mfma_f32_32x32x16_bf16 v[156:171], v[52:55], v[48:51], v[156:171]
    ds_read_b64_tr_b16 v[40:41], v123 offset:28672
    ds_read_b64_tr_b16 v[42:43], v123 offset:29696
    v_mfma_f32_32x32x16_bf16 v[172:187], v[56:59], v[48:51], v[172:187]
    s_barrier
    s_waitcnt lgkmcnt(6)
    v_mfma_f32_32x32x16_bf16 v[124:139], v[68:71], v[60:63], v[124:139]
    v_mfma_f32_32x32x16_bf16 v[140:155], v[72:75], v[60:63], v[140:155]
    v_mfma_f32_32x32x16_bf16 v[156:171], v[68:71], v[64:67], v[156:171]
    v_mfma_f32_32x32x16_bf16 v[172:187], v[72:75], v[64:67], v[172:187]
    s_waitcnt lgkmcnt(0)
    v_mfma_f32_32x32x16_bf16 v[124:139], v[36:39], v[28:31], v[124:139]
    v_mfma_f32_32x32x16_bf16 v[140:155], v[40:43], v[28:31], v[140:155]
    v_mfma_f32_32x32x16_bf16 v[156:171], v[36:39], v[32:35], v[156:171]
    v_mfma_f32_32x32x16_bf16 v[172:187], v[40:43], v[32:35], v[172:187]
    s_add_u32 m0, s78, 98304
    s_add_u32 s32, s76, 384
    buffer_load_dwordx4 v242, s[60:63], s32 offen lds
    s_add_u32 m0, s78, 102400
    s_add_u32 s32, s76, 41344
    buffer_load_dwordx4 v242, s[60:63], s32 offen lds
    s_add_u32 m0, s78, 106496
    s_add_u32 s32, s76, 82304
    buffer_load_dwordx4 v242, s[60:63], s32 offen lds
    s_add_u32 m0, s78, 110592
    s_add_u32 s32, s76, 123264
    buffer_load_dwordx4 v242, s[60:63], s32 offen lds
    s_add_u32 m0, s78, 114688
    s_add_u32 s32, s77, 737280
    buffer_load_dwordx4 v243, s[68:71], s32 offen lds
    s_add_u32 m0, s78, 118784
    s_add_u32 s32, s77, 798720
    buffer_load_dwordx4 v243, s[68:71], s32 offen lds
    s_add_u32 m0, s78, 122880
    s_add_u32 s32, s77, 860160
    buffer_load_dwordx4 v243, s[68:71], s32 offen lds
    s_add_u32 m0, s78, 126976
    s_add_u32 s32, s77, 921600
    buffer_load_dwordx4 v243, s[68:71], s32 offen lds
    s_lshl_b32 s80, s72, 7
    s_lshl_b32 s32, s74, 6
    s_add_u32 s80, s80, s32
    s_cmp_lt_u32 s73, 5
    s_mov_b32 s33, 0
    s_cselect_b32 s81, s33, 5242880
    s_mov_b32 s33, 0x3ea52b5c
    s_cselect_b32 s82, s33, 1.0
    s_lshl_b32 s32, s79, 1
    s_add_u32 s32, s32, s75
    s_lshl_b32 s32, s32, 18
    s_add_u32 s81, s81, s32
    s_lshl_b32 s32, s80, 4
    s_add_u32 s81, s81, s32
    v_lshlrev_b32 v76, 15, v3
    v_lshl_add_u32 v76, v2, 4, v76
    v_mov_b32 v22, s82
    v_mov_b32 v23, s82
    s_nop 7
    s_nop 3
    v_pk_mul_f32 v[124:125], v[124:125], v[22:23]
    v_pk_mul_f32 v[126:127], v[126:127], v[22:23]
    v_cvt_pk_bf16_f32 v188, v124, v125
    v_cvt_pk_bf16_f32 v189, v126, v127
    v_pk_mul_f32 v[128:129], v[128:129], v[22:23]
    v_pk_mul_f32 v[130:131], v[130:131], v[22:23]
    v_cvt_pk_bf16_f32 v190, v128, v129
    v_cvt_pk_bf16_f32 v191, v130, v131
    s_add_u32 s33, s81, 0
    s_nop 0
    v_permlane32_swap_b32 v188, v190
    v_permlane32_swap_b32 v189, v191
    buffer_store_dwordx4 v[188:191], v76, s[8:11], s33 offen sc1
    v_pk_mul_f32 v[132:133], v[132:133], v[22:23]
    v_pk_mul_f32 v[134:135], v[134:135], v[22:23]
    v_cvt_pk_bf16_f32 v192, v132, v133
    v_cvt_pk_bf16_f32 v193, v134, v135
    v_pk_mul_f32 v[136:137], v[136:137], v[22:23]
    v_pk_mul_f32 v[138:139], v[138:139], v[22:23]
    v_cvt_pk_bf16_f32 v194, v136, v137
    v_cvt_pk_bf16_f32 v195, v138, v139
    s_add_u32 s33, s81, 65536
    s_nop 0
    v_permlane32_swap_b32 v192, v194
    v_permlane32_swap_b32 v193, v195
    buffer_store_dwordx4 v[192:195], v76, s[8:11], s33 offen sc1
    v_pk_mul_f32 v[140:141], v[140:141], v[22:23]
    v_pk_mul_f32 v[142:143], v[142:143], v[22:23]
    v_cvt_pk_bf16_f32 v196, v140, v141
    v_cvt_pk_bf16_f32 v197, v142, v143
    v_pk_mul_f32 v[144:145], v[144:145], v[22:23]
    v_pk_mul_f32 v[146:147], v[146:147], v[22:23]
    v_cvt_pk_bf16_f32 v198, v144, v145
    v_cvt_pk_bf16_f32 v199, v146, v147
    s_add_u32 s33, s81, 131072
    s_nop 0
    v_permlane32_swap_b32 v196, v198
    v_permlane32_swap_b32 v197, v199
    buffer_store_dwordx4 v[196:199], v76, s[8:11], s33 offen sc1
    v_pk_mul_f32 v[148:149], v[148:149], v[22:23]
    v_pk_mul_f32 v[150:151], v[150:151], v[22:23]
    v_cvt_pk_bf16_f32 v200, v148, v149
    v_cvt_pk_bf16_f32 v201, v150, v151
    v_pk_mul_f32 v[152:153], v[152:153], v[22:23]
    v_pk_mul_f32 v[154:155], v[154:155], v[22:23]
    v_cvt_pk_bf16_f32 v202, v152, v153
    v_cvt_pk_bf16_f32 v203, v154, v155
    s_add_u32 s33, s81, 196608
    s_nop 0
    v_permlane32_swap_b32 v200, v202
    v_permlane32_swap_b32 v201, v203
    buffer_store_dwordx4 v[200:203], v76, s[8:11], s33 offen sc1
    v_pk_mul_f32 v[156:157], v[156:157], v[22:23]
    v_pk_mul_f32 v[158:159], v[158:159], v[22:23]
    v_cvt_pk_bf16_f32 v204, v156, v157
    v_cvt_pk_bf16_f32 v205, v158, v159
    v_pk_mul_f32 v[160:161], v[160:161], v[22:23]
    v_pk_mul_f32 v[162:163], v[162:163], v[22:23]
    v_cvt_pk_bf16_f32 v206, v160, v161
    v_cvt_pk_bf16_f32 v207, v162, v163
    s_add_u32 s33, s81, 512
    s_nop 0
    v_permlane32_swap_b32 v204, v206
    v_permlane32_swap_b32 v205, v207
    buffer_store_dwordx4 v[204:207], v76, s[8:11], s33 offen sc1
    v_pk_mul_f32 v[164:165], v[164:165], v[22:23]
    v_pk_mul_f32 v[166:167], v[166:167], v[22:23]
    v_cvt_pk_bf16_f32 v208, v164, v165
    v_cvt_pk_bf16_f32 v209, v166, v167
    v_pk_mul_f32 v[168:169], v[168:169], v[22:23]
    v_pk_mul_f32 v[170:171], v[170:171], v[22:23]
    v_cvt_pk_bf16_f32 v210, v168, v169
    v_cvt_pk_bf16_f32 v211, v170, v171
    s_add_u32 s33, s81, 66048
    s_nop 0
    v_permlane32_swap_b32 v208, v210
    v_permlane32_swap_b32 v209, v211
    buffer_store_dwordx4 v[208:211], v76, s[8:11], s33 offen sc1
    v_pk_mul_f32 v[172:173], v[172:173], v[22:23]
    v_pk_mul_f32 v[174:175], v[174:175], v[22:23]
    v_cvt_pk_bf16_f32 v212, v172, v173
    v_cvt_pk_bf16_f32 v213, v174, v175
    v_pk_mul_f32 v[176:177], v[176:177], v[22:23]
    v_pk_mul_f32 v[178:179], v[178:179], v[22:23]
    v_cvt_pk_bf16_f32 v214, v176, v177
    v_cvt_pk_bf16_f32 v215, v178, v179
    s_add_u32 s33, s81, 131584
    s_nop 0
    v_permlane32_swap_b32 v212, v214
    v_permlane32_swap_b32 v213, v215
    buffer_store_dwordx4 v[212:215], v76, s[8:11], s33 offen sc1
    v_pk_mul_f32 v[180:181], v[180:181], v[22:23]
    v_pk_mul_f32 v[182:183], v[182:183], v[22:23]
    v_cvt_pk_bf16_f32 v216, v180, v181
    v_cvt_pk_bf16_f32 v217, v182, v183
    v_pk_mul_f32 v[184:185], v[184:185], v[22:23]
    v_pk_mul_f32 v[186:187], v[186:187], v[22:23]
    v_cvt_pk_bf16_f32 v218, v184, v185
    v_cvt_pk_bf16_f32 v219, v186, v187
    s_add_u32 s33, s81, 197120
    s_nop 0
    v_permlane32_swap_b32 v216, v218
    v_permlane32_swap_b32 v217, v219
    buffer_store_dwordx4 v[216:219], v76, s[8:11], s33 offen sc1
    s_barrier
    s_add_u32 m0, s78, 131072
    s_add_u32 s32, s76, 512
    buffer_load_dwordx4 v242, s[60:63], s32 offen lds
    s_add_u32 m0, s78, 135168
    s_add_u32 s32, s76, 41472
    buffer_load_dwordx4 v242, s[60:63], s32 offen lds
    s_add_u32 m0, s78, 139264
    s_add_u32 s32, s76, 82432
    buffer_load_dwordx4 v242, s[60:63], s32 offen lds
    s_add_u32 m0, s78, 143360
    s_add_u32 s32, s76, 123392
    buffer_load_dwordx4 v242, s[60:63], s32 offen lds
    s_add_u32 m0, s78, 147456
    s_add_u32 s32, s77, 983040
    buffer_load_dwordx4 v243, s[68:71], s32 offen lds
    s_add_u32 m0, s78, 151552
    s_add_u32 s32, s77, 1044480
    buffer_load_dwordx4 v243, s[68:71], s32 offen lds
    s_add_u32 m0, s78, 155648
    s_add_u32 s32, s77, 1105920
    buffer_load_dwordx4 v243, s[68:71], s32 offen lds
    s_add_u32 m0, s78, 159744
    s_add_u32 s32, s77, 1167360
    buffer_load_dwordx4 v243, s[68:71], s32 offen lds
    s_barrier
    s_waitcnt vmcnt(0)
    s_add_u32 m0, s78, 0
    s_add_u32 s32, s76, 640
    buffer_load_dwordx4 v242, s[60:63], s32 offen lds
    s_add_u32 m0, s78, 4096
    s_add_u32 s32, s76, 41600
    buffer_load_dwordx4 v242, s[60:63], s32 offen lds
    s_add_u32 m0, s78, 8192
    s_add_u32 s32, s76, 82560
    buffer_load_dwordx4 v242, s[60:63], s32 offen lds
    s_add_u32 m0, s78, 12288
    s_add_u32 s32, s76, 123520
    buffer_load_dwordx4 v242, s[60:63], s32 offen lds
    s_add_u32 m0, s78, 16384
    s_add_u32 s32, s77, 1228800
    buffer_load_dwordx4 v243, s[68:71], s32 offen lds
    s_add_u32 m0, s78, 20480
    s_add_u32 s32, s77, 1290240
    buffer_load_dwordx4 v243, s[68:71], s32 offen lds
    s_add_u32 m0, s78, 24576
    s_add_u32 s32, s77, 1351680
    buffer_load_dwordx4 v243, s[68:71], s32 offen lds
    s_add_u32 m0, s78, 28672
    s_add_u32 s32, s77, 1413120
    buffer_load_dwordx4 v243, s[68:71], s32 offen lds
    s_barrier
    s_add_u32 m0, s78, 32768
    s_add_u32 s32, s76, 768
    buffer_load_dwordx4 v242, s[60:63], s32 offen lds
    s_add_u32 m0, s78, 36864
    s_add_u32 s32, s76, 41728
    buffer_load_dwordx4 v242, s[60:63], s32 offen lds
    s_add_u32 m0, s78, 40960
    s_add_u32 s32, s76, 82688
    buffer_load_dwordx4 v242, s[60:63], s32 offen lds
    s_add_u32 m0, s78, 45056
    s_add_u32 s32, s76, 123648
    buffer_load_dwordx4 v242, s[60:63], s32 offen lds
    s_add_u32 m0, s78, 49152
    s_add_u32 s32, s77, 1474560
    buffer_load_dwordx4 v243, s[68:71], s32 offen lds
    s_add_u32 m0, s78, 53248
    s_add_u32 s32, s77, 1536000
    buffer_load_dwordx4 v243, s[68:71], s32 offen lds
    s_add_u32 m0, s78, 57344
    s_add_u32 s32, s77, 1597440
    buffer_load_dwordx4 v243, s[68:71], s32 offen lds
    s_add_u32 m0, s78, 61440
    s_add_u32 s32, s77, 1658880
    buffer_load_dwordx4 v243, s[68:71], s32 offen lds
    s_cmp_lg_u32 s16, 0
    s_cbranch_scc1 L_w0_pubat
    v_mov_b32 v20, s17
    v_mov_b32 v21, 0
    s_add_u32 s32, s91, 22634496
    s_mov_b64 exec, 1
    buffer_store_dword v20, v21, s[8:11], s32 offen sc1
    s_mov_b64 exec, -1
L_w0_pubat:
    s_barrier
    s_add_u32 m0, s78, 65536
    s_add_u32 s32, s76, 896
    buffer_load_dwordx4 v242, s[60:63], s32 offen lds
    s_add_u32 m0, s78, 69632
    s_add_u32 s32, s76, 41856
    buffer_load_dwordx4 v242, s[60:63], s32 offen lds
    s_add_u32 m0, s78, 73728
    s_add_u32 s32, s76, 82816
    buffer_load_dwordx4 v242, s[60:63], s32 offen lds
    s_add_u32 m0, s78, 77824
    s_add_u32 s32, s76, 123776
    buffer_load_dwordx4 v242, s[60:63], s32 offen lds
    s_add_u32 m0, s78, 81920
    s_add_u32 s32, s77, 1720320
    buffer_load_dwordx4 v243, s[68:71], s32 offen lds
    s_add_u32 m0, s78, 86016
    s_add_u32 s32, s77, 1781760
    buffer_load_dwordx4 v243, s[68:71], s32 offen lds
    s_add_u32 m0, s78, 90112
    s_add_u32 s32, s77, 1843200
    buffer_load_dwordx4 v243, s[68:71], s32 offen lds
    s_add_u32 m0, s78, 94208
    s_add_u32 s32, s77, 1904640
    buffer_load_dwordx4 v243, s[68:71], s32 offen lds
    s_waitcnt vmcnt(16)
    s_barrier
    s_add_u32 m0, s78, 98304
    s_add_u32 s32, s76, 1024
    buffer_load_dwordx4 v242, s[60:63], s32 offen lds
    s_add_u32 m0, s78, 102400
    s_add_u32 s32, s76, 41984
    buffer_load_dwordx4 v242, s[60:63], s32 offen lds
    s_add_u32 m0, s78, 106496
    s_add_u32 s32, s76, 82944
    buffer_load_dwordx4 v242, s[60:63], s32 offen lds
    s_add_u32 m0, s78, 110592
    s_add_u32 s32, s76, 123904
    buffer_load_dwordx4 v242, s[60:63], s32 offen lds
    s_add_u32 m0, s78, 114688
    s_add_u32 s32, s77, 1966080
    buffer_load_dwordx4 v243, s[68:71], s32 offen lds
    s_add_u32 m0, s78, 118784
    s_add_u32 s32, s77, 2027520
    buffer_load_dwordx4 v243, s[68:71], s32 offen lds
    s_add_u32 m0, s78, 122880
    s_add_u32 s32, s77, 2088960
    buffer_load_dwordx4 v243, s[68:71], s32 offen lds
    s_add_u32 m0, s78, 126976
    s_add_u32 s32, s77, 2150400
    buffer_load_dwordx4 v243, s[68:71], s32 offen lds
    s_waitcnt vmcnt(16)
    s_barrier
    s_add_u32 m0, s78, 131072
    s_add_u32 s32, s76, 1152
    buffer_load_dwordx4 v242, s[60:63], s32 offen lds
    s_add_u32 m0, s78, 135168
    s_add_u32 s32, s76, 42112
    buffer_load_dwordx4 v242, s[60:63], s32 offen lds
    s_add_u32 m0, s78, 139264
    s_add_u32 s32, s76, 83072
    buffer_load_dwordx4 v242, s[60:63], s32 offen lds
    s_add_u32 m0, s78, 143360
    s_add_u32 s32, s76, 124032
    buffer_load_dwordx4 v242, s[60:63], s32 offen lds
    s_add_u32 m0, s78, 147456
    s_add_u32 s32, s77, 2211840
    buffer_load_dwordx4 v243, s[68:71], s32 offen lds
    s_add_u32 m0, s78, 151552
    s_add_u32 s32, s77, 2273280
    buffer_load_dwordx4 v243, s[68:71], s32 offen lds
    s_add_u32 m0, s78, 155648
    s_add_u32 s32, s77, 2334720
    buffer_load_dwordx4 v243, s[68:71], s32 offen lds
    s_add_u32 m0, s78, 159744
    s_add_u32 s32, s77, 2396160
    buffer_load_dwordx4 v243, s[68:71], s32 offen lds
    s_cmp_lg_u32 s16, 0
    s_cbranch_scc1 L_w0_f1t_i
    s_mov_b32 s32, 22634496
    buffer_load_dword v19, v232, s[8:11], s32 offen sc1
    s_mov_b32 s32, 22634496
    buffer_load_dword v235, v233, s[8:11], s32 offen sc1
L_w0_f1t_i:
    s_waitcnt vmcnt(16)
    s_barrier
    s_waitcnt vmcnt(8)
    s_barrier
    s_cmp_lg_u32 s16, 0
    s_cbranch_scc1 L_w0_f1t_c
    s_waitcnt vmcnt(0)
    v_cmp_eq_u32 vcc, s17, v19
    v_cmp_eq_u32 s[36:37], s17, v235
    s_nop 3
    s_and_b64 vcc, vcc, s[36:37]
    s_nop 3
    s_cmp_eq_u64 vcc, exec
    s_cbranch_scc1 L_f1t_ok
    s_mov_b32 s42, 0
L_f1t_spin:
    s_sleep 2
    s_mov_b32 s32, 22634496
    buffer_load_dword v19, v232, s[8:11], s32 offen sc1
    s_mov_b32 s32, 22634496
    buffer_load_dword v235, v233, s[8:11], s32 offen sc1
    s_add_u32 s42, s42, 1
    s_cmp_ge_u32 s42, 1048576
    s_cbranch_scc1 L_f1t_ok
    s_waitcnt vmcnt(0)
    v_cmp_eq_u32 vcc, s17, v19
    v_cmp_eq_u32 s[36:37], s17, v235
    s_nop 3
    s_and_b64 vcc, vcc, s[36:37]
    s_nop 3
    s_cmp_eq_u64 vcc, exec
    s_cbranch_scc0 L_f1t_spin
L_f1t_ok:
L_w0_f1t_c:
    s_waitcnt vmcnt(0)
    s_barrier
    s_add_u32 m0, s21, 0
    v_mad_u32_u24 v250, v247, 0, v244
    buffer_load_dwordx4 v250, s[8:11], 0 offen sc1 lds
    s_add_u32 m0, s21, 1024
    v_mad_u32_u24 v250, v248, 0, v245
    buffer_load_dwordx4 v250, s[8:11], 0 offen sc1 lds
    s_add_u32 m0, s21, 2048
    v_mad_u32_u24 v250, v249, 0, v246
    s_mov_b32 exec_hi, 0xffff
    buffer_load_dwordx4 v250, s[8:11], 0 offen sc1 lds
    s_mov_b32 exec_hi, -1
    buffer_load_dwordx4 v[100:103], v236, s[8:11], s88 offen sc1
    v_mov_b32 v104, 0
    v_mov_b32 v105, 0
    s_mov_b32 exec_hi, 0
    buffer_load_dwordx2 v[104:105], v237, s[8:11], s89 offen sc1
    s_mov_b32 exec_hi, -1
    s_add_u32 m0, s21, 22528
    v_mad_u32_u24 v250, v247, 1, v244
    buffer_load_dwordx4 v250, s[8:11], 0 offen sc1 lds
    s_add_u32 m0, s21, 23552
    v_mad_u32_u24 v250, v248, 1, v245
    buffer_load_dwordx4 v250, s[8:11], 0 offen sc1 lds
    s_add_u32 m0, s21, 24576
    v_mad_u32_u24 v250, v249, 1, v246
    s_mov_b32 exec_hi, 0xffff
    buffer_load_dwordx4 v250, s[8:11], 0 offen sc1 lds
    s_mov_b32 exec_hi, -1
    s_add_u32 m0, s21, 45056
    v_mad_u32_u24 v250, v247, 2, v244
    buffer_load_dwordx4 v250, s[8:11], 0 offen sc1 lds
    s_add_u32 m0, s21, 46080
    v_mad_u32_u24 v250, v248, 2, v245
    buffer_load_dwordx4 v250, s[8:11], 0 offen sc1 lds
    s_add_u32 m0, s21, 47104
    v_mad_u32_u24 v250, v249, 2, v246
    s_mov_b32 exec_hi, 0xffff
    buffer_load_dwordx4 v250, s[8:11], 0 offen sc1 lds
    s_mov_b32 exec_hi, -1
    v_and_b32 v20, 255, v0
    v_mul_u32_u24 v21, 3277, v20
    v_lshrrev_b32 v21, 16, v21
    v_mul_u32_u24 v21, 20, v21
    v_cmp_eq_u32 vcc, v21, v20
    v_mov_b32 v24, 0
    v_mov_b32 v25, 0x3f803f80
    v_cndmask_b32 v24, v24, v25, vcc
    v_mov_b32 v25, v24
    v_mov_b32 v26, v24
    v_mov_b32 v27, v24
    v_lshlrev_b32 v20, 4, v20
    v_add_u32 v20, 90112, v20
    ds_write_b128 v20, v[24:27]
    v_and_b32 v20, 255, v0
    v_add_u32 v20, 256, v20
    v_mul_u32_u24 v21, 3277, v20
    v_lshrrev_b32 v21, 16, v21
    v_mul_u32_u24 v21, 20, v21
    v_cmp_eq_u32 vcc, v21, v20
    v_mov_b32 v24, 0
    v_mov_b32 v25, 0x3f803f80
    v_cndmask_b32 v24, v24, v25, vcc
    v_mov_b32 v25, v24
    v_mov_b32 v26, v24
    v_mov_b32 v27, v24
    v_cmp_gt_u32 vcc, 336, v20
    v_lshlrev_b32 v20, 4, v20
    v_add_u32 v20, 90112, v20
    s_and_saveexec_b64 s[36:37], vcc
    s_cbranch_execz L_pat_donet
    ds_write_b128 v20, v[24:27]
L_pat_donet:
    s_mov_b64 exec, -1
    s_waitcnt lgkmcnt(0)
    s_waitcnt vmcnt(0)
    s_barrier
    s_branch L_attn
L_g1t:
    s_waitcnt vmcnt(16)
    s_barrier
    s_add_u32 m0, s78, 98304
    s_add_u32 s32, s76, 384
    buffer_load_dwordx4 v242, s[60:63], s32 offen lds
    s_add_u32 m0, s78, 102400
    s_add_u32 s32, s76, 41344
    buffer_load_dwordx4 v242, s[60:63], s32 offen lds
    s_add_u32 m0, s78, 106496
    s_add_u32 s32, s76, 82304
    buffer_load_dwordx4 v242, s[60:63], s32 offen lds
    s_add_u32 m0, s78, 110592
    s_add_u32 s32, s76, 123264
    buffer_load_dwordx4 v242, s[60:63], s32 offen lds
    s_add_u32 m0, s78, 114688
    s_add_u32 s32, s77, 737280
    buffer_load_dwordx4 v243, s[64:67], s32 offen lds
    s_add_u32 m0, s78, 118784
    s_add_u32 s32, s77, 798720
    buffer_load_dwordx4 v243, s[64:67], s32 offen lds
    s_add_u32 m0, s78, 122880
    s_add_u32 s32, s77, 860160
    buffer_load_dwordx4 v243, s[64:67], s32 offen lds
    s_add_u32 m0, s78, 126976
    s_add_u32 s32, s77, 921600
    buffer_load_dwordx4 v243, s[64:67], s32 offen lds
    v_lshrrev_b32 v22, 1, v2
    v_and_b32 v22, 7, v22
    v_xor_b32 v22, v22, v3
    v_lshlrev_b32 v22, 4, v22
    s_lshl_b32 s32, s74, 6
    v_add_u32 v23, s32, v2
    v_lshl_add_u32 v106, v23, 7, v22
    v_xor_b32 v109, 32, v106
    v_xor_b32 v112, 64, v106
    v_xor_b32 v115, 96, v106
    v_add_u32 v107, 0x10000, v106
    v_add_u32 v108, 0x20000, v106
    v_add_u32 v110, 0x10000, v109
    v_add_u32 v111, 0x20000, v109
    v_add_u32 v113, 0x10000, v112
    v_add_u32 v114, 0x20000, v112
    v_add_u32 v116, 0x10000, v115
    v_add_u32 v117, 0x20000, v115
    v_bfe_u32 v22, v1, 2, 2
    v_lshl_add_u32 v23, v3, 3, v22
    v_lshlrev_b32 v23, 8, v23
    v_bfe_u32 v24, v1, 4, 1
    v_lshlrev_b32 v24, 5, v24
    v_add_u32 v23, v23, v24
    v_and_b32 v24, 3, v1
    v_lshlrev_b32 v24, 3, v24
    v_add_u32 v23, v23, v24
    s_lshl_b32 s32, s75, 1
    s_add_u32 s32, s32, 0
    v_xor_b32 v24, s32, v22
    v_lshl_add_u32 v118, v24, 6, v23
    v_add_u32 v119, 0x10000, v118
    v_add_u32 v120, 0x20000, v118
    s_lshl_b32 s32, s75, 1
    s_add_u32 s32, s32, 1
    v_xor_b32 v24, s32, v22
    v_lshl_add_u32 v121, v24, 6, v23
    v_add_u32 v122, 0x10000, v121
    v_add_u32 v123, 0x20000, v121
    s_waitcnt vmcnt(16)
    s_barrier
    s_add_u32 m0, s78, 131072
    s_add_u32 s32, s76, 512
    buffer_load_dwordx4 v242, s[60:63], s32 offen lds
    s_add_u32 m0, s78, 135168
    s_add_u32 s32, s76, 41472
    buffer_load_dwordx4 v242, s[60:63], s32 offen lds
    s_add_u32 m0, s78, 139264
    s_add_u32 s32, s76, 82432
    buffer_load_dwordx4 v242, s[60:63], s32 offen lds
    s_add_u32 m0, s78, 143360
    s_add_u32 s32, s76, 123392
    buffer_load_dwordx4 v242, s[60:63], s32 offen lds
    s_add_u32 m0, s78, 147456
    s_add_u32 s32, s77, 983040
    buffer_load_dwordx4 v243, s[64:67], s32 offen lds
    s_add_u32 m0, s78, 151552
    s_add_u32 s32, s77, 1044480
    buffer_load_dwordx4 v243, s[64:67], s32 offen lds
    s_add_u32 m0, s78, 155648
    s_add_u32 s32, s77, 1105920
    buffer_load_dwordx4 v243, s[64:67], s32 offen lds
    s_add_u32 m0, s78, 159744
    s_add_u32 s32, s77, 1167360
    buffer_load_dwordx4 v243, s[64:67], s32 offen lds
    s_lshl_b32 s91, s73, 4
    s_add_u32 s91, s91, s72
    s_lshl_b32 s91, s91, 2
    s_and_b32 s32, s2, 7
    s_lshl_b32 s32, s32, 2
    s_lshr_b32 s33, s2, 3
    s_and_b32 s33, s33, 3
    s_add_u32 s18, s32, s33
    s_lshr_b32 s19, s2, 5
    s_lshr_b32 s32, s18, 1
    s_mul_i32 s32, s32, 5
    s_add_u32 s43, s32, 2
    s_and_b32 s33, s18, 1
    s_mul_i32 s33, s33, 3
    s_add_u32 s20, s32, s33
    s_mul_i32 s57, s18, 81920
    s_mul_i32 s21, s16, 2816
    s_mul_i32 s22, s16, 2560
    s_lshl_b32 s29, s19, 8
    s_lshl_b32 s32, s16, 5
    s_add_u32 s29, s29, s32
    s_lshl_b32 s31, s19, 2
    s_lshr_b32 s32, s16, 1
    s_add_u32 s31, s31, s32
    s_and_b32 s33, s16, 1
    s_lshl_b32 s30, s31, 6
    s_add_u32 s30, s30, s33
    s_mov_b32 s40, 0xfffff
    s_mov_b32 s41, 0xfffff
    v_lshlrev_b32 v236, 15, v3
    v_lshl_add_u32 v236, v2, 4, v236
    v_lshlrev_b32 v237, 4, v2
    v_lshlrev_b32 v238, 2, v2
    s_lshl_b32 s32, s29, 4
    s_lshl_b32 s88, s20, 15
    s_add_u32 s88, s88, s32
    s_lshl_b32 s89, s43, 15
    s_add_u32 s89, s89, s32
    s_and_b32 s33, s18, 1
    s_lshl_b32 s33, s33, 3
    s_add_u32 s89, s89, s33
    s_lshl_b32 s90, s29, 2
    s_add_u32 s90, s90, 22609920
    s_waitcnt vmcnt(16)
    s_barrier
    s_add_u32 m0, s78, 0
    s_add_u32 s32, s76, 640
    buffer_load_dwordx4 v242, s[60:63], s32 offen lds
    s_add_u32 m0, s78, 4096
    s_add_u32 s32, s76, 41600
    buffer_load_dwordx4 v242, s[60:63], s32 offen lds
    s_add_u32 m0, s78, 8192
    s_add_u32 s32, s76, 82560
    buffer_load_dwordx4 v242, s[60:63], s32 offen lds
    s_add_u32 m0, s78, 12288
    s_add_u32 s32, s76, 123520
    buffer_load_dwordx4 v242, s[60:63], s32 offen lds
    s_add_u32 m0, s78, 16384
    s_add_u32 s32, s77, 1228800
    buffer_load_dwordx4 v243, s[64:67], s32 offen lds
    s_add_u32 m0, s78, 20480
    s_add_u32 s32, s77, 1290240
    buffer_load_dwordx4 v243, s[64:67], s32 offen lds
    s_add_u32 m0, s78, 24576
    s_add_u32 s32, s77, 1351680
    buffer_load_dwordx4 v243, s[64:67], s32 offen lds
    s_add_u32 m0, s78, 28672
    s_add_u32 s32, s77, 1413120
    buffer_load_dwordx4 v243, s[64:67], s32 offen lds
    s_and_b32 s33, s18, 1
    s_lshl_b32 s33, s33, 3
    v_lshlrev_b32 v20, 12, v3
    v_lshl_add_u32 v20, v2, 4, v20
    v_lshlrev_b32 v21, 4, v2
    v_add_u32 v21, s33, v21
    v_mul_u32_u24 v22, 320, v3
    v_lshl_add_u32 v22, v2, 4, v22
    v_add_u32 v23, 90112, v22
    v_cmp_gt_u32 vcc, 20, v2
    v_add_u32 v4, 0, v20
    v_add_u32 v8, 0, v21
    v_add_u32 v24, 12288, v22
    v_cndmask_b32 v12, v23, v24, vcc
    v_add_u32 v5, 22528, v20
    v_add_u32 v9, 22528, v21
    v_add_u32 v24, 34816, v22
    v_cndmask_b32 v13, v23, v24, vcc
    v_add_u32 v6, 45056, v20
    v_add_u32 v10, 45056, v21
    v_add_u32 v24, 57344, v22
    v_cndmask_b32 v14, v23, v24, vcc
    v_add_u32 v7, 67584, v20
    v_add_u32 v11, 67584, v21
    v_add_u32 v24, 79872, v22
    v_cndmask_b32 v15, v23, v24, vcc
    s_lshl_b32 s34, s20, 15
    s_add_u32 s34, s34, 5242880
    s_lshl_b32 s35, s43, 15
    s_add_u32 s35, s35, 5234688
    s_add_u32 s36, s57, 10473472
    v_add_u32 v20, s21, v16
    v_lshrrev_b32 v21, 12, v20
    v_and_b32 v22, 4095, v20
    v_lshl_add_u32 v22, v21, 15, v22
    v_add_u32 v22, s34, v22
    v_add_u32 v23, s35, v20
    v_add_u32 v24, s36, v20
    v_cmp_eq_u32 vcc, 2, v21
    v_mov_b32 v25, 4096
    v_mov_b32 v26, 10240
    v_cndmask_b32 v22, v22, v23, vcc
    v_cmp_le_u32 vcc, 3, v21
    s_nop 1
    v_cndmask_b32 v244, v22, v24, vcc
    v_cndmask_b32 v247, v25, v26, vcc
    v_add_u32 v20, s21, v16
    v_add_u32 v20, 1024, v20
    v_lshrrev_b32 v21, 12, v20
    v_and_b32 v22, 4095, v20
    v_lshl_add_u32 v22, v21, 15, v22
    v_add_u32 v22, s34, v22
    v_add_u32 v23, s35, v20
    v_add_u32 v24, s36, v20
    v_cmp_eq_u32 vcc, 2, v21
    v_mov_b32 v25, 4096
    v_mov_b32 v26, 10240
    v_cndmask_b32 v22, v22, v23, vcc
    v_cmp_le_u32 vcc, 3, v21
    s_nop 1
    v_cndmask_b32 v245, v22, v24, vcc
    v_cndmask_b32 v248, v25, v26, vcc
    v_add_u32 v20, s21, v16
    v_add_u32 v20, 2048, v20
    v_lshrrev_b32 v21, 12, v20
    v_and_b32 v22, 4095, v20
    v_lshl_add_u32 v22, v21, 15, v22
    v_add_u32 v22, s34, v22
    v_add_u32 v23, s35, v20
    v_add_u32 v24, s36, v20
    v_cmp_eq_u32 vcc, 2, v21
    v_mov_b32 v25, 4096
    v_mov_b32 v26, 10240
    v_cndmask_b32 v22, v22, v23, vcc
    v_cmp_le_u32 vcc, 3, v21
    s_nop 1
    v_cndmask_b32 v246, v22, v24, vcc
    v_cndmask_b32 v249, v25, v26, vcc
    s_waitcnt vmcnt(16)
    s_barrier
    s_add_u32 m0, s78, 32768
    s_add_u32 s32, s76, 768
    buffer_load_dwordx4 v242, s[60:63], s32 offen lds
    s_add_u32 m0, s78, 36864
    s_add_u32 s32, s76, 41728
    buffer_load_dwordx4 v242, s[60:63], s32 offen lds
    s_add_u32 m0, s78, 40960
    s_add_u32 s32, s76, 82688
    buffer_load_dwordx4 v242, s[60:63], s32 offen lds
    s_add_u32 m0, s78, 45056
    s_add_u32 s32, s76, 123648
    buffer_load_dwordx4 v242, s[60:63], s32 offen lds
    s_add_u32 m0, s78, 49152
    s_add_u32 s32, s77, 1474560
    buffer_load_dwordx4 v243, s[64:67], s32 offen lds
    s_add_u32 m0, s78, 53248
    s_add_u32 s32, s77, 1536000
    buffer_load_dwordx4 v243, s[64:67], s32 offen lds
    s_add_u32 m0, s78, 57344
    s_add_u32 s32, s77, 1597440
    buffer_load_dwordx4 v243, s[64:67], s32 offen lds
    s_add_u32 m0, s78, 61440
    s_add_u32 s32, s77, 1658880
    buffer_load_dwordx4 v243, s[64:67], s32 offen lds
    s_lshr_b32 s32, s18, 1
    s_mul_i32 s32, s32, 5
    s_and_b32 s33, s18, 1
    s_lshl_b32 s34, s33, 1
    s_add_u32 s34, s34, s32
    v_add_u32 v20, s34, v3
    v_lshlrev_b32 v20, 15, v20
    v_lshl_add_u32 v252, v2, 4, v20
    v_lshl_add_u32 v253, v2, 5, v20
    s_add_u32 s32, s32, 4
    s_lshl_b32 s32, s32, 15
    s_lshl_b32 s33, s33, 3
    s_add_u32 s32, s32, s33
    v_lshlrev_b32 v20, 4, v2
    v_add_u32 v254, s32, v20
    v_lshlrev_b32 v20, 5, v2
    v_add_u32 v255, s32, v20
    s_mul_i32 s32, s18, 20
    s_add_u32 s33, s32, 19
    s_lshr_b32 s32, s32, 7
    s_lshr_b32 s33, s33, 7
    v_bfe_u32 v20, v1, 4, 1
    s_sub_u32 s34, s33, s32
    v_mul_u32_u24 v21, s34, v20
    v_add_u32 v21, s32, v21
    v_mul_u32_u24 v22, 5, v3
    v_add_u32 v22, 5, v22
    v_add_u32 v22, v22, v21
    v_and_b32 v23, 15, v1
    v_lshl_add_u32 v22, v22, 4, v23
    v_lshlrev_b32 v232, 2, v22
    v_add_u32 v22, 240, v23
    v_lshlrev_b32 v241, 2, v22
    v_and_b32 v24, 1, v1
    s_lshl_b32 s35, s19, 1
    v_add_u32 v24, s35, v24
    v_lshl_add_u32 v24, v21, 4, v24
    v_lshlrev_b32 v233, 2, v24
    v_and_b32 v20, 1, v1
    v_mul_u32_u24 v21, s34, v20
    v_add_u32 v21, s32, v21
    v_bfe_u32 v22, v1, 1, 2
    v_min_u32 v22, 2, v22
    v_mul_u32_u24 v22, 5, v22
    v_add_u32 v21, v21, v22
    s_lshl_b32 s35, s19, 1
    v_bfe_u32 v22, v1, 3, 2
    v_min_u32 v22, 2, v22
    v_add_u32 v22, s35, v22
    v_max_u32 v22, 1, v22
    v_subrev_u32 v22, 1, v22
    v_lshl_add_u32 v21, v21, 4, v22
    v_lshlrev_b32 v234, 2, v21
    s_waitcnt vmcnt(16)
    s_barrier
    s_add_u32 m0, s78, 65536
    s_add_u32 s32, s76, 896
    buffer_load_dwordx4 v242, s[60:63], s32 offen lds
    s_add_u32 m0, s78, 69632
    s_add_u32 s32, s76, 41856
    buffer_load_dwordx4 v242, s[60:63], s32 offen lds
    s_add_u32 m0, s78, 73728
    s_add_u32 s32, s76, 82816
    buffer_load_dwordx4 v242, s[60:63], s32 offen lds
    s_add_u32 m0, s78, 77824
    s_add_u32 s32, s76, 123776
    buffer_load_dwordx4 v242, s[60:63], s32 offen lds
    s_add_u32 m0, s78, 81920
    s_add_u32 s32, s77, 1720320
    buffer_load_dwordx4 v243, s[64:67], s32 offen lds
    s_add_u32 m0, s78, 86016
    s_add_u32 s32, s77, 1781760
    buffer_load_dwordx4 v243, s[64:67], s32 offen lds
    s_add_u32 m0, s78, 90112
    s_add_u32 s32, s77, 1843200
    buffer_load_dwordx4 v243, s[64:67], s32 offen lds
    s_add_u32 m0, s78, 94208
    s_add_u32 s32, s77, 1904640
    buffer_load_dwordx4 v243, s[64:67], s32 offen lds
    v_lshlrev_b32 v220, 15, v3
    v_lshl_add_u32 v220, v2, 4, v220
    v_lshlrev_b32 v221, 4, v2
    v_and_b32 v22, 25, v2
    v_bfe_u32 v23, v2, 1, 1
    v_lshl_or_b32 v22, v23, 2, v22
    v_bfe_u32 v23, v2, 2, 1
    v_lshl_or_b32 v22, v23, 1, v22
    v_lshlrev_b32 v23, 15, v3
    v_lshl_add_u32 v222, v22, 4, v23
    v_lshlrev_b32 v223, 4, v22
    v_mul_u32_u24 v24, 320, v3
    v_lshl_add_u32 v224, v2, 4, v24
    s_and_b32 s33, s16, 1
    s_lshl_b32 s33, s33, 10
    s_lshl_b32 s32, s31, 5
    s_add_u32 s34, s33, s32
    s_lshl_b32 s32, s20, 15
    s_lshl_b32 s33, s43, 15
    s_and_b32 s35, s18, 1
    s_lshl_b32 s35, s35, 3
    s_add_u32 s33, s33, s35
    s_lshl_b32 s35, s34, 4
    s_add_u32 s48, s35, s32
    s_add_u32 s48, s48, 2621440
    s_add_u32 s49, s35, s33
    s_add_u32 s49, s49, 2621440
    s_add_u32 s50, s35, s32
    s_add_u32 s50, s50, 7864320
    s_add_u32 s51, s35, s33
    s_add_u32 s51, s51, 7864320
    s_lshr_b32 s35, s34, 4
    s_mul_i32 s35, s35, 640
    s_add_u32 s52, s35, s57
    s_add_u32 s52, s52, 13107200
    s_cmp_eq_u32 s31, 0
    s_cselect_b32 s35, 0, 32
    s_sub_u32 s34, s34, s35
    s_lshl_b32 s35, s34, 4
    s_add_u32 s53, s35, s32
    s_add_u32 s53, s53, 7864320
    s_add_u32 s54, s35, s33
    s_add_u32 s54, s54, 7864320
    s_lshr_b32 s35, s34, 4
    s_mul_i32 s35, s35, 640
    s_add_u32 s55, s35, s57
    s_add_u32 s55, s55, 13107200
    s_lshl_b32 s56, s30, 2
    s_add_u32 s56, s56, 22609920
    s_waitcnt vmcnt(16)
    s_barrier
    s_add_u32 m0, s78, 98304
    s_add_u32 s32, s76, 1024
    buffer_load_dwordx4 v242, s[60:63], s32 offen lds
    s_add_u32 m0, s78, 102400
    s_add_u32 s32, s76, 41984
    buffer_load_dwordx4 v242, s[60:63], s32 offen lds
    s_add_u32 m0, s78, 106496
    s_add_u32 s32, s76, 82944
    buffer_load_dwordx4 v242, s[60:63], s32 offen lds
    s_add_u32 m0, s78, 110592
    s_add_u32 s32, s76, 123904
    buffer_load_dwordx4 v242, s[60:63], s32 offen lds
    s_add_u32 m0, s78, 114688
    s_add_u32 s32, s77, 1966080
    buffer_load_dwordx4 v243, s[64:67], s32 offen lds
    s_add_u32 m0, s78, 118784
    s_add_u32 s32, s77, 2027520
    buffer_load_dwordx4 v243, s[64:67], s32 offen lds
    s_add_u32 m0, s78, 122880
    s_add_u32 s32, s77, 2088960
    buffer_load_dwordx4 v243, s[64:67], s32 offen lds
    s_add_u32 m0, s78, 126976
    s_add_u32 s32, s77, 2150400
    buffer_load_dwordx4 v243, s[64:67], s32 offen lds
    s_lshr_b32 s33, s18, 3
    s_lshl_b32 s32, s19, 2
    s_add_u32 s33, s33, s32
    s_and_b32 s34, s18, 7
    s_and_b32 s35, s16, 3
    s_lshr_b32 s28, s16, 2
    s_lshl_b32 s25, s33, 8
    s_mul_i32 s23, s16, 20480
    s_mul_i32 s32, s34, 1280
    s_add_u32 s23, s23, s32
    s_add_u32 s23, s23, 20971520
    s_lshl_b32 s33, s33, 6
    s_lshl_b32 s35, s35, 4
    s_add_u32 s33, s33, s35
    s_mul_i32 s27, s33, 1280
    s_mul_i32 s32, s34, 160
    s_add_u32 s27, s27, s32
    s_lshl_b32 s24, s33, 4
    s_mul_i32 s32, s28, 1310720
    s_add_u32 s24, s24, s32
    s_add_u32 s24, s24, 15728640
    s_lshl_b32 s26, s31, 6
    s_lshl_b32 s32, s18, 1
    s_add_u32 s26, s26, s32
    s_and_b32 s32, s16, 1
    s_add_u32 s26, s26, s32
    s_lshl_b32 s26, s26, 2
    v_lshlrev_b32 v231, 2, v1
    v_mov_b32 v225, v16
    v_add_u32 v20, 1024, v16
    v_add_u32 v21, 9984, v16
    v_cmp_gt_u32 vcc, 16, v1
    v_add_u32 v227, 11008, v16
    v_lshrrev_b32 v22, 4, v1
    v_cndmask_b32 v226, v21, v20, vcc
    v_and_b32 v23, 15, v1
    v_lshlrev_b32 v24, 15, v22
    v_lshl_add_u32 v228, v23, 4, v24
    v_mul_u32_u24 v24, 1280, v22
    v_lshl_add_u32 v229, v23, 4, v24
    v_mul_u32_u24 v24, 1280, v23
    v_lshl_add_u32 v230, v22, 3, v24
    s_waitcnt vmcnt(16)
    s_barrier
    s_add_u32 m0, s78, 131072
    s_add_u32 s32, s76, 1152
    buffer_load_dwordx4 v242, s[60:63], s32 offen lds
    s_add_u32 m0, s78, 135168
    s_add_u32 s32, s76, 42112
    buffer_load_dwordx4 v242, s[60:63], s32 offen lds
    s_add_u32 m0, s78, 139264
    s_add_u32 s32, s76, 83072
    buffer_load_dwordx4 v242, s[60:63], s32 offen lds
    s_add_u32 m0, s78, 143360
    s_add_u32 s32, s76, 124032
    buffer_load_dwordx4 v242, s[60:63], s32 offen lds
    s_add_u32 m0, s78, 147456
    s_add_u32 s32, s77, 2211840
    buffer_load_dwordx4 v243, s[64:67], s32 offen lds
    s_add_u32 m0, s78, 151552
    s_add_u32 s32, s77, 2273280
    buffer_load_dwordx4 v243, s[64:67], s32 offen lds
    s_add_u32 m0, s78, 155648
    s_add_u32 s32, s77, 2334720
    buffer_load_dwordx4 v243, s[64:67], s32 offen lds
    s_add_u32 m0, s78, 159744
    s_add_u32 s32, s77, 2396160
    buffer_load_dwordx4 v243, s[64:67], s32 offen lds
    s_waitcnt vmcnt(16)
    s_barrier
    s_add_u32 m0, s78, 0
    s_add_u32 s32, s76, 0
    buffer_load_dwordx4 v242, s[60:63], s32 offen lds
    s_add_u32 m0, s78, 4096
    s_add_u32 s32, s76, 40960
    buffer_load_dwordx4 v242, s[60:63], s32 offen lds
    s_add_u32 m0, s78, 8192
    s_add_u32 s32, s76, 81920
    buffer_load_dwordx4 v242, s[60:63], s32 offen lds
    s_add_u32 m0, s78, 12288
    s_add_u32 s32, s76, 122880
    buffer_load_dwordx4 v242, s[60:63], s32 offen lds
    s_add_u32 m0, s78, 16384
    s_add_u32 s32, s77, 0
    buffer_load_dwordx4 v243, s[68:71], s32 offen lds
    s_add_u32 m0, s78, 20480
    s_add_u32 s32, s77, 61440
    buffer_load_dwordx4 v243, s[68:71], s32 offen lds
    s_add_u32 m0, s78, 24576
    s_add_u32 s32, s77, 122880
    buffer_load_dwordx4 v243, s[68:71], s32 offen lds
    s_add_u32 m0, s78, 28672
    s_add_u32 s32, s77, 184320
    buffer_load_dwordx4 v243, s[68:71], s32 offen lds
    s_waitcnt vmcnt(16)
    s_barrier
    s_add_u32 m0, s78, 32768
    s_add_u32 s32, s76, 128
    buffer_load_dwordx4 v242, s[60:63], s32 offen lds
    s_add_u32 m0, s78, 36864
    s_add_u32 s32, s76, 41088
    buffer_load_dwordx4 v242, s[60:63], s32 offen lds
    s_add_u32 m0, s78, 40960
    s_add_u32 s32, s76, 82048
    buffer_load_dwordx4 v242, s[60:63], s32 offen lds
    s_add_u32 m0, s78, 45056
    s_add_u32 s32, s76, 123008
    buffer_load_dwordx4 v242, s[60:63], s32 offen lds
    s_add_u32 m0, s78, 49152
    s_add_u32 s32, s77, 245760
    buffer_load_dwordx4 v243, s[68:71], s32 offen lds
    s_add_u32 m0, s78, 53248
    s_add_u32 s32, s77, 307200
    buffer_load_dwordx4 v243, s[68:71], s32 offen lds
    s_add_u32 m0, s78, 57344
    s_add_u32 s32, s77, 368640
    buffer_load_dwordx4 v243, s[68:71], s32 offen lds
    s_add_u32 m0, s78, 61440
    s_add_u32 s32, s77, 430080
    buffer_load_dwordx4 v243, s[68:71], s32 offen lds
    s_waitcnt vmcnt(16)
    s_barrier
    s_add_u32 m0, s78, 65536
    s_add_u32 s32, s76, 256
    buffer_load_dwordx4 v242, s[60:63], s32 offen lds
    s_add_u32 m0, s78, 69632
    s_add_u32 s32, s76, 41216
    buffer_load_dwordx4 v242, s[60:63], s32 offen lds
    s_add_u32 m0, s78, 73728
    s_add_u32 s32, s76, 82176
    buffer_load_dwordx4 v242, s[60:63], s32 offen lds
    s_add_u32 m0, s78, 77824
    s_add_u32 s32, s76, 123136
    buffer_load_dwordx4 v242, s[60:63], s32 offen lds
    s_add_u32 m0, s78, 81920
    s_add_u32 s32, s77, 491520
    buffer_load_dwordx4 v243, s[68:71], s32 offen lds
    s_add_u32 m0, s78, 86016
    s_add_u32 s32, s77, 552960
    buffer_load_dwordx4 v243, s[68:71], s32 offen lds
    s_add_u32 m0, s78, 90112
    s_add_u32 s32, s77, 614400
    buffer_load_dwordx4 v243, s[68:71], s32 offen lds
    s_add_u32 m0, s78, 94208
    s_add_u32 s32, s77, 675840
    buffer_load_dwordx4 v243, s[68:71], s32 offen lds
    s_waitcnt vmcnt(16)
    s_barrier
    s_setprio 1
    ds_read_b128 v[44:47], v106 offset:0
    ds_read_b128 v[48:51], v106 offset:4096
    ds_read_b64_tr_b16 v[52:53], v118 offset:16384
    ds_read_b64_tr_b16 v[54:55], v118 offset:17408
    ds_read_b64_tr_b16 v[56:57], v121 offset:16384
    ds_read_b64_tr_b16 v[58:59], v121 offset:17408
    ds_read_b128 v[60:63], v109 offset:0
    ds_read_b128 v[64:67], v109 offset:4096
    ds_read_b64_tr_b16 v[68:69], v118 offset:20480
    ds_read_b64_tr_b16 v[70:71], v118 offset:21504
    ds_read_b64_tr_b16 v[72:73], v121 offset:20480
    ds_read_b64_tr_b16 v[74:75], v121 offset:21504
    s_waitcnt lgkmcnt(6)
    v_mfma_f32_32x32x16_bf16 v[124:139], v[52:55], v[44:47], 0
    ds_read_b128 v[28:31], v112 offset:0
    ds_read_b128 v[32:35], v112 offset:4096
    v_mfma_f32_32x32x16_bf16 v[140:155], v[56:59], v[44:47], 0
    ds_read_b64_tr_b16 v[36:37], v118 offset:24576
    ds_read_b64_tr_b16 v[38:39], v118 offset:25600
    v_mfma_f32_32x32x16_bf16 v[156:171], v[52:55], v[48:51], 0
    ds_read_b64_tr_b16 v[40:41], v121 offset:24576
    ds_read_b64_tr_b16 v[42:43], v121 offset:25600
    v_mfma_f32_32x32x16_bf16 v[172:187], v[56:59], v[48:51], 0
    s_waitcnt lgkmcnt(6)
    v_mfma_f32_32x32x16_bf16 v[124:139], v[68:71], v[60:63], v[124:139]
    ds_read_b128 v[44:47], v115 offset:0
    ds_read_b128 v[48:51], v115 offset:4096
    v_mfma_f32_32x32x16_bf16 v[140:155], v[72:75], v[60:63], v[140:155]
    ds_read_b64_tr_b16 v[52:53], v118 offset:28672
    ds_read_b64_tr_b16 v[54:55], v118 offset:29696
    v_mfma_f32_32x32x16_bf16 v[156:171], v[68:71], v[64:67], v[156:171]
    ds_read_b64_tr_b16 v[56:57], v121 offset:28672
    ds_read_b64_tr_b16 v[58:59], v121 offset:29696
    v_mfma_f32_32x32x16_bf16 v[172:187], v[72:75], v[64:67], v[172:187]
    s_waitcnt vmcnt(8)
    s_barrier
    s_waitcnt lgkmcnt(6)
    v_mfma_f32_32x32x16_bf16 v[124:139], v[36:39], v[28:31], v[124:139]
    ds_read_b128 v[60:63], v106 offset:32768
    ds_read_b128 v[64:67], v106 offset:36864
    v_mfma_f32_32x32x16_bf16 v[140:155], v[40:43], v[28:31], v[140:155]
    ds_read_b64_tr_b16 v[68:69], v118 offset:49152
    ds_read_b64_tr_b16 v[70:71], v118 offset:50176
    v_mfma_f32_32x32x16_bf16 v[156:171], v[36:39], v[32:35], v[156:171]
    ds_read_b64_tr_b16 v[72:73], v121 offset:49152
    ds_read_b64_tr_b16 v[74:75], v121 offset:50176
    v_mfma_f32_32x32x16_bf16 v[172:187], v[40:43], v[32:35], v[172:187]
    s_waitcnt lgkmcnt(6)
    v_mfma_f32_32x32x16_bf16 v[124:139], v[52:55], v[44:47], v[124:139]
    ds_read_b128 v[28:31], v109 offset:32768
    ds_read_b128 v[32:35], v109 offset:36864
    v_mfma_f32_32x32x16_bf16 v[140:155], v[56:59], v[44:47], v[140:155]
    ds_read_b64_tr_b16 v[36:37], v118 offset:53248
    ds_read_b64_tr_b16 v[38:39], v118 offset:54272
    v_mfma_f32_32x32x16_bf16 v[156:171], v[52:55], v[48:51], v[156:171]
    ds_read_b64_tr_b16 v[40:41], v121 offset:53248
    ds_read_b64_tr_b16 v[42:43], v121 offset:54272
    v_mfma_f32_32x32x16_bf16 v[172:187], v[56:59], v[48:51], v[172:187]
    s_waitcnt lgkmcnt(6)
    v_mfma_f32_32x32x16_bf16 v[124:139], v[68:71], v[60:63], v[124:139]
    ds_read_b128 v[44:47], v112 offset:32768
    ds_read_b128 v[48:51], v112 offset:36864
    v_mfma_f32_32x32x16_bf16 v[140:155], v[72:75], v[60:63], v[140:155]
    ds_read_b64_tr_b16 v[52:53], v118 offset:57344
    ds_read_b64_tr_b16 v[54:55], v118 offset:58368
    v_mfma_f32_32x32x16_bf16 v[156:171], v[68:71], v[64:67], v[156:171]
    ds_read_b64_tr_b16 v[56:57], v121 offset:57344
    ds_read_b64_tr_b16 v[58:59], v121 offset:58368
    v_mfma_f32_32x32x16_bf16 v[172:187], v[72:75], v[64:67], v[172:187]
    s_waitcnt lgkmcnt(6)
    v_mfma_f32_32x32x16_bf16 v[124:139], v[36:39], v[28:31], v[124:139]
    ds_read_b128 v[60:63], v115 offset:32768
    ds_read_b128 v[64:67], v115 offset:36864
    v_mfma_f32_32x32x16_bf16 v[140:155], v[40:43], v[28:31], v[140:155]
    ds_read_b64_tr_b16 v[68:69], v118 offset:61440
    ds_read_b64_tr_b16 v[70:71], v118 offset:62464
    v_mfma_f32_32x32x16_bf16 v[156:171], v[36:39], v[32:35], v[156:171]
    ds_read_b64_tr_b16 v[72:73], v121 offset:61440
    ds_read_b64_tr_b16 v[74:75], v121 offset:62464
    v_mfma_f32_32x32x16_bf16 v[172:187], v[40:43], v[32:35], v[172:187]
    s_waitcnt vmcnt(0)
    s_barrier
    s_waitcnt lgkmcnt(6)
    v_mfma_f32_32x32x16_bf16 v[124:139], v[52:55], v[44:47], v[124:139]
    ds_read_b128 v[28:31], v107 offset:0
    ds_read_b128 v[32:35], v107 offset:4096
    v_mfma_f32_32x32x16_bf16 v[140:155], v[56:59], v[44:47], v[140:155]
    ds_read_b64_tr_b16 v[36:37], v119 offset:16384
    ds_read_b64_tr_b16 v[38:39], v119 offset:17408
    v_mfma_f32_32x32x16_bf16 v[156:171], v[52:55], v[48:51], v[156:171]
    ds_read_b64_tr_b16 v[40:41], v122 offset:16384
    ds_read_b64_tr_b16 v[42:43], v122 offset:17408
    v_mfma_f32_32x32x16_bf16 v[172:187], v[56:59], v[48:51], v[172:187]
    s_waitcnt lgkmcnt(6)
    v_mfma_f32_32x32x16_bf16 v[124:139], v[68:71], v[60:63], v[124:139]
    ds_read_b128 v[44:47], v110 offset:0
    ds_read_b128 v[48:51], v110 offset:4096
    v_mfma_f32_32x32x16_bf16 v[140:155], v[72:75], v[60:63], v[140:155]
    ds_read_b64_tr_b16 v[52:53], v119 offset:20480
    ds_read_b64_tr_b16 v[54:55], v119 offset:21504
    v_mfma_f32_32x32x16_bf16 v[156:171], v[68:71], v[64:67], v[156:171]
    ds_read_b64_tr_b16 v[56:57], v122 offset:20480
    ds_read_b64_tr_b16 v[58:59], v122 offset:21504
    v_mfma_f32_32x32x16_bf16 v[172:187], v[72:75], v[64:67], v[172:187]
    s_waitcnt lgkmcnt(6)
    v_mfma_f32_32x32x16_bf16 v[124:139], v[36:39], v[28:31], v[124:139]
    ds_read_b128 v[60:63], v113 offset:0
    ds_read_b128 v[64:67], v113 offset:4096
    v_mfma_f32_32x32x16_bf16 v[140:155], v[40:43], v[28:31], v[140:155]
    ds_read_b64_tr_b16 v[68:69], v119 offset:24576
    ds_read_b64_tr_b16 v[70:71], v119 offset:25600
    v_mfma_f32_32x32x16_bf16 v[156:171], v[36:39], v[32:35], v[156:171]
    ds_read_b64_tr_b16 v[72:73], v122 offset:24576
    ds_read_b64_tr_b16 v[74:75], v122 offset:25600
    v_mfma_f32_32x32x16_bf16 v[172:187], v[40:43], v[32:35], v[172:187]
    s_waitcnt lgkmcnt(6)
    v_mfma_f32_32x32x16_bf16 v[124:139], v[52:55], v[44:47], v[124:139]
    ds_read_b128 v[28:31], v116 offset:0
    ds_read_b128 v[32:35], v116 offset:4096
    v_mfma_f32_32x32x16_bf16 v[140:155], v[56:59], v[44:47], v[140:155]
    ds_read_b64_tr_b16 v[36:37], v119 offset:28672
    ds_read_b64_tr_b16 v[38:39], v119 offset:29696
    v_mfma_f32_32x32x16_bf16 v[156:171], v[52:55], v[48:51], v[156:171]
    ds_read_b64_tr_b16 v[40:41], v122 offset:28672
    ds_read_b64_tr_b16 v[42:43], v122 offset:29696
    v_mfma_f32_32x32x16_bf16 v[172:187], v[56:59], v[48:51], v[172:187]
    s_barrier
    s_waitcnt lgkmcnt(6)
    v_mfma_f32_32x32x16_bf16 v[124:139], v[68:71], v[60:63], v[124:139]
    ds_read_b128 v[44:47], v107 offset:32768
    ds_read_b128 v[48:51], v107 offset:36864
    v_mfma_f32_32x32x16_bf16 v[140:155], v[72:75], v[60:63], v[140:155]
    ds_read_b64_tr_b16 v[52:53], v119 offset:49152
    ds_read_b64_tr_b16 v[54:55], v119 offset:50176
    v_mfma_f32_32x32x16_bf16 v[156:171], v[68:71], v[64:67], v[156:171]
    ds_read_b64_tr_b16 v[56:57], v122 offset:49152
    ds_read_b64_tr_b16 v[58:59], v122 offset:50176
    v_mfma_f32_32x32x16_bf16 v[172:187], v[72:75], v[64:67], v[172:187]
    s_waitcnt lgkmcnt(6)
    v_mfma_f32_32x32x16_bf16 v[124:139], v[36:39], v[28:31], v[124:139]
    ds_read_b128 v[60:63], v110 offset:32768
    ds_read_b128 v[64:67], v110 offset:36864
    v_mfma_f32_32x32x16_bf16 v[140:155], v[40:43], v[28:31], v[140:155]
    ds_read_b64_tr_b16 v[68:69], v119 offset:53248
    ds_read_b64_tr_b16 v[70:71], v119 offset:54272
    v_mfma_f32_32x32x16_bf16 v[156:171], v[36:39], v[32:35], v[156:171]
    ds_read_b64_tr_b16 v[72:73], v122 offset:53248
    ds_read_b64_tr_b16 v[74:75], v122 offset:54272
    v_mfma_f32_32x32x16_bf16 v[172:187], v[40:43], v[32:35], v[172:187]
    s_waitcnt lgkmcnt(6)
    v_mfma_f32_32x32x16_bf16 v[124:139], v[52:55], v[44:47], v[124:139]
    ds_read_b128 v[28:31], v113 offset:32768
    ds_read_b128 v[32:35], v113 offset:36864
    v_mfma_f32_32x32x16_bf16 v[140:155], v[56:59], v[44:47], v[140:155]
    ds_read_b64_tr_b16 v[36:37], v119 offset:57344
    ds_read_b64_tr_b16 v[38:39], v119 offset:58368
    v_mfma_f32_32x32x16_bf16 v[156:171], v[52:55], v[48:51], v[156:171]
    ds_read_b64_tr_b16 v[40:41], v122 offset:57344
    ds_read_b64_tr_b16 v[42:43], v122 offset:58368
    v_mfma_f32_32x32x16_bf16 v[172:187], v[56:59], v[48:51], v[172:187]
    s_waitcnt lgkmcnt(6)
    v_mfma_f32_32x32x16_bf16 v[124:139], v[68:71], v[60:63], v[124:139]
    ds_read_b128 v[44:47], v116 offset:32768
    ds_read_b128 v[48:51], v116 offset:36864
    v_mfma_f32_32x32x16_bf16 v[140:155], v[72:75], v[60:63], v[140:155]
    ds_read_b64_tr_b16 v[52:53], v119 offset:61440
    ds_read_b64_tr_b16 v[54:55], v119 offset:62464
    v_mfma_f32_32x32x16_bf16 v[156:171], v[68:71], v[64:67], v[156:171]
    ds_read_b64_tr_b16 v[56:57], v122 offset:61440
    ds_read_b64_tr_b16 v[58:59], v122 offset:62464
    v_mfma_f32_32x32x16_bf16 v[172:187], v[72:75], v[64:67], v[172:187]
    s_barrier
    s_waitcnt lgkmcnt(6)
    v_mfma_f32_32x32x16_bf16 v[124:139], v[36:39], v[28:31], v[124:139]
    ds_read_b128 v[60:63], v108 offset:0
    ds_read_b128 v[64:67], v108 offset:4096
    v_mfma_f32_32x32x16_bf16 v[140:155], v[40:43], v[28:31], v[140:155]
    ds_read_b64_tr_b16 v[68:69], v120 offset:16384
    ds_read_b64_tr_b16 v[70:71], v120 offset:17408
    v_mfma_f32_32x32x16_bf16 v[156:171], v[36:39], v[32:35], v[156:171]
    ds_read_b64_tr_b16 v[72:73], v123 offset:16384
    ds_read_b64_tr_b16 v[74:75], v123 offset:17408
    v_mfma_f32_32x32x16_bf16 v[172:187], v[40:43], v[32:35], v[172:187]
    s_waitcnt lgkmcnt(6)
    v_mfma_f32_32x32x16_bf16 v[124:139], v[52:55], v[44:47], v[124:139]
    ds_read_b128 v[28:31], v111 offset:0
    ds_read_b128 v[32:35], v111 offset:4096
    v_mfma_f32_32x32x16_bf16 v[140:155], v[56:59], v[44:47], v[140:155]
    ds_read_b64_tr_b16 v[36:37], v120 offset:20480
    ds_read_b64_tr_b16 v[38:39], v120 offset:21504
    v_mfma_f32_32x32x16_bf16 v[156:171], v[52:55], v[48:51], v[156:171]
    ds_read_b64_tr_b16 v[40:41], v123 offset:20480
    ds_read_b64_tr_b16 v[42:43], v123 offset:21504
    v_mfma_f32_32x32x16_bf16 v[172:187], v[56:59], v[48:51], v[172:187]
    s_waitcnt lgkmcnt(6)
    v_mfma_f32_32x32x16_bf16 v[124:139], v[68:71], v[60:63], v[124:139]
    ds_read_b128 v[44:47], v114 offset:0
    ds_read_b128 v[48:51], v114 offset:4096
    v_mfma_f32_32x32x16_bf16 v[140:155], v[72:75], v[60:63], v[140:155]
    ds_read_b64_tr_b16 v[52:53], v120 offset:24576
    ds_read_b64_tr_b16 v[54:55], v120 offset:25600
    v_mfma_f32_32x32x16_bf16 v[156:171], v[68:71], v[64:67], v[156:171]
    ds_read_b64_tr_b16 v[56:57], v123 offset:24576
    ds_read_b64_tr_b16 v[58:59], v123 offset:25600
    v_mfma_f32_32x32x16_bf16 v[172:187], v[72:75], v[64:67], v[172:187]
    s_waitcnt lgkmcnt(6)
    v_mfma_f32_32x32x16_bf16 v[124:139], v[36:39], v[28:31], v[124:139]
    ds_read_b128 v[60:63], v117 offset:0
    ds_read_b128 v[64:67], v117 offset:4096
    v_mfma_f32_32x32x16_bf16 v[140:155], v[40:43], v[28:31], v[140:155]
    ds_read_b64_tr_b16 v[68:69], v120 offset:28672
    ds_read_b64_tr_b16 v[70:71], v120 offset:29696
    v_mfma_f32_32x32x16_bf16 v[156:171], v[36:39], v[32:35], v[156:171]
    ds_read_b64_tr_b16 v[72:73], v123 offset:28672
    ds_read_b64_tr_b16 v[74:75], v123 offset:29696
    v_mfma_f32_32x32x16_bf16 v[172:187], v[40:43], v[32:35], v[172:187]
    s_barrier
    s_waitcnt lgkmcnt(6)
    v_mfma_f32_32x32x16_bf16 v[124:139], v[52:55], v[44:47], v[124:139]
    ds_read_b128 v[28:31], v106 offset:0
    ds_read_b128 v[32:35], v106 offset:4096
    v_mfma_f32_32x32x16_bf16 v[140:155], v[56:59], v[44:47], v[140:155]
    ds_read_b64_tr_b16 v[36:37], v118 offset:16384
    ds_read_b64_tr_b16 v[38:39], v118 offset:17408
    v_mfma_f32_32x32x16_bf16 v[156:171], v[52:55], v[48:51], v[156:171]
    ds_read_b64_tr_b16 v[40:41], v121 offset:16384
    ds_read_b64_tr_b16 v[42:43], v121 offset:17408
    v_mfma_f32_32x32x16_bf16 v[172:187], v[56:59], v[48:51], v[172:187]
    s_waitcnt lgkmcnt(6)
    v_mfma_f32_32x32x16_bf16 v[124:139], v[68:71], v[60:63], v[124:139]
    ds_read_b128 v[44:47], v109 offset:0
    ds_read_b128 v[48:51], v109 offset:4096
    v_mfma_f32_32x32x16_bf16 v[140:155], v[72:75], v[60:63], v[140:155]
    ds_read_b64_tr_b16 v[52:53], v118 offset:20480
    ds_read_b64_tr_b16 v[54:55], v118 offset:21504
    v_mfma_f32_32x32x16_bf16 v[156:171], v[68:71], v[64:67], v[156:171]
    ds_read_b64_tr_b16 v[56:57], v121 offset:20480
    ds_read_b64_tr_b16 v[58:59], v121 offset:21504
    v_mfma_f32_32x32x16_bf16 v[172:187], v[72:75], v[64:67], v[172:187]
    s_waitcnt lgkmcnt(6)
    v_mfma_f32_32x32x16_bf16 v[124:139], v[36:39], v[28:31], v[124:139]
    ds_read_b128 v[60:63], v112 offset:0
    ds_read_b128 v[64:67], v112 offset:4096
    v_mfma_f32_32x32x16_bf16 v[140:155], v[40:43], v[28:31], v[140:155]
    ds_read_b64_tr_b16 v[68:69], v118 offset:24576
    ds_read_b64_tr_b16 v[70:71], v118 offset:25600
    v_mfma_f32_32x32x16_bf16 v[156:171], v[36:39], v[32:35], v[156:171]
    ds_read_b64_tr_b16 v[72:73], v121 offset:24576
    ds_read_b64_tr_b16 v[74:75], v121 offset:25600
    v_mfma_f32_32x32x16_bf16 v[172:187], v[40:43], v[32:35], v[172:187]
    s_waitcnt lgkmcnt(6)
    v_mfma_f32_32x32x16_bf16 v[124:139], v[52:55], v[44:47], v[124:139]
    ds_read_b128 v[28:31], v115 offset:0
    ds_read_b128 v[32:35], v115 offset:4096
    v_mfma_f32_32x32x16_bf16 v[140:155], v[56:59], v[44:47], v[140:155]
    ds_read_b64_tr_b16 v[36:37], v118 offset:28672
    ds_read_b64_tr_b16 v[38:39], v118 offset:29696
    v_mfma_f32_32x32x16_bf16 v[156:171], v[52:55], v[48:51], v[156:171]
    ds_read_b64_tr_b16 v[40:41], v121 offset:28672
    ds_read_b64_tr_b16 v[42:43], v121 offset:29696
    v_mfma_f32_32x32x16_bf16 v[172:187], v[56:59], v[48:51], v[172:187]
    s_barrier
    s_waitcnt lgkmcnt(6)
    v_mfma_f32_32x32x16_bf16 v[124:139], v[68:71], v[60:63], v[124:139]
    ds_read_b128 v[44:47], v106 offset:32768
    ds_read_b128 v[48:51], v106 offset:36864
    v_mfma_f32_32x32x16_bf16 v[140:155], v[72:75], v[60:63], v[140:155]
    ds_read_b64_tr_b16 v[52:53], v118 offset:49152
    ds_read_b64_tr_b16 v[54:55], v118 offset:50176
    v_mfma_f32_32x32x16_bf16 v[156:171], v[68:71], v[64:67], v[156:171]
    ds_read_b64_tr_b16 v[56:57], v121 offset:49152
    ds_read_b64_tr_b16 v[58:59], v121 offset:50176
    v_mfma_f32_32x32x16_bf16 v[172:187], v[72:75], v[64:67], v[172:187]
    s_waitcnt lgkmcnt(6)
    v_mfma_f32_32x32x16_bf16 v[124:139], v[36:39], v[28:31], v[124:139]
    ds_read_b128 v[60:63], v109 offset:32768
    ds_read_b128 v[64:67], v109 offset:36864
    v_mfma_f32_32x32x16_bf16 v[140:155], v[40:43], v[28:31], v[140:155]
    ds_read_b64_tr_b16 v[68:69], v118 offset:53248
    ds_read_b64_tr_b16 v[70:71], v118 offset:54272
    v_mfma_f32_32x32x16_bf16 v[156:171], v[36:39], v[32:35], v[156:171]
    ds_read_b64_tr_b16 v[72:73], v121 offset:53248
    ds_read_b64_tr_b16 v[74:75], v121 offset:54272
    v_mfma_f32_32x32x16_bf16 v[172:187], v[40:43], v[32:35], v[172:187]
    s_waitcnt lgkmcnt(6)
    v_mfma_f32_32x32x16_bf16 v[124:139], v[52:55], v[44:47], v[124:139]
    ds_read_b128 v[28:31], v112 offset:32768
    ds_read_b128 v[32:35], v112 offset:36864
    v_mfma_f32_32x32x16_bf16 v[140:155], v[56:59], v[44:47], v[140:155]
    ds_read_b64_tr_b16 v[36:37], v118 offset:57344
    ds_read_b64_tr_b16 v[38:39], v118 offset:58368
    v_mfma_f32_32x32x16_bf16 v[156:171], v[52:55], v[48:51], v[156:171]
    ds_read_b64_tr_b16 v[40:41], v121 offset:57344
    ds_read_b64_tr_b16 v[42:43], v121 offset:58368
    v_mfma_f32_32x32x16_bf16 v[172:187], v[56:59], v[48:51], v[172:187]
    s_waitcnt lgkmcnt(6)
    v_mfma_f32_32x32x16_bf16 v[124:139], v[68:71], v[60:63], v[124:139]
    ds_read_b128 v[44:47], v115 offset:32768
    ds_read_b128 v[48:51], v115 offset:36864
    v_mfma_f32_32x32x16_bf16 v[140:155], v[72:75], v[60:63], v[140:155]
    ds_read_b64_tr_b16 v[52:53], v118 offset:61440
    ds_read_b64_tr_b16 v[54:55], v118 offset:62464
    v_mfma_f32_32x32x16_bf16 v[156:171], v[68:71], v[64:67], v[156:171]
    ds_read_b64_tr_b16 v[56:57], v121 offset:61440
    ds_read_b64_tr_b16 v[58:59], v121 offset:62464
    v_mfma_f32_32x32x16_bf16 v[172:187], v[72:75], v[64:67], v[172:187]
    s_barrier
    s_waitcnt lgkmcnt(6)
    v_mfma_f32_32x32x16_bf16 v[124:139], v[36:39], v[28:31], v[124:139]
    ds_read_b128 v[60:63], v107 offset:0
    ds_read_b128 v[64:67], v107 offset:4096
    v_mfma_f32_32x32x16_bf16 v[140:155], v[40:43], v[28:31], v[140:155]
    ds_read_b64_tr_b16 v[68:69], v119 offset:16384
    ds_read_b64_tr_b16 v[70:71], v119 offset:17408
    v_mfma_f32_32x32x16_bf16 v[156:171], v[36:39], v[32:35], v[156:171]
    ds_read_b64_tr_b16 v[72:73], v122 offset:16384
    ds_read_b64_tr_b16 v[74:75], v122 offset:17408
    v_mfma_f32_32x32x16_bf16 v[172:187], v[40:43], v[32:35], v[172:187]
    s_waitcnt lgkmcnt(6)
    v_mfma_f32_32x32x16_bf16 v[124:139], v[52:55], v[44:47], v[124:139]
    ds_read_b128 v[28:31], v110 offset:0
    ds_read_b128 v[32:35], v110 offset:4096
    v_mfma_f32_32x32x16_bf16 v[140:155], v[56:59], v[44:47], v[140:155]
    ds_read_b64_tr_b16 v[36:37], v119 offset:20480
    ds_read_b64_tr_b16 v[38:39], v119 offset:21504
    v_mfma_f32_32x32x16_bf16 v[156:171], v[52:55], v[48:51], v[156:171]
    ds_read_b64_tr_b16 v[40:41], v122 offset:20480
    ds_read_b64_tr_b16 v[42:43], v122 offset:21504
    v_mfma_f32_32x32x16_bf16 v[172:187], v[56:59], v[48:51], v[172:187]
    s_waitcnt lgkmcnt(6)
    v_mfma_f32_32x32x16_bf16 v[124:139], v[68:71], v[60:63], v[124:139]
    ds_read_b128 v[44:47], v113 offset:0
    ds_read_b128 v[48:51], v113 offset:4096
    v_mfma_f32_32x32x16_bf16 v[140:155], v[72:75], v[60:63], v[140:155]
    ds_read_b64_tr_b16 v[52:53], v119 offset:24576
    ds_read_b64_tr_b16 v[54:55], v119 offset:25600
    v_mfma_f32_32x32x16_bf16 v[156:171], v[68:71], v[64:67], v[156:171]
    ds_read_b64_tr_b16 v[56:57], v122 offset:24576
    ds_read_b64_tr_b16 v[58:59], v122 offset:25600
    v_mfma_f32_32x32x16_bf16 v[172:187], v[72:75], v[64:67], v[172:187]
    s_waitcnt lgkmcnt(6)
    v_mfma_f32_32x32x16_bf16 v[124:139], v[36:39], v[28:31], v[124:139]
    ds_read_b128 v[60:63], v116 offset:0
    ds_read_b128 v[64:67], v116 offset:4096
    v_mfma_f32_32x32x16_bf16 v[140:155], v[40:43], v[28:31], v[140:155]
    ds_read_b64_tr_b16 v[68:69], v119 offset:28672
    ds_read_b64_tr_b16 v[70:71], v119 offset:29696
    v_mfma_f32_32x32x16_bf16 v[156:171], v[36:39], v[32:35], v[156:171]
    ds_read_b64_tr_b16 v[72:73], v122 offset:28672
    ds_read_b64_tr_b16 v[74:75], v122 offset:29696
    v_mfma_f32_32x32x16_bf16 v[172:187], v[40:43], v[32:35], v[172:187]
    s_barrier
    s_waitcnt lgkmcnt(6)
    v_mfma_f32_32x32x16_bf16 v[124:139], v[52:55], v[44:47], v[124:139]
    ds_read_b128 v[28:31], v107 offset:32768
    ds_read_b128 v[32:35], v107 offset:36864
    v_mfma_f32_32x32x16_bf16 v[140:155], v[56:59], v[44:47], v[140:155]
    ds_read_b64_tr_b16 v[36:37], v119 offset:49152
    ds_read_b64_tr_b16 v[38:39], v119 offset:50176
    v_mfma_f32_32x32x16_bf16 v[156:171], v[52:55], v[48:51], v[156:171]
    ds_read_b64_tr_b16 v[40:41], v122 offset:49152
    ds_read_b64_tr_b16 v[42:43], v122 offset:50176
    v_mfma_f32_32x32x16_bf16 v[172:187], v[56:59], v[48:51], v[172:187]
    s_waitcnt lgkmcnt(6)
    v_mfma_f32_32x32x16_bf16 v[124:139], v[68:71], v[60:63], v[124:139]
    ds_read_b128 v[44:47], v110 offset:32768
    ds_read_b128 v[48:51], v110 offset:36864
    v_mfma_f32_32x32x16_bf16 v[140:155], v[72:75], v[60:63], v[140:155]
    ds_read_b64_tr_b16 v[52:53], v119 offset:53248
    ds_read_b64_tr_b16 v[54:55], v119 offset:54272
    v_mfma_f32_32x32x16_bf16 v[156:171], v[68:71], v[64:67], v[156:171]
    ds_read_b64_tr_b16 v[56:57], v122 offset:53248
    ds_read_b64_tr_b16 v[58:59], v122 offset:54272
    v_mfma_f32_32x32x16_bf16 v[172:187], v[72:75], v[64:67], v[172:187]
    s_waitcnt lgkmcnt(6)
    v_mfma_f32_32x32x16_bf16 v[124:139], v[36:39], v[28:31], v[124:139]
    ds_read_b128 v[60:63], v113 offset:32768
    ds_read_b128 v[64:67], v113 offset:36864
    v_mfma_f32_32x32x16_bf16 v[140:155], v[40:43], v[28:31], v[140:155]
    ds_read_b64_tr_b16 v[68:69], v119 offset:57344
    ds_read_b64_tr_b16 v[70:71], v119 offset:58368
    v_mfma_f32_32x32x16_bf16 v[156:171], v[36:39], v[32:35], v[156:171]
    ds_read_b64_tr_b16 v[72:73], v122 offset:57344
    ds_read_b64_tr_b16 v[74:75], v122 offset:58368
    v_mfma_f32_32x32x16_bf16 v[172:187], v[40:43], v[32:35], v[172:187]
    s_waitcnt lgkmcnt(6)
    v_mfma_f32_32x32x16_bf16 v[124:139], v[52:55], v[44:47], v[124:139]
    ds_read_b128 v[28:31], v116 offset:32768
    ds_read_b128 v[32:35], v116 offset:36864
    v_mfma_f32_32x32x16_bf16 v[140:155], v[56:59], v[44:47], v[140:155]
    ds_read_b64_tr_b16 v[36:37], v119 offset:61440
    ds_read_b64_tr_b16 v[38:39], v119 offset:62464
    v_mfma_f32_32x32x16_bf16 v[156:171], v[52:55], v[48:51], v[156:171]
    ds_read_b64_tr_b16 v[40:41], v122 offset:61440
    ds_read_b64_tr_b16 v[42:43], v122 offset:62464
    v_mfma_f32_32x32x16_bf16 v[172:187], v[56:59], v[48:51], v[172:187]
    s_barrier
    s_waitcnt lgkmcnt(6)
    v_mfma_f32_32x32x16_bf16 v[124:139], v[68:71], v[60:63], v[124:139]
    ds_read_b128 v[44:47], v108 offset:0
    ds_read_b128 v[48:51], v108 offset:4096
    v_mfma_f32_32x32x16_bf16 v[140:155], v[72:75], v[60:63], v[140:155]
    ds_read_b64_tr_b16 v[52:53], v120 offset:16384
    ds_read_b64_tr_b16 v[54:55], v120 offset:17408
    v_mfma_f32_32x32x16_bf16 v[156:171], v[68:71], v[64:67], v[156:171]
    ds_read_b64_tr_b16 v[56:57], v123 offset:16384
    ds_read_b64_tr_b16 v[58:59], v123 offset:17408
    v_mfma_f32_32x32x16_bf16 v[172:187], v[72:75], v[64:67], v[172:187]
    s_add_u32 m0, s21, 0
    v_mad_u32_u24 v250, v247, 0, v244
    buffer_load_dwordx4 v250, s[8:11], 0 offen sc1 lds
    s_add_u32 m0, s21, 1024
    v_mad_u32_u24 v250, v248, 0, v245
    buffer_load_dwordx4 v250, s[8:11], 0 offen sc1 lds
    s_waitcnt lgkmcnt(6)
    v_mfma_f32_32x32x16_bf16 v[124:139], v[36:39], v[28:31], v[124:139]
    ds_read_b128 v[60:63], v111 offset:0
    ds_read_b128 v[64:67], v111 offset:4096
    v_mfma_f32_32x32x16_bf16 v[140:155], v[40:43], v[28:31], v[140:155]
    ds_read_b64_tr_b16 v[68:69], v120 offset:20480
    ds_read_b64_tr_b16 v[70:71], v120 offset:21504
    v_mfma_f32_32x32x16_bf16 v[156:171], v[36:39], v[32:35], v[156:171]
    ds_read_b64_tr_b16 v[72:73], v123 offset:20480
    ds_read_b64_tr_b16 v[74:75], v123 offset:21504
    v_mfma_f32_32x32x16_bf16 v[172:187], v[40:43], v[32:35], v[172:187]
    s_add_u32 m0, s21, 2048
    v_mad_u32_u24 v250, v249, 0, v246
    s_mov_b32 exec_hi, 0xffff
    buffer_load_dwordx4 v250, s[8:11], 0 offen sc1 lds
    s_mov_b32 exec_hi, -1
    buffer_load_dwordx4 v[100:103], v236, s[8:11], s88 offen sc1
    s_waitcnt lgkmcnt(6)
    v_mfma_f32_32x32x16_bf16 v[124:139], v[52:55], v[44:47], v[124:139]
    ds_read_b128 v[28:31], v114 offset:0
    ds_read_b128 v[32:35], v114 offset:4096
    v_mfma_f32_32x32x16_bf16 v[140:155], v[56:59], v[44:47], v[140:155]
    ds_read_b64_tr_b16 v[36:37], v120 offset:24576
    ds_read_b64_tr_b16 v[38:39], v120 offset:25600
    v_mfma_f32_32x32x16_bf16 v[156:171], v[52:55], v[48:51], v[156:171]
    ds_read_b64_tr_b16 v[40:41], v123 offset:24576
    ds_read_b64_tr_b16 v[42:43], v123 offset:25600
    v_mfma_f32_32x32x16_bf16 v[172:187], v[56:59], v[48:51], v[172:187]
    v_mov_b32 v104, 0
    v_mov_b32 v105, 0
    s_mov_b32 exec_hi, 0
    buffer_load_dwordx2 v[104:105], v237, s[8:11], s89 offen sc1
    s_mov_b32 exec_hi, -1
    v_mov_b32 v20, 0
    buffer_load_dword v19, v20, s[44:47], 0 offen sc1
    s_waitcnt lgkmcnt(6)
    v_mfma_f32_32x32x16_bf16 v[124:139], v[68:71], v[60:63], v[124:139]
    ds_read_b128 v[44:47], v117 offset:0
    ds_read_b128 v[48:51], v117 offset:4096
    v_mfma_f32_32x32x16_bf16 v[140:155], v[72:75], v[60:63], v[140:155]
    ds_read_b64_tr_b16 v[52:53], v120 offset:28672
    ds_read_b64_tr_b16 v[54:55], v120 offset:29696
    v_mfma_f32_32x32x16_bf16 v[156:171], v[68:71], v[64:67], v[156:171]
    ds_read_b64_tr_b16 v[56:57], v123 offset:28672
    ds_read_b64_tr_b16 v[58:59], v123 offset:29696
    v_mfma_f32_32x32x16_bf16 v[172:187], v[72:75], v[64:67], v[172:187]
    s_waitcnt lgkmcnt(6)
    v_mfma_f32_32x32x16_bf16 v[124:139], v[36:39], v[28:31], v[124:139]
    v_mfma_f32_32x32x16_bf16 v[140:155], v[40:43], v[28:31], v[140:155]
    v_mfma_f32_32x32x16_bf16 v[156:171], v[36:39], v[32:35], v[156:171]
    v_mfma_f32_32x32x16_bf16 v[172:187], v[40:43], v[32:35], v[172:187]
    s_waitcnt lgkmcnt(0)
    v_mfma_f32_32x32x16_bf16 v[124:139], v[52:55], v[44:47], v[124:139]
    v_mfma_f32_32x32x16_bf16 v[140:155], v[56:59], v[44:47], v[140:155]
    v_mfma_f32_32x32x16_bf16 v[156:171], v[52:55], v[48:51], v[156:171]
    v_mfma_f32_32x32x16_bf16 v[172:187], v[56:59], v[48:51], v[172:187]
    s_setprio 0
    s_waitcnt vmcnt(0)
    s_nop 0
    v_readfirstlane_b32 s17, v19
    s_barrier
    s_add_u32 m0, s21, 22528
    v_mad_u32_u24 v250, v247, 1, v244
    buffer_load_dwordx4 v250, s[8:11], 0 offen sc1 lds
    s_add_u32 m0, s21, 23552
    v_mad_u32_u24 v250, v248, 1, v245
    buffer_load_dwordx4 v250, s[8:11], 0 offen sc1 lds
    s_add_u32 m0, s21, 24576
    v_mad_u32_u24 v250, v249, 1, v246
    s_mov_b32 exec_hi, 0xffff
    buffer_load_dwordx4 v250, s[8:11], 0 offen sc1 lds
    s_mov_b32 exec_hi, -1
    s_add_u32 m0, s21, 45056
    v_mad_u32_u24 v250, v247, 2, v244
    buffer_load_dwordx4 v250, s[8:11], 0 offen sc1 lds
    s_add_u32 m0, s21, 46080
    v_mad_u32_u24 v250, v248, 2, v245
    buffer_load_dwordx4 v250, s[8:11], 0 offen sc1 lds
    s_add_u32 m0, s21, 47104
    v_mad_u32_u24 v250, v249, 2, v246
    s_mov_b32 exec_hi, 0xffff
    buffer_load_dwordx4 v250, s[8:11], 0 offen sc1 lds
    s_mov_b32 exec_hi, -1
    s_lshl_b32 s80, s72, 7
    s_lshl_b32 s32, s74, 6
    s_add_u32 s80, s80, s32
    s_lshr_b32 s80, s80, 1
    s_cmp_lt_u32 s73, 5
    s_mov_b32 s33, 2621440
    s_cselect_b32 s81, s33, 7864320
    s_mov_b32 s33, 0x3ea52b5c
    s_cselect_b32 s82, s33, 1.0
    s_lshl_b32 s32, s79, 1
    s_add_u32 s32, s32, s75
    s_lshl_b32 s32, s32, 18
    s_add_u32 s81, s81, s32
    s_lshl_b32 s32, s80, 4
    s_add_u32 s81, s81, s32
    v_lshlrev_b32 v76, 15, v3
    v_and_b32 v20, 1, v2
    v_lshl_add_u32 v76, v20, 14, v76
    v_lshrrev_b32 v20, 1, v2
    v_lshl_add_u32 v76, v20, 4, v76
    v_mov_b32 v22, s82
    v_mov_b32 v23, s82
    s_nop 7
    s_nop 3
    v_pk_mul_f32 v[124:125], v[124:125], v[22:23]
    v_pk_mul_f32 v[126:127], v[126:127], v[22:23]
    v_cvt_pk_bf16_f32 v188, v124, v125
    v_cvt_pk_bf16_f32 v189, v126, v127
    v_pk_mul_f32 v[128:129], v[128:129], v[22:23]
    v_pk_mul_f32 v[130:131], v[130:131], v[22:23]
    v_cvt_pk_bf16_f32 v190, v128, v129
    v_cvt_pk_bf16_f32 v191, v130, v131
    s_add_u32 s33, s81, 0
    s_nop 0
    v_permlane32_swap_b32 v188, v190
    v_permlane32_swap_b32 v189, v191
    buffer_store_dwordx4 v[188:191], v76, s[8:11], s33 offen sc1
    v_pk_mul_f32 v[132:133], v[132:133], v[22:23]
    v_pk_mul_f32 v[134:135], v[134:135], v[22:23]
    v_cvt_pk_bf16_f32 v192, v132, v133
    v_cvt_pk_bf16_f32 v193, v134, v135
    v_pk_mul_f32 v[136:137], v[136:137], v[22:23]
    v_pk_mul_f32 v[138:139], v[138:139], v[22:23]
    v_cvt_pk_bf16_f32 v194, v136, v137
    v_cvt_pk_bf16_f32 v195, v138, v139
    s_add_u32 s33, s81, 65536
    s_nop 0
    v_permlane32_swap_b32 v192, v194
    v_permlane32_swap_b32 v193, v195
    buffer_store_dwordx4 v[192:195], v76, s[8:11], s33 offen sc1
    v_pk_mul_f32 v[140:141], v[140:141], v[22:23]
    v_pk_mul_f32 v[142:143], v[142:143], v[22:23]
    v_cvt_pk_bf16_f32 v196, v140, v141
    v_cvt_pk_bf16_f32 v197, v142, v143
    v_pk_mul_f32 v[144:145], v[144:145], v[22:23]
    v_pk_mul_f32 v[146:147], v[146:147], v[22:23]
    v_cvt_pk_bf16_f32 v198, v144, v145
    v_cvt_pk_bf16_f32 v199, v146, v147
    s_add_u32 s33, s81, 131072
    s_nop 0
    v_permlane32_swap_b32 v196, v198
    v_permlane32_swap_b32 v197, v199
    buffer_store_dwordx4 v[196:199], v76, s[8:11], s33 offen sc1
    v_pk_mul_f32 v[148:149], v[148:149], v[22:23]
    v_pk_mul_f32 v[150:151], v[150:151], v[22:23]
    v_cvt_pk_bf16_f32 v200, v148, v149
    v_cvt_pk_bf16_f32 v201, v150, v151
    v_pk_mul_f32 v[152:153], v[152:153], v[22:23]
    v_pk_mul_f32 v[154:155], v[154:155], v[22:23]
    v_cvt_pk_bf16_f32 v202, v152, v153
    v_cvt_pk_bf16_f32 v203, v154, v155
    s_add_u32 s33, s81, 196608
    s_nop 0
    v_permlane32_swap_b32 v200, v202
    v_permlane32_swap_b32 v201, v203
    buffer_store_dwordx4 v[200:203], v76, s[8:11], s33 offen sc1
    v_pk_mul_f32 v[156:157], v[156:157], v[22:23]
    v_pk_mul_f32 v[158:159], v[158:159], v[22:23]
    v_cvt_pk_bf16_f32 v204, v156, v157
    v_cvt_pk_bf16_f32 v205, v158, v159
    v_pk_mul_f32 v[160:161], v[160:161], v[22:23]
    v_pk_mul_f32 v[162:163], v[162:163], v[22:23]
    v_cvt_pk_bf16_f32 v206, v160, v161
    v_cvt_pk_bf16_f32 v207, v162, v163
    s_add_u32 s33, s81, 256
    s_nop 0
    v_permlane32_swap_b32 v204, v206
    v_permlane32_swap_b32 v205, v207
    buffer_store_dwordx4 v[204:207], v76, s[8:11], s33 offen sc1
    v_pk_mul_f32 v[164:165], v[164:165], v[22:23]
    v_pk_mul_f32 v[166:167], v[166:167], v[22:23]
    v_cvt_pk_bf16_f32 v208, v164, v165
    v_cvt_pk_bf16_f32 v209, v166, v167
    v_pk_mul_f32 v[168:169], v[168:169], v[22:23]
    v_pk_mul_f32 v[170:171], v[170:171], v[22:23]
    v_cvt_pk_bf16_f32 v210, v168, v169
    v_cvt_pk_bf16_f32 v211, v170, v171
    s_add_u32 s33, s81, 65792
    s_nop 0
    v_permlane32_swap_b32 v208, v210
    v_permlane32_swap_b32 v209, v211
    buffer_store_dwordx4 v[208:211], v76, s[8:11], s33 offen sc1
    v_pk_mul_f32 v[172:173], v[172:173], v[22:23]
    v_pk_mul_f32 v[174:175], v[174:175], v[22:23]
    v_cvt_pk_bf16_f32 v212, v172, v173
    v_cvt_pk_bf16_f32 v213, v174, v175
    v_pk_mul_f32 v[176:177], v[176:177], v[22:23]
    v_pk_mul_f32 v[178:179], v[178:179], v[22:23]
    v_cvt_pk_bf16_f32 v214, v176, v177
    v_cvt_pk_bf16_f32 v215, v178, v179
    s_add_u32 s33, s81, 131328
    s_nop 0
    v_permlane32_swap_b32 v212, v214
    v_permlane32_swap_b32 v213, v215
    buffer_store_dwordx4 v[212:215], v76, s[8:11], s33 offen sc1
    v_pk_mul_f32 v[180:181], v[180:181], v[22:23]
    v_pk_mul_f32 v[182:183], v[182:183], v[22:23]
    v_cvt_pk_bf16_f32 v216, v180, v181
    v_cvt_pk_bf16_f32 v217, v182, v183
    v_pk_mul_f32 v[184:185], v[184:185], v[22:23]
    v_pk_mul_f32 v[186:187], v[186:187], v[22:23]
    v_cvt_pk_bf16_f32 v218, v184, v185
    v_cvt_pk_bf16_f32 v219, v186, v187
    s_add_u32 s33, s81, 196864
    s_nop 0
    v_permlane32_swap_b32 v216, v218
    v_permlane32_swap_b32 v217, v219
    buffer_store_dwordx4 v[216:219], v76, s[8:11], s33 offen sc1
    s_nop 3
    s_cmp_lg_u32 s17, 0
    s_cbranch_scc1 L_nonce1t_ok
    s_mov_b32 s42, 0
L_nonce1t_spin:
    s_sleep 1
    v_mov_b32 v20, 0
    buffer_load_dword v19, v20, s[44:47], 0 offen sc1
    s_add_u32 s42, s42, 1
    s_cmp_ge_u32 s42, 1048576
    s_cbranch_scc1 L_nonce1t_ok
    s_waitcnt vmcnt(0)
    v_readfirstlane_b32 s17, v19
    s_nop 3
    s_cmp_eq_u32 s17, 0
    s_cbranch_scc1 L_nonce1t_spin
L_nonce1t_ok:
    s_branch L_attn
L_vtile:
    s_barrier
    ds_read_b128 v[28:31], v106 offset:0
    ds_read_b128 v[32:35], v106 offset:4096
    ds_read_b64_tr_b16 v[36:37], v118 offset:16384
    ds_read_b64_tr_b16 v[38:39], v118 offset:17408
    ds_read_b64_tr_b16 v[40:41], v121 offset:16384
    ds_read_b64_tr_b16 v[42:43], v121 offset:17408
    ds_read_b128 v[44:47], v109 offset:0
    ds_read_b128 v[48:51], v109 offset:4096
    ds_read_b64_tr_b16 v[52:53], v118 offset:20480
    ds_read_b64_tr_b16 v[54:55], v118 offset:21504
    ds_read_b64_tr_b16 v[56:57], v121 offset:20480
    ds_read_b64_tr_b16 v[58:59], v121 offset:21504
    s_waitcnt lgkmcnt(6)
    v_mfma_f32_32x32x16_bf16 v[124:139], v[28:31], v[36:39], 0
    ds_read_b128 v[60:63], v112 offset:0
    ds_read_b128 v[64:67], v112 offset:4096
    v_mfma_f32_32x32x16_bf16 v[140:155], v[28:31], v[40:43], 0
    ds_read_b64_tr_b16 v[68:69], v118 offset:24576
    ds_read_b64_tr_b16 v[70:71], v118 offset:25600
    v_mfma_f32_32x32x16_bf16 v[156:171], v[32:35], v[36:39], 0
    ds_read_b64_tr_b16 v[72:73], v121 offset:24576
    ds_read_b64_tr_b16 v[74:75], v121 offset:25600
    v_mfma_f32_32x32x16_bf16 v[172:187], v[32:35], v[40:43], 0
    s_waitcnt lgkmcnt(6)
    v_mfma_f32_32x32x16_bf16 v[124:139], v[44:47], v[52:55], v[124:139]
    ds_read_b128 v[28:31], v115 offset:0
    ds_read_b128 v[32:35], v115 offset:4096
    v_mfma_f32_32x32x16_bf16 v[140:155], v[44:47], v[56:59], v[140:155]
    ds_read_b64_tr_b16 v[36:37], v118 offset:28672
    ds_read_b64_tr_b16 v[38:39], v118 offset:29696
    v_mfma_f32_32x32x16_bf16 v[156:171], v[48:51], v[52:55], v[156:171]
    ds_read_b64_tr_b16 v[40:41], v121 offset:28672
    ds_read_b64_tr_b16 v[42:43], v121 offset:29696
    v_mfma_f32_32x32x16_bf16 v[172:187], v[48:51], v[56:59], v[172:187]
    s_barrier
    s_waitcnt lgkmcnt(6)
    v_mfma_f32_32x32x16_bf16 v[124:139], v[60:63], v[68:71], v[124:139]
    ds_read_b128 v[44:47], v106 offset:32768
    ds_read_b128 v[48:51], v106 offset:36864
    v_mfma_f32_32x32x16_bf16 v[140:155], v[60:63], v[72:75], v[140:155]
    ds_read_b64_tr_b16 v[52:53], v118 offset:49152
    ds_read_b64_tr_b16 v[54:55], v118 offset:50176
    v_mfma_f32_32x32x16_bf16 v[156:171], v[64:67], v[68:71], v[156:171]
    ds_read_b64_tr_b16 v[56:57], v121 offset:49152
    ds_read_b64_tr_b16 v[58:59], v121 offset:50176
    v_mfma_f32_32x32x16_bf16 v[172:187], v[64:67], v[72:75], v[172:187]
    s_waitcnt lgkmcnt(6)
    v_mfma_f32_32x32x16_bf16 v[124:139], v[28:31], v[36:39], v[124:139]
    ds_read_b128 v[60:63], v109 offset:32768
    ds_read_b128 v[64:67], v109 offset:36864
    v_mfma_f32_32x32x16_bf16 v[140:155], v[28:31], v[40:43], v[140:155]
    ds_read_b64_tr_b16 v[68:69], v118 offset:53248
    ds_read_b64_tr_b16 v[70:71], v118 offset:54272
    v_mfma_f32_32x32x16_bf16 v[156:171], v[32:35], v[36:39], v[156:171]
    ds_read_b64_tr_b16 v[72:73], v121 offset:53248
    ds_read_b64_tr_b16 v[74:75], v121 offset:54272
    v_mfma_f32_32x32x16_bf16 v[172:187], v[32:35], v[40:43], v[172:187]
    s_waitcnt lgkmcnt(6)
    v_mfma_f32_32x32x16_bf16 v[124:139], v[44:47], v[52:55], v[124:139]
    ds_read_b128 v[28:31], v112 offset:32768
    ds_read_b128 v[32:35], v112 offset:36864
    v_mfma_f32_32x32x16_bf16 v[140:155], v[44:47], v[56:59], v[140:155]
    ds_read_b64_tr_b16 v[36:37], v118 offset:57344
    ds_read_b64_tr_b16 v[38:39], v118 offset:58368
    v_mfma_f32_32x32x16_bf16 v[156:171], v[48:51], v[52:55], v[156:171]
    ds_read_b64_tr_b16 v[40:41], v121 offset:57344
    ds_read_b64_tr_b16 v[42:43], v121 offset:58368
    v_mfma_f32_32x32x16_bf16 v[172:187], v[48:51], v[56:59], v[172:187]
    s_waitcnt lgkmcnt(6)
    v_mfma_f32_32x32x16_bf16 v[124:139], v[60:63], v[68:71], v[124:139]
    ds_read_b128 v[44:47], v115 offset:32768
    ds_read_b128 v[48:51], v115 offset:36864
    v_mfma_f32_32x32x16_bf16 v[140:155], v[60:63], v[72:75], v[140:155]
    ds_read_b64_tr_b16 v[52:53], v118 offset:61440
    ds_read_b64_tr_b16 v[54:55], v118 offset:62464
    v_mfma_f32_32x32x16_bf16 v[156:171], v[64:67], v[68:71], v[156:171]
    ds_read_b64_tr_b16 v[56:57], v121 offset:61440
    ds_read_b64_tr_b16 v[58:59], v121 offset:62464
    v_mfma_f32_32x32x16_bf16 v[172:187], v[64:67], v[72:75], v[172:187]
    s_barrier
    s_waitcnt lgkmcnt(6)
    v_mfma_f32_32x32x16_bf16 v[124:139], v[28:31], v[36:39], v[124:139]
    ds_read_b128 v[60:63], v107 offset:0
    ds_read_b128 v[64:67], v107 offset:4096
    v_mfma_f32_32x32x16_bf16 v[140:155], v[28:31], v[40:43], v[140:155]
    ds_read_b64_tr_b16 v[68:69], v119 offset:16384
    ds_read_b64_tr_b16 v[70:71], v119 offset:17408
    v_mfma_f32_32x32x16_bf16 v[156:171], v[32:35], v[36:39], v[156:171]
    ds_read_b64_tr_b16 v[72:73], v122 offset:16384
    ds_read_b64_tr_b16 v[74:75], v122 offset:17408
    v_mfma_f32_32x32x16_bf16 v[172:187], v[32:35], v[40:43], v[172:187]
    s_waitcnt lgkmcnt(6)
    v_mfma_f32_32x32x16_bf16 v[124:139], v[44:47], v[52:55], v[124:139]
    ds_read_b128 v[28:31], v110 offset:0
    ds_read_b128 v[32:35], v110 offset:4096
    v_mfma_f32_32x32x16_bf16 v[140:155], v[44:47], v[56:59], v[140:155]
    ds_read_b64_tr_b16 v[36:37], v119 offset:20480
    ds_read_b64_tr_b16 v[38:39], v119 offset:21504
    v_mfma_f32_32x32x16_bf16 v[156:171], v[48:51], v[52:55], v[156:171]
    ds_read_b64_tr_b16 v[40:41], v122 offset:20480
    ds_read_b64_tr_b16 v[42:43], v122 offset:21504
    v_mfma_f32_32x32x16_bf16 v[172:187], v[48:51], v[56:59], v[172:187]
    s_waitcnt lgkmcnt(6)
    v_mfma_f32_32x32x16_bf16 v[124:139], v[60:63], v[68:71], v[124:139]
    ds_read_b128 v[44:47], v113 offset:0
    ds_read_b128 v[48:51], v113 offset:4096
    v_mfma_f32_32x32x16_bf16 v[140:155], v[60:63], v[72:75], v[140:155]
    ds_read_b64_tr_b16 v[52:53], v119 offset:24576
    ds_read_b64_tr_b16 v[54:55], v119 offset:25600
    v_mfma_f32_32x32x16_bf16 v[156:171], v[64:67], v[68:71], v[156:171]
    ds_read_b64_tr_b16 v[56:57], v122 offset:24576
    ds_read_b64_tr_b16 v[58:59], v122 offset:25600
    v_mfma_f32_32x32x16_bf16 v[172:187], v[64:67], v[72:75], v[172:187]
    s_waitcnt lgkmcnt(6)
    v_mfma_f32_32x32x16_bf16 v[124:139], v[28:31], v[36:39], v[124:139]
    ds_read_b128 v[60:63], v116 offset:0
    ds_read_b128 v[64:67], v116 offset:4096
    v_mfma_f32_32x32x16_bf16 v[140:155], v[28:31], v[40:43], v[140:155]
    ds_read_b64_tr_b16 v[68:69], v119 offset:28672
    ds_read_b64_tr_b16 v[70:71], v119 offset:29696
    v_mfma_f32_32x32x16_bf16 v[156:171], v[32:35], v[36:39], v[156:171]
    ds_read_b64_tr_b16 v[72:73], v122 offset:28672
    ds_read_b64_tr_b16 v[74:75], v122 offset:29696
    v_mfma_f32_32x32x16_bf16 v[172:187], v[32:35], v[40:43], v[172:187]
    s_barrier
    s_waitcnt lgkmcnt(6)
    v_mfma_f32_32x32x16_bf16 v[124:139], v[44:47], v[52:55], v[124:139]
    ds_read_b128 v[28:31], v107 offset:32768
    ds_read_b128 v[32:35], v107 offset:36864
    v_mfma_f32_32x32x16_bf16 v[140:155], v[44:47], v[56:59], v[140:155]
    ds_read_b64_tr_b16 v[36:37], v119 offset:49152
    ds_read_b64_tr_b16 v[38:39], v119 offset:50176
    v_mfma_f32_32x32x16_bf16 v[156:171], v[48:51], v[52:55], v[156:171]
    ds_read_b64_tr_b16 v[40:41], v122 offset:49152
    ds_read_b64_tr_b16 v[42:43], v122 offset:50176
    v_mfma_f32_32x32x16_bf16 v[172:187], v[48:51], v[56:59], v[172:187]
    s_waitcnt lgkmcnt(6)
    v_mfma_f32_32x32x16_bf16 v[124:139], v[60:63], v[68:71], v[124:139]
    ds_read_b128 v[44:47], v110 offset:32768
    ds_read_b128 v[48:51], v110 offset:36864
    v_mfma_f32_32x32x16_bf16 v[140:155], v[60:63], v[72:75], v[140:155]
    ds_read_b64_tr_b16 v[52:53], v119 offset:53248
    ds_read_b64_tr_b16 v[54:55], v119 offset:54272
    v_mfma_f32_32x32x16_bf16 v[156:171], v[64:67], v[68:71], v[156:171]
    ds_read_b64_tr_b16 v[56:57], v122 offset:53248
    ds_read_b64_tr_b16 v[58:59], v122 offset:54272
    v_mfma_f32_32x32x16_bf16 v[172:187], v[64:67], v[72:75], v[172:187]
    s_waitcnt lgkmcnt(6)
    v_mfma_f32_32x32x16_bf16 v[124:139], v[28:31], v[36:39], v[124:139]
    ds_read_b128 v[60:63], v113 offset:32768
    ds_read_b128 v[64:67], v113 offset:36864
    v_mfma_f32_32x32x16_bf16 v[140:155], v[28:31], v[40:43], v[140:155]
    ds_read_b64_tr_b16 v[68:69], v119 offset:57344
    ds_read_b64_tr_b16 v[70:71], v119 offset:58368
    v_mfma_f32_32x32x16_bf16 v[156:171], v[32:35], v[36:39], v[156:171]
    ds_read_b64_tr_b16 v[72:73], v122 offset:57344
    ds_read_b64_tr_b16 v[74:75], v122 offset:58368
    v_mfma_f32_32x32x16_bf16 v[172:187], v[32:35], v[40:43], v[172:187]
    s_waitcnt lgkmcnt(6)
    v_mfma_f32_32x32x16_bf16 v[124:139], v[44:47], v[52:55], v[124:139]
    ds_read_b128 v[28:31], v116 offset:32768
    ds_read_b128 v[32:35], v116 offset:36864
    v_mfma_f32_32x32x16_bf16 v[140:155], v[44:47], v[56:59], v[140:155]
    ds_read_b64_tr_b16 v[36:37], v119 offset:61440
    ds_read_b64_tr_b16 v[38:39], v119 offset:62464
    v_mfma_f32_32x32x16_bf16 v[156:171], v[48:51], v[52:55], v[156:171]
    ds_read_b64_tr_b16 v[40:41], v122 offset:61440
    ds_read_b64_tr_b16 v[42:43], v122 offset:62464
    v_mfma_f32_32x32x16_bf16 v[172:187], v[48:51], v[56:59], v[172:187]
    s_barrier
    s_waitcnt lgkmcnt(6)
    v_mfma_f32_32x32x16_bf16 v[124:139], v[60:63], v[68:71], v[124:139]
    ds_read_b128 v[44:47], v108 offset:0
    ds_read_b128 v[48:51], v108 offset:4096
    v_mfma_f32_32x32x16_bf16 v[140:155], v[60:63], v[72:75], v[140:155]
    ds_read_b64_tr_b16 v[52:53], v120 offset:16384
    ds_read_b64_tr_b16 v[54:55], v120 offset:17408
    v_mfma_f32_32x32x16_bf16 v[156:171], v[64:67], v[68:71], v[156:171]
    ds_read_b64_tr_b16 v[56:57], v123 offset:16384
    ds_read_b64_tr_b16 v[58:59], v123 offset:17408
    v_mfma_f32_32x32x16_bf16 v[172:187], v[64:67], v[72:75], v[172:187]
    s_waitcnt lgkmcnt(6)
    v_mfma_f32_32x32x16_bf16 v[124:139], v[28:31], v[36:39], v[124:139]
    ds_read_b128 v[60:63], v111 offset:0
    ds_read_b128 v[64:67], v111 offset:4096
    v_mfma_f32_32x32x16_bf16 v[140:155], v[28:31], v[40:43], v[140:155]
    ds_read_b64_tr_b16 v[68:69], v120 offset:20480
    ds_read_b64_tr_b16 v[70:71], v120 offset:21504
    v_mfma_f32_32x32x16_bf16 v[156:171], v[32:35], v[36:39], v[156:171]
    ds_read_b64_tr_b16 v[72:73], v123 offset:20480
    ds_read_b64_tr_b16 v[74:75], v123 offset:21504
    v_mfma_f32_32x32x16_bf16 v[172:187], v[32:35], v[40:43], v[172:187]
    s_waitcnt lgkmcnt(6)
    v_mfma_f32_32x32x16_bf16 v[124:139], v[44:47], v[52:55], v[124:139]
    ds_read_b128 v[28:31], v114 offset:0
    ds_read_b128 v[32:35], v114 offset:4096
    v_mfma_f32_32x32x16_bf16 v[140:155], v[44:47], v[56:59], v[140:155]
    ds_read_b64_tr_b16 v[36:37], v120 offset:24576
    ds_read_b64_tr_b16 v[38:39], v120 offset:25600
    v_mfma_f32_32x32x16_bf16 v[156:171], v[48:51], v[52:55], v[156:171]
    ds_read_b64_tr_b16 v[40:41], v123 offset:24576
    ds_read_b64_tr_b16 v[42:43], v123 offset:25600
    v_mfma_f32_32x32x16_bf16 v[172:187], v[48:51], v[56:59], v[172:187]
    s_waitcnt lgkmcnt(6)
    v_mfma_f32_32x32x16_bf16 v[124:139], v[60:63], v[68:71], v[124:139]
    ds_read_b128 v[44:47], v117 offset:0
    ds_read_b128 v[48:51], v117 offset:4096
    v_mfma_f32_32x32x16_bf16 v[140:155], v[60:63], v[72:75], v[140:155]
    ds_read_b64_tr_b16 v[52:53], v120 offset:28672
    ds_read_b64_tr_b16 v[54:55], v120 offset:29696
    v_mfma_f32_32x32x16_bf16 v[156:171], v[64:67], v[68:71], v[156:171]
    ds_read_b64_tr_b16 v[56:57], v123 offset:28672
    ds_read_b64_tr_b16 v[58:59], v123 offset:29696
    v_mfma_f32_32x32x16_bf16 v[172:187], v[64:67], v[72:75], v[172:187]
    s_barrier
    s_waitcnt lgkmcnt(6)
    v_mfma_f32_32x32x16_bf16 v[124:139], v[28:31], v[36:39], v[124:139]
    ds_read_b128 v[60:63], v106 offset:0
    ds_read_b128 v[64:67], v106 offset:4096
    v_mfma_f32_32x32x16_bf16 v[140:155], v[28:31], v[40:43], v[140:155]
    ds_read_b64_tr_b16 v[68:69], v118 offset:16384
    ds_read_b64_tr_b16 v[70:71], v118 offset:17408
    v_mfma_f32_32x32x16_bf16 v[156:171], v[32:35], v[36:39], v[156:171]
    ds_read_b64_tr_b16 v[72:73], v121 offset:16384
    ds_read_b64_tr_b16 v[74:75], v121 offset:17408
    v_mfma_f32_32x32x16_bf16 v[172:187], v[32:35], v[40:43], v[172:187]
    s_waitcnt lgkmcnt(6)
    v_mfma_f32_32x32x16_bf16 v[124:139], v[44:47], v[52:55], v[124:139]
    ds_read_b128 v[28:31], v109 offset:0
    ds_read_b128 v[32:35], v109 offset:4096
    v_mfma_f32_32x32x16_bf16 v[140:155], v[44:47], v[56:59], v[140:155]
    ds_read_b64_tr_b16 v[36:37], v118 offset:20480
    ds_read_b64_tr_b16 v[38:39], v118 offset:21504
    v_mfma_f32_32x32x16_bf16 v[156:171], v[48:51], v[52:55], v[156:171]
    ds_read_b64_tr_b16 v[40:41], v121 offset:20480
    ds_read_b64_tr_b16 v[42:43], v121 offset:21504
    v_mfma_f32_32x32x16_bf16 v[172:187], v[48:51], v[56:59], v[172:187]
    s_waitcnt lgkmcnt(6)
    v_mfma_f32_32x32x16_bf16 v[124:139], v[60:63], v[68:71], v[124:139]
    ds_read_b128 v[44:47], v112 offset:0
    ds_read_b128 v[48:51], v112 offset:4096
    v_mfma_f32_32x32x16_bf16 v[140:155], v[60:63], v[72:75], v[140:155]
    ds_read_b64_tr_b16 v[52:53], v118 offset:24576
    ds_read_b64_tr_b16 v[54:55], v118 offset:25600
    v_mfma_f32_32x32x16_bf16 v[156:171], v[64:67], v[68:71], v[156:171]
    ds_read_b64_tr_b16 v[56:57], v121 offset:24576
    ds_read_b64_tr_b16 v[58:59], v121 offset:25600
    v_mfma_f32_32x32x16_bf16 v[172:187], v[64:67], v[72:75], v[172:187]
    s_waitcnt lgkmcnt(6)
    v_mfma_f32_32x32x16_bf16 v[124:139], v[28:31], v[36:39], v[124:139]
    ds_read_b128 v[60:63], v115 offset:0
    ds_read_b128 v[64:67], v115 offset:4096
    v_mfma_f32_32x32x16_bf16 v[140:155], v[28:31], v[40:43], v[140:155]
    ds_read_b64_tr_b16 v[68:69], v118 offset:28672
    ds_read_b64_tr_b16 v[70:71], v118 offset:29696
    v_mfma_f32_32x32x16_bf16 v[156:171], v[32:35], v[36:39], v[156:171]
    ds_read_b64_tr_b16 v[72:73], v121 offset:28672
    ds_read_b64_tr_b16 v[74:75], v121 offset:29696
    v_mfma_f32_32x32x16_bf16 v[172:187], v[32:35], v[40:43], v[172:187]
    s_barrier
    v_mov_b32 v20, 0
    buffer_load_dword v19, v20, s[44:47], 0 offen sc1
    s_waitcnt lgkmcnt(6)
    v_mfma_f32_32x32x16_bf16 v[124:139], v[44:47], v[52:55], v[124:139]
    ds_read_b128 v[28:31], v106 offset:32768
    ds_read_b128 v[32:35], v106 offset:36864
    v_mfma_f32_32x32x16_bf16 v[140:155], v[44:47], v[56:59], v[140:155]
    ds_read_b64_tr_b16 v[36:37], v118 offset:49152
    ds_read_b64_tr_b16 v[38:39], v118 offset:50176
    v_mfma_f32_32x32x16_bf16 v[156:171], v[48:51], v[52:55], v[156:171]
    ds_read_b64_tr_b16 v[40:41], v121 offset:49152
    ds_read_b64_tr_b16 v[42:43], v121 offset:50176
    v_mfma_f32_32x32x16_bf16 v[172:187], v[48:51], v[56:59], v[172:187]
    s_waitcnt lgkmcnt(6)
    v_mfma_f32_32x32x16_bf16 v[124:139], v[60:63], v[68:71], v[124:139]
    ds_read_b128 v[44:47], v109 offset:32768
    ds_read_b128 v[48:51], v109 offset:36864
    v_mfma_f32_32x32x16_bf16 v[140:155], v[60:63], v[72:75], v[140:155]
    ds_read_b64_tr_b16 v[52:53], v118 offset:53248
    ds_read_b64_tr_b16 v[54:55], v118 offset:54272
    v_mfma_f32_32x32x16_bf16 v[156:171], v[64:67], v[68:71], v[156:171]
    ds_read_b64_tr_b16 v[56:57], v121 offset:53248
    ds_read_b64_tr_b16 v[58:59], v121 offset:54272
    v_mfma_f32_32x32x16_bf16 v[172:187], v[64:67], v[72:75], v[172:187]
    s_waitcnt lgkmcnt(6)
    v_mfma_f32_32x32x16_bf16 v[124:139], v[28:31], v[36:39], v[124:139]
    ds_read_b128 v[60:63], v112 offset:32768
    ds_read_b128 v[64:67], v112 offset:36864
    v_mfma_f32_32x32x16_bf16 v[140:155], v[28:31], v[40:43], v[140:155]
    ds_read_b64_tr_b16 v[68:69], v118 offset:57344
    ds_read_b64_tr_b16 v[70:71], v118 offset:58368
    v_mfma_f32_32x32x16_bf16 v[156:171], v[32:35], v[36:39], v[156:171]
    ds_read_b64_tr_b16 v[72:73], v121 offset:57344
    ds_read_b64_tr_b16 v[74:75], v121 offset:58368
    v_mfma_f32_32x32x16_bf16 v[172:187], v[32:35], v[40:43], v[172:187]
    s_waitcnt lgkmcnt(6)
    v_mfma_f32_32x32x16_bf16 v[124:139], v[44:47], v[52:55], v[124:139]
    ds_read_b128 v[28:31], v115 offset:32768
    ds_read_b128 v[32:35], v115 offset:36864
    v_mfma_f32_32x32x16_bf16 v[140:155], v[44:47], v[56:59], v[140:155]
    ds_read_b64_tr_b16 v[36:37], v118 offset:61440
    ds_read_b64_tr_b16 v[38:39], v118 offset:62464
    v_mfma_f32_32x32x16_bf16 v[156:171], v[48:51], v[52:55], v[156:171]
    ds_read_b64_tr_b16 v[40:41], v121 offset:61440
    ds_read_b64_tr_b16 v[42:43], v121 offset:62464
    v_mfma_f32_32x32x16_bf16 v[172:187], v[48:51], v[56:59], v[172:187]
    s_barrier
    s_waitcnt lgkmcnt(6)
    v_mfma_f32_32x32x16_bf16 v[124:139], v[60:63], v[68:71], v[124:139]
    ds_read_b128 v[44:47], v107 offset:0
    ds_read_b128 v[48:51], v107 offset:4096
    v_mfma_f32_32x32x16_bf16 v[140:155], v[60:63], v[72:75], v[140:155]
    ds_read_b64_tr_b16 v[52:53], v119 offset:16384
    ds_read_b64_tr_b16 v[54:55], v119 offset:17408
    v_mfma_f32_32x32x16_bf16 v[156:171], v[64:67], v[68:71], v[156:171]
    ds_read_b64_tr_b16 v[56:57], v122 offset:16384
    ds_read_b64_tr_b16 v[58:59], v122 offset:17408
    v_mfma_f32_32x32x16_bf16 v[172:187], v[64:67], v[72:75], v[172:187]
    s_waitcnt lgkmcnt(6)
    v_mfma_f32_32x32x16_bf16 v[124:139], v[28:31], v[36:39], v[124:139]
    ds_read_b128 v[60:63], v110 offset:0
    ds_read_b128 v[64:67], v110 offset:4096
    v_mfma_f32_32x32x16_bf16 v[140:155], v[28:31], v[40:43], v[140:155]
    ds_read_b64_tr_b16 v[68:69], v119 offset:20480
    ds_read_b64_tr_b16 v[70:71], v119 offset:21504
    v_mfma_f32_32x32x16_bf16 v[156:171], v[32:35], v[36:39], v[156:171]
    ds_read_b64_tr_b16 v[72:73], v122 offset:20480
    ds_read_b64_tr_b16 v[74:75], v122 offset:21504
    v_mfma_f32_32x32x16_bf16 v[172:187], v[32:35], v[40:43], v[172:187]
    s_waitcnt lgkmcnt(6)
    v_mfma_f32_32x32x16_bf16 v[124:139], v[44:47], v[52:55], v[124:139]
    ds_read_b128 v[28:31], v113 offset:0
    ds_read_b128 v[32:35], v113 offset:4096
    v_mfma_f32_32x32x16_bf16 v[140:155], v[44:47], v[56:59], v[140:155]
    ds_read_b64_tr_b16 v[36:37], v119 offset:24576
    ds_read_b64_tr_b16 v[38:39], v119 offset:25600
    v_mfma_f32_32x32x16_bf16 v[156:171], v[48:51], v[52:55], v[156:171]
    ds_read_b64_tr_b16 v[40:41], v122 offset:24576
    ds_read_b64_tr_b16 v[42:43], v122 offset:25600
    v_mfma_f32_32x32x16_bf16 v[172:187], v[48:51], v[56:59], v[172:187]
    s_waitcnt lgkmcnt(6)
    v_mfma_f32_32x32x16_bf16 v[124:139], v[60:63], v[68:71], v[124:139]
    ds_read_b128 v[44:47], v116 offset:0
    ds_read_b128 v[48:51], v116 offset:4096
    v_mfma_f32_32x32x16_bf16 v[140:155], v[60:63], v[72:75], v[140:155]
    ds_read_b64_tr_b16 v[52:53], v119 offset:28672
    ds_read_b64_tr_b16 v[54:55], v119 offset:29696
    v_mfma_f32_32x32x16_bf16 v[156:171], v[64:67], v[68:71], v[156:171]
    ds_read_b64_tr_b16 v[56:57], v122 offset:28672
    ds_read_b64_tr_b16 v[58:59], v122 offset:29696
    v_mfma_f32_32x32x16_bf16 v[172:187], v[64:67], v[72:75], v[172:187]
    s_barrier
    s_waitcnt vmcnt(0)
    s_nop 0
    v_readfirstlane_b32 s17, v19
    s_nop 3
    s_cmp_lg_u32 s17, 0
    s_cbranch_scc1 L_nonce0n_ok
    s_mov_b32 s42, 0
L_nonce0n_spin:
    s_sleep 1
    v_mov_b32 v20, 0
    buffer_load_dword v19, v20, s[44:47], 0 offen sc1
    s_add_u32 s42, s42, 1
    s_cmp_ge_u32 s42, 1048576
    s_cbranch_scc1 L_nonce0n_ok
    s_waitcnt vmcnt(0)
    v_readfirstlane_b32 s17, v19
    s_nop 3
    s_cmp_eq_u32 s17, 0
    s_cbranch_scc1 L_nonce0n_spin
L_nonce0n_ok:
    s_waitcnt lgkmcnt(6)
    v_mfma_f32_32x32x16_bf16 v[124:139], v[28:31], v[36:39], v[124:139]
    ds_read_b128 v[60:63], v107 offset:32768
    ds_read_b128 v[64:67], v107 offset:36864
    v_mfma_f32_32x32x16_bf16 v[140:155], v[28:31], v[40:43], v[140:155]
    ds_read_b64_tr_b16 v[68:69], v119 offset:49152
    ds_read_b64_tr_b16 v[70:71], v119 offset:50176
    v_mfma_f32_32x32x16_bf16 v[156:171], v[32:35], v[36:39], v[156:171]
    ds_read_b64_tr_b16 v[72:73], v122 offset:49152
    ds_read_b64_tr_b16 v[74:75], v122 offset:50176
    v_mfma_f32_32x32x16_bf16 v[172:187], v[32:35], v[40:43], v[172:187]
    s_waitcnt lgkmcnt(6)
    v_mfma_f32_32x32x16_bf16 v[124:139], v[44:47], v[52:55], v[124:139]
    ds_read_b128 v[28:31], v110 offset:32768
    ds_read_b128 v[32:35], v110 offset:36864
    v_mfma_f32_32x32x16_bf16 v[140:155], v[44:47], v[56:59], v[140:155]
    ds_read_b64_tr_b16 v[36:37], v119 offset:53248
    ds_read_b64_tr_b16 v[38:39], v119 offset:54272
    v_mfma_f32_32x32x16_bf16 v[156:171], v[48:51], v[52:55], v[156:171]
    ds_read_b64_tr_b16 v[40:41], v122 offset:53248
    ds_read_b64_tr_b16 v[42:43], v122 offset:54272
    v_mfma_f32_32x32x16_bf16 v[172:187], v[48:51], v[56:59], v[172:187]
    s_waitcnt lgkmcnt(6)
    v_mfma_f32_32x32x16_bf16 v[124:139], v[60:63], v[68:71], v[124:139]
    ds_read_b128 v[44:47], v113 offset:32768
    ds_read_b128 v[48:51], v113 offset:36864
    v_mfma_f32_32x32x16_bf16 v[140:155], v[60:63], v[72:75], v[140:155]
    ds_read_b64_tr_b16 v[52:53], v119 offset:57344
    ds_read_b64_tr_b16 v[54:55], v119 offset:58368
    v_mfma_f32_32x32x16_bf16 v[156:171], v[64:67], v[68:71], v[156:171]
    ds_read_b64_tr_b16 v[56:57], v122 offset:57344
    ds_read_b64_tr_b16 v[58:59], v122 offset:58368
    v_mfma_f32_32x32x16_bf16 v[172:187], v[64:67], v[72:75], v[172:187]
    s_waitcnt lgkmcnt(6)
    v_mfma_f32_32x32x16_bf16 v[124:139], v[28:31], v[36:39], v[124:139]
    ds_read_b128 v[60:63], v116 offset:32768
    ds_read_b128 v[64:67], v116 offset:36864
    v_mfma_f32_32x32x16_bf16 v[140:155], v[28:31], v[40:43], v[140:155]
    ds_read_b64_tr_b16 v[68:69], v119 offset:61440
    ds_read_b64_tr_b16 v[70:71], v119 offset:62464
    v_mfma_f32_32x32x16_bf16 v[156:171], v[32:35], v[36:39], v[156:171]
    ds_read_b64_tr_b16 v[72:73], v122 offset:61440
    ds_read_b64_tr_b16 v[74:75], v122 offset:62464
    v_mfma_f32_32x32x16_bf16 v[172:187], v[32:35], v[40:43], v[172:187]
    s_barrier
    s_waitcnt lgkmcnt(6)
    v_mfma_f32_32x32x16_bf16 v[124:139], v[44:47], v[52:55], v[124:139]
    ds_read_b128 v[28:31], v108 offset:0
    ds_read_b128 v[32:35], v108 offset:4096
    v_mfma_f32_32x32x16_bf16 v[140:155], v[44:47], v[56:59], v[140:155]
    ds_read_b64_tr_b16 v[36:37], v120 offset:16384
    ds_read_b64_tr_b16 v[38:39], v120 offset:17408
    v_mfma_f32_32x32x16_bf16 v[156:171], v[48:51], v[52:55], v[156:171]
    ds_read_b64_tr_b16 v[40:41], v123 offset:16384
    ds_read_b64_tr_b16 v[42:43], v123 offset:17408
    v_mfma_f32_32x32x16_bf16 v[172:187], v[48:51], v[56:59], v[172:187]
    s_waitcnt lgkmcnt(6)
    v_mfma_f32_32x32x16_bf16 v[124:139], v[60:63], v[68:71], v[124:139]
    ds_read_b128 v[44:47], v111 offset:0
    ds_read_b128 v[48:51], v111 offset:4096
    v_mfma_f32_32x32x16_bf16 v[140:155], v[60:63], v[72:75], v[140:155]
    ds_read_b64_tr_b16 v[52:53], v120 offset:20480
    ds_read_b64_tr_b16 v[54:55], v120 offset:21504
    v_mfma_f32_32x32x16_bf16 v[156:171], v[64:67], v[68:71], v[156:171]
    ds_read_b64_tr_b16 v[56:57], v123 offset:20480
    ds_read_b64_tr_b16 v[58:59], v123 offset:21504
    v_mfma_f32_32x32x16_bf16 v[172:187], v[64:67], v[72:75], v[172:187]
    s_waitcnt lgkmcnt(6)
    v_mfma_f32_32x32x16_bf16 v[124:139], v[28:31], v[36:39], v[124:139]
    ds_read_b128 v[60:63], v114 offset:0
    ds_read_b128 v[64:67], v114 offset:4096
    v_mfma_f32_32x32x16_bf16 v[140:155], v[28:31], v[40:43], v[140:155]
    ds_read_b64_tr_b16 v[68:69], v120 offset:24576
    ds_read_b64_tr_b16 v[70:71], v120 offset:25600
    v_mfma_f32_32x32x16_bf16 v[156:171], v[32:35], v[36:39], v[156:171]
    ds_read_b64_tr_b16 v[72:73], v123 offset:24576
    ds_read_b64_tr_b16 v[74:75], v123 offset:25600
    v_mfma_f32_32x32x16_bf16 v[172:187], v[32:35], v[40:43], v[172:187]
    s_waitcnt lgkmcnt(6)
    v_mfma_f32_32x32x16_bf16 v[124:139], v[44:47], v[52:55], v[124:139]
    ds_read_b128 v[28:31], v117 offset:0
    ds_read_b128 v[32:35], v117 offset:4096
    v_mfma_f32_32x32x16_bf16 v[140:155], v[44:47], v[56:59], v[140:155]
    ds_read_b64_tr_b16 v[36:37], v120 offset:28672
    ds_read_b64_tr_b16 v[38:39], v120 offset:29696
    v_mfma_f32_32x32x16_bf16 v[156:171], v[48:51], v[52:55], v[156:171]
    ds_read_b64_tr_b16 v[40:41], v123 offset:28672
    ds_read_b64_tr_b16 v[42:43], v123 offset:29696
    v_mfma_f32_32x32x16_bf16 v[172:187], v[48:51], v[56:59], v[172:187]
    s_barrier
    s_waitcnt lgkmcnt(6)
    v_mfma_f32_32x32x16_bf16 v[124:139], v[60:63], v[68:71], v[124:139]
    v_mfma_f32_32x32x16_bf16 v[140:155], v[60:63], v[72:75], v[140:155]
    v_mfma_f32_32x32x16_bf16 v[156:171], v[64:67], v[68:71], v[156:171]
    v_mfma_f32_32x32x16_bf16 v[172:187], v[64:67], v[72:75], v[172:187]
    s_waitcnt lgkmcnt(0)
    v_mfma_f32_32x32x16_bf16 v[124:139], v[28:31], v[36:39], v[124:139]
    v_mfma_f32_32x32x16_bf16 v[140:155], v[28:31], v[40:43], v[140:155]
    v_mfma_f32_32x32x16_bf16 v[156:171], v[32:35], v[36:39], v[156:171]
    v_mfma_f32_32x32x16_bf16 v[172:187], v[32:35], v[40:43], v[172:187]
    s_add_u32 m0, s78, 98304
    s_add_u32 s32, s76, 384
    buffer_load_dwordx4 v242, s[60:63], s32 offen lds
    s_add_u32 m0, s78, 102400
    s_add_u32 s32, s76, 41344
    buffer_load_dwordx4 v242, s[60:63], s32 offen lds
    s_add_u32 m0, s78, 106496
    s_add_u32 s32, s76, 82304
    buffer_load_dwordx4 v242, s[60:63], s32 offen lds
    s_add_u32 m0, s78, 110592
    s_add_u32 s32, s76, 123264
    buffer_load_dwordx4 v242, s[60:63], s32 offen lds
    s_add_u32 m0, s78, 114688
    s_add_u32 s32, s77, 737280
    buffer_load_dwordx4 v243, s[68:71], s32 offen lds
    s_add_u32 m0, s78, 118784
    s_add_u32 s32, s77, 798720
    buffer_load_dwordx4 v243, s[68:71], s32 offen lds
    s_add_u32 m0, s78, 122880
    s_add_u32 s32, s77, 860160
    buffer_load_dwordx4 v243, s[68:71], s32 offen lds
    s_add_u32 m0, s78, 126976
    s_add_u32 s32, s77, 921600
    buffer_load_dwordx4 v243, s[68:71], s32 offen lds
    s_lshl_b32 s80, s72, 7
    s_lshl_b32 s32, s74, 6
    s_add_u32 s80, s80, s32
    v_mul_u32_u24 v21, 320, v3
    s_lshl_b32 s32, s79, 7
    s_lshl_b32 s33, s75, 6
    s_add_u32 s32, s32, s33
    v_add_u32 v22, s32, v2
    v_mul_u32_u24 v23, 3277, v22
    v_lshrrev_b32 v23, 16, v23
    v_mul_u32_u24 v24, 20, v23
    v_sub_u32 v24, v22, v24
    v_mul_u32_u24 v23, 81920, v23
    v_lshl_add_u32 v23, v24, 4, v23
    v_add_u32 v76, v23, v21
    v_add_u32 v22, s32, v2
    v_add_u32 v22, 32, v22
    v_mul_u32_u24 v23, 3277, v22
    v_lshrrev_b32 v23, 16, v23
    v_mul_u32_u24 v24, 20, v23
    v_sub_u32 v24, v22, v24
    v_mul_u32_u24 v23, 81920, v23
    v_lshl_add_u32 v23, v24, 4, v23
    v_add_u32 v77, v23, v21
    s_lshr_b32 s32, s80, 4
    s_mul_i32 s32, s32, 640
    s_add_u32 s81, s32, 10485760
    s_nop 7
    s_nop 3
    v_cvt_pk_bf16_f32 v188, v124, v125
    v_cvt_pk_bf16_f32 v189, v126, v127
    v_cvt_pk_bf16_f32 v190, v128, v129
    v_cvt_pk_bf16_f32 v191, v130, v131
    s_add_u32 s33, s81, 0
    buffer_store_dwordx4 v[188:191], v76, s[8:11], s33 offen sc1
    v_cvt_pk_bf16_f32 v192, v132, v133
    v_cvt_pk_bf16_f32 v193, v134, v135
    v_cvt_pk_bf16_f32 v194, v136, v137
    v_cvt_pk_bf16_f32 v195, v138, v139
    s_add_u32 s33, s81, 640
    buffer_store_dwordx4 v[192:195], v76, s[8:11], s33 offen sc1
    v_cvt_pk_bf16_f32 v196, v140, v141
    v_cvt_pk_bf16_f32 v197, v142, v143
    v_cvt_pk_bf16_f32 v198, v144, v145
    v_cvt_pk_bf16_f32 v199, v146, v147
    s_add_u32 s33, s81, 0
    buffer_store_dwordx4 v[196:199], v77, s[8:11], s33 offen sc1
    v_cvt_pk_bf16_f32 v200, v148, v149
    v_cvt_pk_bf16_f32 v201, v150, v151
    v_cvt_pk_bf16_f32 v202, v152, v153
    v_cvt_pk_bf16_f32 v203, v154, v155
    s_add_u32 s33, s81, 640
    buffer_store_dwordx4 v[200:203], v77, s[8:11], s33 offen sc1
    v_cvt_pk_bf16_f32 v204, v156, v157
    v_cvt_pk_bf16_f32 v205, v158, v159
    v_cvt_pk_bf16_f32 v206, v160, v161
    v_cvt_pk_bf16_f32 v207, v162, v163
    s_add_u32 s33, s81, 1280
    buffer_store_dwordx4 v[204:207], v76, s[8:11], s33 offen sc1
    v_cvt_pk_bf16_f32 v208, v164, v165
    v_cvt_pk_bf16_f32 v209, v166, v167
    v_cvt_pk_bf16_f32 v210, v168, v169
    v_cvt_pk_bf16_f32 v211, v170, v171
    s_add_u32 s33, s81, 1920
    buffer_store_dwordx4 v[208:211], v76, s[8:11], s33 offen sc1
    v_cvt_pk_bf16_f32 v212, v172, v173
    v_cvt_pk_bf16_f32 v213, v174, v175
    v_cvt_pk_bf16_f32 v214, v176, v177
    v_cvt_pk_bf16_f32 v215, v178, v179
    s_add_u32 s33, s81, 1280
    buffer_store_dwordx4 v[212:215], v77, s[8:11], s33 offen sc1
    v_cvt_pk_bf16_f32 v216, v180, v181
    v_cvt_pk_bf16_f32 v217, v182, v183
    v_cvt_pk_bf16_f32 v218, v184, v185
    v_cvt_pk_bf16_f32 v219, v186, v187
    s_add_u32 s33, s81, 1920
    buffer_store_dwordx4 v[216:219], v77, s[8:11], s33 offen sc1
    s_barrier
    s_add_u32 m0, s78, 131072
    s_add_u32 s32, s76, 512
    buffer_load_dwordx4 v242, s[60:63], s32 offen lds
    s_add_u32 m0, s78, 135168
    s_add_u32 s32, s76, 41472
    buffer_load_dwordx4 v242, s[60:63], s32 offen lds
    s_add_u32 m0, s78, 139264
    s_add_u32 s32, s76, 82432
    buffer_load_dwordx4 v242, s[60:63], s32 offen lds
    s_add_u32 m0, s78, 143360
    s_add_u32 s32, s76, 123392
    buffer_load_dwordx4 v242, s[60:63], s32 offen lds
    s_add_u32 m0, s78, 147456
    s_add_u32 s32, s77, 983040
    buffer_load_dwordx4 v243, s[68:71], s32 offen lds
    s_add_u32 m0, s78, 151552
    s_add_u32 s32, s77, 1044480
    buffer_load_dwordx4 v243, s[68:71], s32 offen lds
    s_add_u32 m0, s78, 155648
    s_add_u32 s32, s77, 1105920
    buffer_load_dwordx4 v243, s[68:71], s32 offen lds
    s_add_u32 m0, s78, 159744
    s_add_u32 s32, s77, 1167360
    buffer_load_dwordx4 v243, s[68:71], s32 offen lds
    s_barrier
    s_waitcnt vmcnt(0)
    s_add_u32 m0, s78, 0
    s_add_u32 s32, s76, 640
    buffer_load_dwordx4 v242, s[60:63], s32 offen lds
    s_add_u32 m0, s78, 4096
    s_add_u32 s32, s76, 41600
    buffer_load_dwordx4 v242, s[60:63], s32 offen lds
    s_add_u32 m0, s78, 8192
    s_add_u32 s32, s76, 82560
    buffer_load_dwordx4 v242, s[60:63], s32 offen lds
    s_add_u32 m0, s78, 12288
    s_add_u32 s32, s76, 123520
    buffer_load_dwordx4 v242, s[60:63], s32 offen lds
    s_add_u32 m0, s78, 16384
    s_add_u32 s32, s77, 1228800
    buffer_load_dwordx4 v243, s[68:71], s32 offen lds
    s_add_u32 m0, s78, 20480
    s_add_u32 s32, s77, 1290240
    buffer_load_dwordx4 v243, s[68:71], s32 offen lds
    s_add_u32 m0, s78, 24576
    s_add_u32 s32, s77, 1351680
    buffer_load_dwordx4 v243, s[68:71], s32 offen lds
    s_add_u32 m0, s78, 28672
    s_add_u32 s32, s77, 1413120
    buffer_load_dwordx4 v243, s[68:71], s32 offen lds
    s_barrier
    s_add_u32 m0, s78, 32768
    s_add_u32 s32, s76, 768
    buffer_load_dwordx4 v242, s[60:63], s32 offen lds
    s_add_u32 m0, s78, 36864
    s_add_u32 s32, s76, 41728
    buffer_load_dwordx4 v242, s[60:63], s32 offen lds
    s_add_u32 m0, s78, 40960
    s_add_u32 s32, s76, 82688
    buffer_load_dwordx4 v242, s[60:63], s32 offen lds
    s_add_u32 m0, s78, 45056
    s_add_u32 s32, s76, 123648
    buffer_load_dwordx4 v242, s[60:63], s32 offen lds
    s_add_u32 m0, s78, 49152
    s_add_u32 s32, s77, 1474560
    buffer_load_dwordx4 v243, s[68:71], s32 offen lds
    s_add_u32 m0, s78, 53248
    s_add_u32 s32, s77, 1536000
    buffer_load_dwordx4 v243, s[68:71], s32 offen lds
    s_add_u32 m0, s78, 57344
    s_add_u32 s32, s77, 1597440
    buffer_load_dwordx4 v243, s[68:71], s32 offen lds
    s_add_u32 m0, s78, 61440
    s_add_u32 s32, s77, 1658880
    buffer_load_dwordx4 v243, s[68:71], s32 offen lds
    s_cmp_lg_u32 s16, 0
    s_cbranch_scc1 L_w0_puban
    v_mov_b32 v20, s17
    v_mov_b32 v21, 0
    s_add_u32 s32, s91, 22634496
    s_mov_b64 exec, 1
    buffer_store_dword v20, v21, s[8:11], s32 offen sc1
    s_mov_b64 exec, -1
L_w0_puban:
    s_barrier
    s_add_u32 m0, s78, 65536
    s_add_u32 s32, s76, 896
    buffer_load_dwordx4 v242, s[60:63], s32 offen lds
    s_add_u32 m0, s78, 69632
    s_add_u32 s32, s76, 41856
    buffer_load_dwordx4 v242, s[60:63], s32 offen lds
    s_add_u32 m0, s78, 73728
    s_add_u32 s32, s76, 82816
    buffer_load_dwordx4 v242, s[60:63], s32 offen lds
    s_add_u32 m0, s78, 77824
    s_add_u32 s32, s76, 123776
    buffer_load_dwordx4 v242, s[60:63], s32 offen lds
    s_add_u32 m0, s78, 81920
    s_add_u32 s32, s77, 1720320
    buffer_load_dwordx4 v243, s[68:71], s32 offen lds
    s_add_u32 m0, s78, 86016
    s_add_u32 s32, s77, 1781760
    buffer_load_dwordx4 v243, s[68:71], s32 offen lds
    s_add_u32 m0, s78, 90112
    s_add_u32 s32, s77, 1843200
    buffer_load_dwordx4 v243, s[68:71], s32 offen lds
    s_add_u32 m0, s78, 94208
    s_add_u32 s32, s77, 1904640
    buffer_load_dwordx4 v243, s[68:71], s32 offen lds
    s_waitcnt vmcnt(16)
    s_barrier
    s_add_u32 m0, s78, 98304
    s_add_u32 s32, s76, 1024
    buffer_load_dwordx4 v242, s[60:63], s32 offen lds
    s_add_u32 m0, s78, 102400
    s_add_u32 s32, s76, 41984
    buffer_load_dwordx4 v242, s[60:63], s32 offen lds
    s_add_u32 m0, s78, 106496
    s_add_u32 s32, s76, 82944
    buffer_load_dwordx4 v242, s[60:63], s32 offen lds
    s_add_u32 m0, s78, 110592
    s_add_u32 s32, s76, 123904
    buffer_load_dwordx4 v242, s[60:63], s32 offen lds
    s_add_u32 m0, s78, 114688
    s_add_u32 s32, s77, 1966080
    buffer_load_dwordx4 v243, s[68:71], s32 offen lds
    s_add_u32 m0, s78, 118784
    s_add_u32 s32, s77, 2027520
    buffer_load_dwordx4 v243, s[68:71], s32 offen lds
    s_add_u32 m0, s78, 122880
    s_add_u32 s32, s77, 2088960
    buffer_load_dwordx4 v243, s[68:71], s32 offen lds
    s_add_u32 m0, s78, 126976
    s_add_u32 s32, s77, 2150400
    buffer_load_dwordx4 v243, s[68:71], s32 offen lds
    s_waitcnt vmcnt(16)
    s_barrier
    s_add_u32 m0, s78, 131072
    s_add_u32 s32, s76, 1152
    buffer_load_dwordx4 v242, s[60:63], s32 offen lds
    s_add_u32 m0, s78, 135168
    s_add_u32 s32, s76, 42112
    buffer_load_dwordx4 v242, s[60:63], s32 offen lds
    s_add_u32 m0, s78, 139264
    s_add_u32 s32, s76, 83072
    buffer_load_dwordx4 v242, s[60:63], s32 offen lds
    s_add_u32 m0, s78, 143360
    s_add_u32 s32, s76, 124032
    buffer_load_dwordx4 v242, s[60:63], s32 offen lds
    s_add_u32 m0, s78, 147456
    s_add_u32 s32, s77, 2211840
    buffer_load_dwordx4 v243, s[68:71], s32 offen lds
    s_add_u32 m0, s78, 151552
    s_add_u32 s32, s77, 2273280
    buffer_load_dwordx4 v243, s[68:71], s32 offen lds
    s_add_u32 m0, s78, 155648
    s_add_u32 s32, s77, 2334720
    buffer_load_dwordx4 v243, s[68:71], s32 offen lds
    s_add_u32 m0, s78, 159744
    s_add_u32 s32, s77, 2396160
    buffer_load_dwordx4 v243, s[68:71], s32 offen lds
    s_cmp_lg_u32 s16, 0
    s_cbranch_scc1 L_w0_f1n_i
    s_mov_b32 s32, 22634496
    buffer_load_dword v19, v232, s[8:11], s32 offen sc1
    s_mov_b32 s32, 22634496
    buffer_load_dword v235, v233, s[8:11], s32 offen sc1
L_w0_f1n_i:
    s_waitcnt vmcnt(16)
    s_barrier
    s_waitcnt vmcnt(8)
    s_barrier
    s_cmp_lg_u32 s16, 0
    s_cbranch_scc1 L_w0_f1n_c
    s_waitcnt vmcnt(0)
    v_cmp_eq_u32 vcc, s17, v19
    v_cmp_eq_u32 s[36:37], s17, v235
    s_nop 3
    s_and_b64 vcc, vcc, s[36:37]
    s_nop 3
    s_cmp_eq_u64 vcc, exec
    s_cbranch_scc1 L_f1n_ok
    s_mov_b32 s42, 0
L_f1n_spin:
    s_sleep 2
    s_mov_b32 s32, 22634496
    buffer_load_dword v19, v232, s[8:11], s32 offen sc1
    s_mov_b32 s32, 22634496
    buffer_load_dword v235, v233, s[8:11], s32 offen sc1
    s_add_u32 s42, s42, 1
    s_cmp_ge_u32 s42, 1048576
    s_cbranch_scc1 L_f1n_ok
    s_waitcnt vmcnt(0)
    v_cmp_eq_u32 vcc, s17, v19
    v_cmp_eq_u32 s[36:37], s17, v235
    s_nop 3
    s_and_b64 vcc, vcc, s[36:37]
    s_nop 3
    s_cmp_eq_u64 vcc, exec
    s_cbranch_scc0 L_f1n_spin
L_f1n_ok:
L_w0_f1n_c:
    s_waitcnt vmcnt(0)
    s_barrier
    s_add_u32 m0, s21, 0
    v_mad_u32_u24 v250, v247, 0, v244
    buffer_load_dwordx4 v250, s[8:11], 0 offen sc1 lds
    s_add_u32 m0, s21, 1024
    v_mad_u32_u24 v250, v248, 0, v245
    buffer_load_dwordx4 v250, s[8:11], 0 offen sc1 lds
    s_add_u32 m0, s21, 2048
    v_mad_u32_u24 v250, v249, 0, v246
    s_mov_b32 exec_hi, 0xffff
    buffer_load_dwordx4 v250, s[8:11], 0 offen sc1 lds
    s_mov_b32 exec_hi, -1
    buffer_load_dwordx4 v[100:103], v236, s[8:11], s88 offen sc1
    v_mov_b32 v104, 0
    v_mov_b32 v105, 0
    s_mov_b32 exec_hi, 0
    buffer_load_dwordx2 v[104:105], v237, s[8:11], s89 offen sc1
    s_mov_b32 exec_hi, -1
    s_add_u32 m0, s21, 22528
    v_mad_u32_u24 v250, v247, 1, v244
    buffer_load_dwordx4 v250, s[8:11], 0 offen sc1 lds
    s_add_u32 m0, s21, 23552
    v_mad_u32_u24 v250, v248, 1, v245
    buffer_load_dwordx4 v250, s[8:11], 0 offen sc1 lds
    s_add_u32 m0, s21, 24576
    v_mad_u32_u24 v250, v249, 1, v246
    s_mov_b32 exec_hi, 0xffff
    buffer_load_dwordx4 v250, s[8:11], 0 offen sc1 lds
    s_mov_b32 exec_hi, -1
    s_add_u32 m0, s21, 45056
    v_mad_u32_u24 v250, v247, 2, v244
    buffer_load_dwordx4 v250, s[8:11], 0 offen sc1 lds
    s_add_u32 m0, s21, 46080
    v_mad_u32_u24 v250, v248, 2, v245
    buffer_load_dwordx4 v250, s[8:11], 0 offen sc1 lds
    s_add_u32 m0, s21, 47104
    v_mad_u32_u24 v250, v249, 2, v246
    s_mov_b32 exec_hi, 0xffff
    buffer_load_dwordx4 v250, s[8:11], 0 offen sc1 lds
    s_mov_b32 exec_hi, -1
    v_and_b32 v20, 255, v0
    v_mul_u32_u24 v21, 3277, v20
    v_lshrrev_b32 v21, 16, v21
    v_mul_u32_u24 v21, 20, v21
    v_cmp_eq_u32 vcc, v21, v20
    v_mov_b32 v24, 0
    v_mov_b32 v25, 0x3f803f80
    v_cndmask_b32 v24, v24, v25, vcc
    v_mov_b32 v25, v24
    v_mov_b32 v26, v24
    v_mov_b32 v27, v24
    v_lshlrev_b32 v20, 4, v20
    v_add_u32 v20, 90112, v20
    ds_write_b128 v20, v[24:27]
    v_and_b32 v20, 255, v0
    v_add_u32 v20, 256, v20
    v_mul_u32_u24 v21, 3277, v20
    v_lshrrev_b32 v21, 16, v21
    v_mul_u32_u24 v21, 20, v21
    v_cmp_eq_u32 vcc, v21, v20
    v_mov_b32 v24, 0
    v_mov_b32 v25, 0x3f803f80
    v_cndmask_b32 v24, v24, v25, vcc
    v_mov_b32 v25, v24
    v_mov_b32 v26, v24
    v_mov_b32 v27, v24
    v_cmp_gt_u32 vcc, 336, v20
    v_lshlrev_b32 v20, 4, v20
    v_add_u32 v20, 90112, v20
    s_and_saveexec_b64 s[36:37], vcc
    s_cbranch_execz L_pat_donen
    ds_write_b128 v20, v[24:27]
L_pat_donen:
    s_mov_b64 exec, -1
    s_waitcnt lgkmcnt(0)
    s_waitcnt vmcnt(0)
    s_barrier
    s_branch L_attn
L_g1n:
    s_waitcnt vmcnt(16)
    s_barrier
    s_add_u32 m0, s78, 98304
    s_add_u32 s32, s76, 384
    buffer_load_dwordx4 v242, s[60:63], s32 offen lds
    s_add_u32 m0, s78, 102400
    s_add_u32 s32, s76, 41344
    buffer_load_dwordx4 v242, s[60:63], s32 offen lds
    s_add_u32 m0, s78, 106496
    s_add_u32 s32, s76, 82304
    buffer_load_dwordx4 v242, s[60:63], s32 offen lds
    s_add_u32 m0, s78, 110592
    s_add_u32 s32, s76, 123264
    buffer_load_dwordx4 v242, s[60:63], s32 offen lds
    s_add_u32 m0, s78, 114688
    s_add_u32 s32, s77, 737280
    buffer_load_dwordx4 v243, s[64:67], s32 offen lds
    s_add_u32 m0, s78, 118784
    s_add_u32 s32, s77, 798720
    buffer_load_dwordx4 v243, s[64:67], s32 offen lds
    s_add_u32 m0, s78, 122880
    s_add_u32 s32, s77, 860160
    buffer_load_dwordx4 v243, s[64:67], s32 offen lds
    s_add_u32 m0, s78, 126976
    s_add_u32 s32, s77, 921600
    buffer_load_dwordx4 v243, s[64:67], s32 offen lds
    v_lshrrev_b32 v22, 1, v2
    v_and_b32 v22, 7, v22
    v_xor_b32 v22, v22, v3
    v_lshlrev_b32 v22, 4, v22
    s_lshl_b32 s32, s74, 6
    v_add_u32 v23, s32, v2
    v_lshl_add_u32 v106, v23, 7, v22
    v_xor_b32 v109, 32, v106
    v_xor_b32 v112, 64, v106
    v_xor_b32 v115, 96, v106
    v_add_u32 v107, 0x10000, v106
    v_add_u32 v108, 0x20000, v106
    v_add_u32 v110, 0x10000, v109
    v_add_u32 v111, 0x20000, v109
    v_add_u32 v113, 0x10000, v112
    v_add_u32 v114, 0x20000, v112
    v_add_u32 v116, 0x10000, v115
    v_add_u32 v117, 0x20000, v115
    v_bfe_u32 v22, v1, 2, 2
    v_lshl_add_u32 v23, v3, 3, v22
    v_lshlrev_b32 v23, 8, v23
    v_bfe_u32 v24, v1, 4, 1
    v_lshlrev_b32 v24, 5, v24
    v_add_u32 v23, v23, v24
    v_and_b32 v24, 3, v1
    v_lshlrev_b32 v24, 3, v24
    v_add_u32 v23, v23, v24
    s_lshl_b32 s32, s75, 1
    s_add_u32 s32, s32, 0
    v_xor_b32 v24, s32, v22
    v_lshl_add_u32 v118, v24, 6, v23
    v_add_u32 v119, 0x10000, v118
    v_add_u32 v120, 0x20000, v118
    s_lshl_b32 s32, s75, 1
    s_add_u32 s32, s32, 1
    v_xor_b32 v24, s32, v22
    v_lshl_add_u32 v121, v24, 6, v23
    v_add_u32 v122, 0x10000, v121
    v_add_u32 v123, 0x20000, v121
    s_waitcnt vmcnt(16)
    s_barrier
    s_add_u32 m0, s78, 131072
    s_add_u32 s32, s76, 512
    buffer_load_dwordx4 v242, s[60:63], s32 offen lds
    s_add_u32 m0, s78, 135168
    s_add_u32 s32, s76, 41472
    buffer_load_dwordx4 v242, s[60:63], s32 offen lds
    s_add_u32 m0, s78, 139264
    s_add_u32 s32, s76, 82432
    buffer_load_dwordx4 v242, s[60:63], s32 offen lds
    s_add_u32 m0, s78, 143360
    s_add_u32 s32, s76, 123392
    buffer_load_dwordx4 v242, s[60:63], s32 offen lds
    s_add_u32 m0, s78, 147456
    s_add_u32 s32, s77, 983040
    buffer_load_dwordx4 v243, s[64:67], s32 offen lds
    s_add_u32 m0, s78, 151552
    s_add_u32 s32, s77, 1044480
    buffer_load_dwordx4 v243, s[64:67], s32 offen lds
    s_add_u32 m0, s78, 155648
    s_add_u32 s32, s77, 1105920
    buffer_load_dwordx4 v243, s[64:67], s32 offen lds
    s_add_u32 m0, s78, 159744
    s_add_u32 s32, s77, 1167360
    buffer_load_dwordx4 v243, s[64:67], s32 offen lds
    s_lshl_b32 s91, s73, 4
    s_add_u32 s91, s91, s72
    s_lshl_b32 s91, s91, 2
    s_and_b32 s32, s2, 7
    s_lshl_b32 s32, s32, 2
    s_lshr_b32 s33, s2, 3
    s_and_b32 s33, s33, 3
    s_add_u32 s18, s32, s33
    s_lshr_b32 s19, s2, 5
    s_lshr_b32 s32, s18, 1
    s_mul_i32 s32, s32, 5
    s_add_u32 s43, s32, 2
    s_and_b32 s33, s18, 1
    s_mul_i32 s33, s33, 3
    s_add_u32 s20, s32, s33
    s_mul_i32 s57, s18, 81920
    s_mul_i32 s21, s16, 2816
    s_mul_i32 s22, s16, 2560
    s_lshl_b32 s29, s19, 8
    s_lshl_b32 s32, s16, 5
    s_add_u32 s29, s29, s32
    s_lshl_b32 s31, s19, 2
    s_lshr_b32 s32, s16, 1
    s_add_u32 s31, s31, s32
    s_and_b32 s33, s16, 1
    s_lshl_b32 s30, s31, 6
    s_add_u32 s30, s30, s33
    s_mov_b32 s40, 0xfffff
    s_mov_b32 s41, 0xfffff
    v_lshlrev_b32 v236, 15, v3
    v_lshl_add_u32 v236, v2, 4, v236
    v_lshlrev_b32 v237, 4, v2
    v_lshlrev_b32 v238, 2, v2
    s_lshl_b32 s32, s29, 4
    s_lshl_b32 s88, s20, 15
    s_add_u32 s88, s88, s32
    s_lshl_b32 s89, s43, 15
    s_add_u32 s89, s89, s32
    s_and_b32 s33, s18, 1
    s_lshl_b32 s33, s33, 3
    s_add_u32 s89, s89, s33
    s_lshl_b32 s90, s29, 2
    s_add_u32 s90, s90, 22609920
    s_waitcnt vmcnt(16)
    s_barrier
    s_add_u32 m0, s78, 0
    s_add_u32 s32, s76, 640
    buffer_load_dwordx4 v242, s[60:63], s32 offen lds
    s_add_u32 m0, s78, 4096
    s_add_u32 s32, s76, 41600
    buffer_load_dwordx4 v242, s[60:63], s32 offen lds
    s_add_u32 m0, s78, 8192
    s_add_u32 s32, s76, 82560
    buffer_load_dwordx4 v242, s[60:63], s32 offen lds
    s_add_u32 m0, s78, 12288
    s_add_u32 s32, s76, 123520
    buffer_load_dwordx4 v242, s[60:63], s32 offen lds
    s_add_u32 m0, s78, 16384
    s_add_u32 s32, s77, 1228800
    buffer_load_dwordx4 v243, s[64:67], s32 offen lds
    s_add_u32 m0, s78, 20480
    s_add_u32 s32, s77, 1290240
    buffer_load_dwordx4 v243, s[64:67], s32 offen lds
    s_add_u32 m0, s78, 24576
    s_add_u32 s32, s77, 1351680
    buffer_load_dwordx4 v243, s[64:67], s32 offen lds
    s_add_u32 m0, s78, 28672
    s_add_u32 s32, s77, 1413120
    buffer_load_dwordx4 v243, s[64:67], s32 offen lds
    s_and_b32 s33, s18, 1
    s_lshl_b32 s33, s33, 3
    v_lshlrev_b32 v20, 12, v3
    v_lshl_add_u32 v20, v2, 4, v20
    v_lshlrev_b32 v21, 4, v2
    v_add_u32 v21, s33, v21
    v_mul_u32_u24 v22, 320, v3
    v_lshl_add_u32 v22, v2, 4, v22
    v_add_u32 v23, 90112, v22
    v_cmp_gt_u32 vcc, 20, v2
    v_add_u32 v4, 0, v20
    v_add_u32 v8, 0, v21
    v_add_u32 v24, 12288, v22
    v_cndmask_b32 v12, v23, v24, vcc
    v_add_u32 v5, 22528, v20
    v_add_u32 v9, 22528, v21
    v_add_u32 v24, 34816, v22
    v_cndmask_b32 v13, v23, v24, vcc
    v_add_u32 v6, 45056, v20
    v_add_u32 v10, 45056, v21
    v_add_u32 v24, 57344, v22
    v_cndmask_b32 v14, v23, v24, vcc
    v_add_u32 v7, 67584, v20
    v_add_u32 v11, 67584, v21
    v_add_u32 v24, 79872, v22
    v_cndmask_b32 v15, v23, v24, vcc
    s_lshl_b32 s34, s20, 15
    s_add_u32 s34, s34, 5242880
    s_lshl_b32 s35, s43, 15
    s_add_u32 s35, s35, 5234688
    s_add_u32 s36, s57, 10473472
    v_add_u32 v20, s21, v16
    v_lshrrev_b32 v21, 12, v20
    v_and_b32 v22, 4095, v20
    v_lshl_add_u32 v22, v21, 15, v22
    v_add_u32 v22, s34, v22
    v_add_u32 v23, s35, v20
    v_add_u32 v24, s36, v20
    v_cmp_eq_u32 vcc, 2, v21
    v_mov_b32 v25, 4096
    v_mov_b32 v26, 10240
    v_cndmask_b32 v22, v22, v23, vcc
    v_cmp_le_u32 vcc, 3, v21
    s_nop 1
    v_cndmask_b32 v244, v22, v24, vcc
    v_cndmask_b32 v247, v25, v26, vcc
    v_add_u32 v20, s21, v16
    v_add_u32 v20, 1024, v20
    v_lshrrev_b32 v21, 12, v20
    v_and_b32 v22, 4095, v20
    v_lshl_add_u32 v22, v21, 15, v22
    v_add_u32 v22, s34, v22
    v_add_u32 v23, s35, v20
    v_add_u32 v24, s36, v20
    v_cmp_eq_u32 vcc, 2, v21
    v_mov_b32 v25, 4096
    v_mov_b32 v26, 10240
    v_cndmask_b32 v22, v22, v23, vcc
    v_cmp_le_u32 vcc, 3, v21
    s_nop 1
    v_cndmask_b32 v245, v22, v24, vcc
    v_cndmask_b32 v248, v25, v26, vcc
    v_add_u32 v20, s21, v16
    v_add_u32 v20, 2048, v20
    v_lshrrev_b32 v21, 12, v20
    v_and_b32 v22, 4095, v20
    v_lshl_add_u32 v22, v21, 15, v22
    v_add_u32 v22, s34, v22
    v_add_u32 v23, s35, v20
    v_add_u32 v24, s36, v20
    v_cmp_eq_u32 vcc, 2, v21
    v_mov_b32 v25, 4096
    v_mov_b32 v26, 10240
    v_cndmask_b32 v22, v22, v23, vcc
    v_cmp_le_u32 vcc, 3, v21
    s_nop 1
    v_cndmask_b32 v246, v22, v24, vcc
    v_cndmask_b32 v249, v25, v26, vcc
    s_waitcnt vmcnt(16)
    s_barrier
    s_add_u32 m0, s78, 32768
    s_add_u32 s32, s76, 768
    buffer_load_dwordx4 v242, s[60:63], s32 offen lds
    s_add_u32 m0, s78, 36864
    s_add_u32 s32, s76, 41728
    buffer_load_dwordx4 v242, s[60:63], s32 offen lds
    s_add_u32 m0, s78, 40960
    s_add_u32 s32, s76, 82688
    buffer_load_dwordx4 v242, s[60:63], s32 offen lds
    s_add_u32 m0, s78, 45056
    s_add_u32 s32, s76, 123648
    buffer_load_dwordx4 v242, s[60:63], s32 offen lds
    s_add_u32 m0, s78, 49152
    s_add_u32 s32, s77, 1474560
    buffer_load_dwordx4 v243, s[64:67], s32 offen lds
    s_add_u32 m0, s78, 53248
    s_add_u32 s32, s77, 1536000
    buffer_load_dwordx4 v243, s[64:67], s32 offen lds
    s_add_u32 m0, s78, 57344
    s_add_u32 s32, s77, 1597440
    buffer_load_dwordx4 v243, s[64:67], s32 offen lds
    s_add_u32 m0, s78, 61440
    s_add_u32 s32, s77, 1658880
    buffer_load_dwordx4 v243, s[64:67], s32 offen lds
    s_lshr_b32 s32, s18, 1
    s_mul_i32 s32, s32, 5
    s_and_b32 s33, s18, 1
    s_lshl_b32 s34, s33, 1
    s_add_u32 s34, s34, s32
    v_add_u32 v20, s34, v3
    v_lshlrev_b32 v20, 15, v20
    v_lshl_add_u32 v252, v2, 4, v20
    v_lshl_add_u32 v253, v2, 5, v20
    s_add_u32 s32, s32, 4
    s_lshl_b32 s32, s32, 15
    s_lshl_b32 s33, s33, 3
    s_add_u32 s32, s32, s33
    v_lshlrev_b32 v20, 4, v2
    v_add_u32 v254, s32, v20
    v_lshlrev_b32 v20, 5, v2
    v_add_u32 v255, s32, v20
    s_mul_i32 s32, s18, 20
    s_add_u32 s33, s32, 19
    s_lshr_b32 s32, s32, 7
    s_lshr_b32 s33, s33, 7
    v_bfe_u32 v20, v1, 4, 1
    s_sub_u32 s34, s33, s32
    v_mul_u32_u24 v21, s34, v20
    v_add_u32 v21, s32, v21
    v_mul_u32_u24 v22, 5, v3
    v_add_u32 v22, 5, v22
    v_add_u32 v22, v22, v21
    v_and_b32 v23, 15, v1
    v_lshl_add_u32 v22, v22, 4, v23
    v_lshlrev_b32 v232, 2, v22
    v_add_u32 v22, 240, v23
    v_lshlrev_b32 v241, 2, v22
    v_and_b32 v24, 1, v1
    s_lshl_b32 s35, s19, 1
    v_add_u32 v24, s35, v24
    v_lshl_add_u32 v24, v21, 4, v24
    v_lshlrev_b32 v233, 2, v24
    v_and_b32 v20, 1, v1
    v_mul_u32_u24 v21, s34, v20
    v_add_u32 v21, s32, v21
    v_bfe_u32 v22, v1, 1, 2
    v_min_u32 v22, 2, v22
    v_mul_u32_u24 v22, 5, v22
    v_add_u32 v21, v21, v22
    s_lshl_b32 s35, s19, 1
    v_bfe_u32 v22, v1, 3, 2
    v_min_u32 v22, 2, v22
    v_add_u32 v22, s35, v22
    v_max_u32 v22, 1, v22
    v_subrev_u32 v22, 1, v22
    v_lshl_add_u32 v21, v21, 4, v22
    v_lshlrev_b32 v234, 2, v21
    s_waitcnt vmcnt(16)
    s_barrier
    s_add_u32 m0, s78, 65536
    s_add_u32 s32, s76, 896
    buffer_load_dwordx4 v242, s[60:63], s32 offen lds
    s_add_u32 m0, s78, 69632
    s_add_u32 s32, s76, 41856
    buffer_load_dwordx4 v242, s[60:63], s32 offen lds
    s_add_u32 m0, s78, 73728
    s_add_u32 s32, s76, 82816
    buffer_load_dwordx4 v242, s[60:63], s32 offen lds
    s_add_u32 m0, s78, 77824
    s_add_u32 s32, s76, 123776
    buffer_load_dwordx4 v242, s[60:63], s32 offen lds
    s_add_u32 m0, s78, 81920
    s_add_u32 s32, s77, 1720320
    buffer_load_dwordx4 v243, s[64:67], s32 offen lds
    s_add_u32 m0, s78, 86016
    s_add_u32 s32, s77, 1781760
    buffer_load_dwordx4 v243, s[64:67], s32 offen lds
    s_add_u32 m0, s78, 90112
    s_add_u32 s32, s77, 1843200
    buffer_load_dwordx4 v243, s[64:67], s32 offen lds
    s_add_u32 m0, s78, 94208
    s_add_u32 s32, s77, 1904640
    buffer_load_dwordx4 v243, s[64:67], s32 offen lds
    v_lshlrev_b32 v220, 15, v3
    v_lshl_add_u32 v220, v2, 4, v220
    v_lshlrev_b32 v221, 4, v2
    v_and_b32 v22, 25, v2
    v_bfe_u32 v23, v2, 1, 1
    v_lshl_or_b32 v22, v23, 2, v22
    v_bfe_u32 v23, v2, 2, 1
    v_lshl_or_b32 v22, v23, 1, v22
    v_lshlrev_b32 v23, 15, v3
    v_lshl_add_u32 v222, v22, 4, v23
    v_lshlrev_b32 v223, 4, v22
    v_mul_u32_u24 v24, 320, v3
    v_lshl_add_u32 v224, v2, 4, v24
    s_and_b32 s33, s16, 1
    s_lshl_b32 s33, s33, 10
    s_lshl_b32 s32, s31, 5
    s_add_u32 s34, s33, s32
    s_lshl_b32 s32, s20, 15
    s_lshl_b32 s33, s43, 15
    s_and_b32 s35, s18, 1
    s_lshl_b32 s35, s35, 3
    s_add_u32 s33, s33, s35
    s_lshl_b32 s35, s34, 4
    s_add_u32 s48, s35, s32
    s_add_u32 s48, s48, 2621440
    s_add_u32 s49, s35, s33
    s_add_u32 s49, s49, 2621440
    s_add_u32 s50, s35, s32
    s_add_u32 s50, s50, 7864320
    s_add_u32 s51, s35, s33
    s_add_u32 s51, s51, 7864320
    s_lshr_b32 s35, s34, 4
    s_mul_i32 s35, s35, 640
    s_add_u32 s52, s35, s57
    s_add_u32 s52, s52, 13107200
    s_cmp_eq_u32 s31, 0
    s_cselect_b32 s35, 0, 32
    s_sub_u32 s34, s34, s35
    s_lshl_b32 s35, s34, 4
    s_add_u32 s53, s35, s32
    s_add_u32 s53, s53, 7864320
    s_add_u32 s54, s35, s33
    s_add_u32 s54, s54, 7864320
    s_lshr_b32 s35, s34, 4
    s_mul_i32 s35, s35, 640
    s_add_u32 s55, s35, s57
    s_add_u32 s55, s55, 13107200
    s_lshl_b32 s56, s30, 2
    s_add_u32 s56, s56, 22609920
    s_waitcnt vmcnt(16)
    s_barrier
    s_add_u32 m0, s78, 98304
    s_add_u32 s32, s76, 1024
    buffer_load_dwordx4 v242, s[60:63], s32 offen lds
    s_add_u32 m0, s78, 102400
    s_add_u32 s32, s76, 41984
    buffer_load_dwordx4 v242, s[60:63], s32 offen lds
    s_add_u32 m0, s78, 106496
    s_add_u32 s32, s76, 82944
    buffer_load_dwordx4 v242, s[60:63], s32 offen lds
    s_add_u32 m0, s78, 110592
    s_add_u32 s32, s76, 123904
    buffer_load_dwordx4 v242, s[60:63], s32 offen lds
    s_add_u32 m0, s78, 114688
    s_add_u32 s32, s77, 1966080
    buffer_load_dwordx4 v243, s[64:67], s32 offen lds
    s_add_u32 m0, s78, 118784
    s_add_u32 s32, s77, 2027520
    buffer_load_dwordx4 v243, s[64:67], s32 offen lds
    s_add_u32 m0, s78, 122880
    s_add_u32 s32, s77, 2088960
    buffer_load_dwordx4 v243, s[64:67], s32 offen lds
    s_add_u32 m0, s78, 126976
    s_add_u32 s32, s77, 2150400
    buffer_load_dwordx4 v243, s[64:67], s32 offen lds
    s_lshr_b32 s33, s18, 3
    s_lshl_b32 s32, s19, 2
    s_add_u32 s33, s33, s32
    s_and_b32 s34, s18, 7
    s_and_b32 s35, s16, 3
    s_lshr_b32 s28, s16, 2
    s_lshl_b32 s25, s33, 8
    s_mul_i32 s23, s16, 20480
    s_mul_i32 s32, s34, 1280
    s_add_u32 s23, s23, s32
    s_add_u32 s23, s23, 20971520
    s_lshl_b32 s33, s33, 6
    s_lshl_b32 s35, s35, 4
    s_add_u32 s33, s33, s35
    s_mul_i32 s27, s33, 1280
    s_mul_i32 s32, s34, 160
    s_add_u32 s27, s27, s32
    s_lshl_b32 s24, s33, 4
    s_mul_i32 s32, s28, 1310720
    s_add_u32 s24, s24, s32
    s_add_u32 s24, s24, 15728640
    s_lshl_b32 s26, s31, 6
    s_lshl_b32 s32, s18, 1
    s_add_u32 s26, s26, s32
    s_and_b32 s32, s16, 1
    s_add_u32 s26, s26, s32
    s_lshl_b32 s26, s26, 2
    v_lshlrev_b32 v231, 2, v1
    v_mov_b32 v225, v16
    v_add_u32 v20, 1024, v16
    v_add_u32 v21, 9984, v16
    v_cmp_gt_u32 vcc, 16, v1
    v_add_u32 v227, 11008, v16
    v_lshrrev_b32 v22, 4, v1
    v_cndmask_b32 v226, v21, v20, vcc
    v_and_b32 v23, 15, v1
    v_lshlrev_b32 v24, 15, v22
    v_lshl_add_u32 v228, v23, 4, v24
    v_mul_u32_u24 v24, 1280, v22
    v_lshl_add_u32 v229, v23, 4, v24
    v_mul_u32_u24 v24, 1280, v23
    v_lshl_add_u32 v230, v22, 3, v24
    s_waitcnt vmcnt(16)
    s_barrier
    s_add_u32 m0, s78, 131072
    s_add_u32 s32, s76, 1152
    buffer_load_dwordx4 v242, s[60:63], s32 offen lds
    s_add_u32 m0, s78, 135168
    s_add_u32 s32, s76, 42112
    buffer_load_dwordx4 v242, s[60:63], s32 offen lds
    s_add_u32 m0, s78, 139264
    s_add_u32 s32, s76, 83072
    buffer_load_dwordx4 v242, s[60:63], s32 offen lds
    s_add_u32 m0, s78, 143360
    s_add_u32 s32, s76, 124032
    buffer_load_dwordx4 v242, s[60:63], s32 offen lds
    s_add_u32 m0, s78, 147456
    s_add_u32 s32, s77, 2211840
    buffer_load_dwordx4 v243, s[64:67], s32 offen lds
    s_add_u32 m0, s78, 151552
    s_add_u32 s32, s77, 2273280
    buffer_load_dwordx4 v243, s[64:67], s32 offen lds
    s_add_u32 m0, s78, 155648
    s_add_u32 s32, s77, 2334720
    buffer_load_dwordx4 v243, s[64:67], s32 offen lds
    s_add_u32 m0, s78, 159744
    s_add_u32 s32, s77, 2396160
    buffer_load_dwordx4 v243, s[64:67], s32 offen lds
    s_waitcnt vmcnt(16)
    s_barrier
    s_add_u32 m0, s78, 0
    s_add_u32 s32, s76, 0
    buffer_load_dwordx4 v242, s[60:63], s32 offen lds
    s_add_u32 m0, s78, 4096
    s_add_u32 s32, s76, 40960
    buffer_load_dwordx4 v242, s[60:63], s32 offen lds
    s_add_u32 m0, s78, 8192
    s_add_u32 s32, s76, 81920
    buffer_load_dwordx4 v242, s[60:63], s32 offen lds
    s_add_u32 m0, s78, 12288
    s_add_u32 s32, s76, 122880
    buffer_load_dwordx4 v242, s[60:63], s32 offen lds
    s_add_u32 m0, s78, 16384
    s_add_u32 s32, s77, 0
    buffer_load_dwordx4 v243, s[68:71], s32 offen lds
    s_add_u32 m0, s78, 20480
    s_add_u32 s32, s77, 61440
    buffer_load_dwordx4 v243, s[68:71], s32 offen lds
    s_add_u32 m0, s78, 24576
    s_add_u32 s32, s77, 122880
    buffer_load_dwordx4 v243, s[68:71], s32 offen lds
    s_add_u32 m0, s78, 28672
    s_add_u32 s32, s77, 184320
    buffer_load_dwordx4 v243, s[68:71], s32 offen lds
    s_waitcnt vmcnt(16)
    s_barrier
    s_add_u32 m0, s78, 32768
    s_add_u32 s32, s76, 128
    buffer_load_dwordx4 v242, s[60:63], s32 offen lds
    s_add_u32 m0, s78, 36864
    s_add_u32 s32, s76, 41088
    buffer_load_dwordx4 v242, s[60:63], s32 offen lds
    s_add_u32 m0, s78, 40960
    s_add_u32 s32, s76, 82048
    buffer_load_dwordx4 v242, s[60:63], s32 offen lds
    s_add_u32 m0, s78, 45056
    s_add_u32 s32, s76, 123008
    buffer_load_dwordx4 v242, s[60:63], s32 offen lds
    s_add_u32 m0, s78, 49152
    s_add_u32 s32, s77, 245760
    buffer_load_dwordx4 v243, s[68:71], s32 offen lds
    s_add_u32 m0, s78, 53248
    s_add_u32 s32, s77, 307200
    buffer_load_dwordx4 v243, s[68:71], s32 offen lds
    s_add_u32 m0, s78, 57344
    s_add_u32 s32, s77, 368640
    buffer_load_dwordx4 v243, s[68:71], s32 offen lds
    s_add_u32 m0, s78, 61440
    s_add_u32 s32, s77, 430080
    buffer_load_dwordx4 v243, s[68:71], s32 offen lds
    s_waitcnt vmcnt(16)
    s_barrier
    s_add_u32 m0, s78, 65536
    s_add_u32 s32, s76, 256
    buffer_load_dwordx4 v242, s[60:63], s32 offen lds
    s_add_u32 m0, s78, 69632
    s_add_u32 s32, s76, 41216
    buffer_load_dwordx4 v242, s[60:63], s32 offen lds
    s_add_u32 m0, s78, 73728
    s_add_u32 s32, s76, 82176
    buffer_load_dwordx4 v242, s[60:63], s32 offen lds
    s_add_u32 m0, s78, 77824
    s_add_u32 s32, s76, 123136
    buffer_load_dwordx4 v242, s[60:63], s32 offen lds
    s_add_u32 m0, s78, 81920
    s_add_u32 s32, s77, 491520
    buffer_load_dwordx4 v243, s[68:71], s32 offen lds
    s_add_u32 m0, s78, 86016
    s_add_u32 s32, s77, 552960
    buffer_load_dwordx4 v243, s[68:71], s32 offen lds
    s_add_u32 m0, s78, 90112
    s_add_u32 s32, s77, 614400
    buffer_load_dwordx4 v243, s[68:71], s32 offen lds
    s_add_u32 m0, s78, 94208
    s_add_u32 s32, s77, 675840
    buffer_load_dwordx4 v243, s[68:71], s32 offen lds
    s_waitcnt vmcnt(16)
    s_barrier
    s_setprio 1
    ds_read_b128 v[44:47], v106 offset:0
    ds_read_b128 v[48:51], v106 offset:4096
    ds_read_b64_tr_b16 v[52:53], v118 offset:16384
    ds_read_b64_tr_b16 v[54:55], v118 offset:17408
    ds_read_b64_tr_b16 v[56:57], v121 offset:16384
    ds_read_b64_tr_b16 v[58:59], v121 offset:17408
    ds_read_b128 v[60:63], v109 offset:0
    ds_read_b128 v[64:67], v109 offset:4096
    ds_read_b64_tr_b16 v[68:69], v118 offset:20480
    ds_read_b64_tr_b16 v[70:71], v118 offset:21504
    ds_read_b64_tr_b16 v[72:73], v121 offset:20480
    ds_read_b64_tr_b16 v[74:75], v121 offset:21504
    s_waitcnt lgkmcnt(6)
    v_mfma_f32_32x32x16_bf16 v[124:139], v[44:47], v[52:55], 0
    ds_read_b128 v[28:31], v112 offset:0
    ds_read_b128 v[32:35], v112 offset:4096
    v_mfma_f32_32x32x16_bf16 v[140:155], v[44:47], v[56:59], 0
    ds_read_b64_tr_b16 v[36:37], v118 offset:24576
    ds_read_b64_tr_b16 v[38:39], v118 offset:25600
    v_mfma_f32_32x32x16_bf16 v[156:171], v[48:51], v[52:55], 0
    ds_read_b64_tr_b16 v[40:41], v121 offset:24576
    ds_read_b64_tr_b16 v[42:43], v121 offset:25600
    v_mfma_f32_32x32x16_bf16 v[172:187], v[48:51], v[56:59], 0
    s_waitcnt lgkmcnt(6)
    v_mfma_f32_32x32x16_bf16 v[124:139], v[60:63], v[68:71], v[124:139]
    ds_read_b128 v[44:47], v115 offset:0
    ds_read_b128 v[48:51], v115 offset:4096
    v_mfma_f32_32x32x16_bf16 v[140:155], v[60:63], v[72:75], v[140:155]
    ds_read_b64_tr_b16 v[52:53], v118 offset:28672
    ds_read_b64_tr_b16 v[54:55], v118 offset:29696
    v_mfma_f32_32x32x16_bf16 v[156:171], v[64:67], v[68:71], v[156:171]
    ds_read_b64_tr_b16 v[56:57], v121 offset:28672
    ds_read_b64_tr_b16 v[58:59], v121 offset:29696
    v_mfma_f32_32x32x16_bf16 v[172:187], v[64:67], v[72:75], v[172:187]
    s_waitcnt vmcnt(8)
    s_barrier
    s_waitcnt lgkmcnt(6)
    v_mfma_f32_32x32x16_bf16 v[124:139], v[28:31], v[36:39], v[124:139]
    ds_read_b128 v[60:63], v106 offset:32768
    ds_read_b128 v[64:67], v106 offset:36864
    v_mfma_f32_32x32x16_bf16 v[140:155], v[28:31], v[40:43], v[140:155]
    ds_read_b64_tr_b16 v[68:69], v118 offset:49152
    ds_read_b64_tr_b16 v[70:71], v118 offset:50176
    v_mfma_f32_32x32x16_bf16 v[156:171], v[32:35], v[36:39], v[156:171]
    ds_read_b64_tr_b16 v[72:73], v121 offset:49152
    ds_read_b64_tr_b16 v[74:75], v121 offset:50176
    v_mfma_f32_32x32x16_bf16 v[172:187], v[32:35], v[40:43], v[172:187]
    s_waitcnt lgkmcnt(6)
    v_mfma_f32_32x32x16_bf16 v[124:139], v[44:47], v[52:55], v[124:139]
    ds_read_b128 v[28:31], v109 offset:32768
    ds_read_b128 v[32:35], v109 offset:36864
    v_mfma_f32_32x32x16_bf16 v[140:155], v[44:47], v[56:59], v[140:155]
    ds_read_b64_tr_b16 v[36:37], v118 offset:53248
    ds_read_b64_tr_b16 v[38:39], v118 offset:54272
    v_mfma_f32_32x32x16_bf16 v[156:171], v[48:51], v[52:55], v[156:171]
    ds_read_b64_tr_b16 v[40:41], v121 offset:53248
    ds_read_b64_tr_b16 v[42:43], v121 offset:54272
    v_mfma_f32_32x32x16_bf16 v[172:187], v[48:51], v[56:59], v[172:187]
    s_waitcnt lgkmcnt(6)
    v_mfma_f32_32x32x16_bf16 v[124:139], v[60:63], v[68:71], v[124:139]
    ds_read_b128 v[44:47], v112 offset:32768
    ds_read_b128 v[48:51], v112 offset:36864
    v_mfma_f32_32x32x16_bf16 v[140:155], v[60:63], v[72:75], v[140:155]
    ds_read_b64_tr_b16 v[52:53], v118 offset:57344
    ds_read_b64_tr_b16 v[54:55], v118 offset:58368
    v_mfma_f32_32x32x16_bf16 v[156:171], v[64:67], v[68:71], v[156:171]
    ds_read_b64_tr_b16 v[56:57], v121 offset:57344
    ds_read_b64_tr_b16 v[58:59], v121 offset:58368
    v_mfma_f32_32x32x16_bf16 v[172:187], v[64:67], v[72:75], v[172:187]
    s_waitcnt lgkmcnt(6)
    v_mfma_f32_32x32x16_bf16 v[124:139], v[28:31], v[36:39], v[124:139]
    ds_read_b128 v[60:63], v115 offset:32768
    ds_read_b128 v[64:67], v115 offset:36864
    v_mfma_f32_32x32x16_bf16 v[140:155], v[28:31], v[40:43], v[140:155]
    ds_read_b64_tr_b16 v[68:69], v118 offset:61440
    ds_read_b64_tr_b16 v[70:71], v118 offset:62464
    v_mfma_f32_32x32x16_bf16 v[156:171], v[32:35], v[36:39], v[156:171]
    ds_read_b64_tr_b16 v[72:73], v121 offset:61440
    ds_read_b64_tr_b16 v[74:75], v121 offset:62464
    v_mfma_f32_32x32x16_bf16 v[172:187], v[32:35], v[40:43], v[172:187]
    s_waitcnt vmcnt(0)
    s_barrier
    s_waitcnt lgkmcnt(6)
    v_mfma_f32_32x32x16_bf16 v[124:139], v[44:47], v[52:55], v[124:139]
    ds_read_b128 v[28:31], v107 offset:0
    ds_read_b128 v[32:35], v107 offset:4096
    v_mfma_f32_32x32x16_bf16 v[140:155], v[44:47], v[56:59], v[140:155]
    ds_read_b64_tr_b16 v[36:37], v119 offset:16384
    ds_read_b64_tr_b16 v[38:39], v119 offset:17408
    v_mfma_f32_32x32x16_bf16 v[156:171], v[48:51], v[52:55], v[156:171]
    ds_read_b64_tr_b16 v[40:41], v122 offset:16384
    ds_read_b64_tr_b16 v[42:43], v122 offset:17408
    v_mfma_f32_32x32x16_bf16 v[172:187], v[48:51], v[56:59], v[172:187]
    s_waitcnt lgkmcnt(6)
    v_mfma_f32_32x32x16_bf16 v[124:139], v[60:63], v[68:71], v[124:139]
    ds_read_b128 v[44:47], v110 offset:0
    ds_read_b128 v[48:51], v110 offset:4096
    v_mfma_f32_32x32x16_bf16 v[140:155], v[60:63], v[72:75], v[140:155]
    ds_read_b64_tr_b16 v[52:53], v119 offset:20480
    ds_read_b64_tr_b16 v[54:55], v119 offset:21504
    v_mfma_f32_32x32x16_bf16 v[156:171], v[64:67], v[68:71], v[156:171]
    ds_read_b64_tr_b16 v[56:57], v122 offset:20480
    ds_read_b64_tr_b16 v[58:59], v122 offset:21504
    v_mfma_f32_32x32x16_bf16 v[172:187], v[64:67], v[72:75], v[172:187]
    s_waitcnt lgkmcnt(6)
    v_mfma_f32_32x32x16_bf16 v[124:139], v[28:31], v[36:39], v[124:139]
    ds_read_b128 v[60:63], v113 offset:0
    ds_read_b128 v[64:67], v113 offset:4096
    v_mfma_f32_32x32x16_bf16 v[140:155], v[28:31], v[40:43], v[140:155]
    ds_read_b64_tr_b16 v[68:69], v119 offset:24576
    ds_read_b64_tr_b16 v[70:71], v119 offset:25600
    v_mfma_f32_32x32x16_bf16 v[156:171], v[32:35], v[36:39], v[156:171]
    ds_read_b64_tr_b16 v[72:73], v122 offset:24576
    ds_read_b64_tr_b16 v[74:75], v122 offset:25600
    v_mfma_f32_32x32x16_bf16 v[172:187], v[32:35], v[40:43], v[172:187]
    s_waitcnt lgkmcnt(6)
    v_mfma_f32_32x32x16_bf16 v[124:139], v[44:47], v[52:55], v[124:139]
    ds_read_b128 v[28:31], v116 offset:0
    ds_read_b128 v[32:35], v116 offset:4096
    v_mfma_f32_32x32x16_bf16 v[140:155], v[44:47], v[56:59], v[140:155]
    ds_read_b64_tr_b16 v[36:37], v119 offset:28672
    ds_read_b64_tr_b16 v[38:39], v119 offset:29696
    v_mfma_f32_32x32x16_bf16 v[156:171], v[48:51], v[52:55], v[156:171]
    ds_read_b64_tr_b16 v[40:41], v122 offset:28672
    ds_read_b64_tr_b16 v[42:43], v122 offset:29696
    v_mfma_f32_32x32x16_bf16 v[172:187], v[48:51], v[56:59], v[172:187]
    s_barrier
    s_waitcnt lgkmcnt(6)
    v_mfma_f32_32x32x16_bf16 v[124:139], v[60:63], v[68:71], v[124:139]
    ds_read_b128 v[44:47], v107 offset:32768
    ds_read_b128 v[48:51], v107 offset:36864
    v_mfma_f32_32x32x16_bf16 v[140:155], v[60:63], v[72:75], v[140:155]
    ds_read_b64_tr_b16 v[52:53], v119 offset:49152
    ds_read_b64_tr_b16 v[54:55], v119 offset:50176
    v_mfma_f32_32x32x16_bf16 v[156:171], v[64:67], v[68:71], v[156:171]
    ds_read_b64_tr_b16 v[56:57], v122 offset:49152
    ds_read_b64_tr_b16 v[58:59], v122 offset:50176
    v_mfma_f32_32x32x16_bf16 v[172:187], v[64:67], v[72:75], v[172:187]
    s_waitcnt lgkmcnt(6)
    v_mfma_f32_32x32x16_bf16 v[124:139], v[28:31], v[36:39], v[124:139]
    ds_read_b128 v[60:63], v110 offset:32768
    ds_read_b128 v[64:67], v110 offset:36864
    v_mfma_f32_32x32x16_bf16 v[140:155], v[28:31], v[40:43], v[140:155]
    ds_read_b64_tr_b16 v[68:69], v119 offset:53248
    ds_read_b64_tr_b16 v[70:71], v119 offset:54272
    v_mfma_f32_32x32x16_bf16 v[156:171], v[32:35], v[36:39], v[156:171]
    ds_read_b64_tr_b16 v[72:73], v122 offset:53248
    ds_read_b64_tr_b16 v[74:75], v122 offset:54272
    v_mfma_f32_32x32x16_bf16 v[172:187], v[32:35], v[40:43], v[172:187]
    s_waitcnt lgkmcnt(6)
    v_mfma_f32_32x32x16_bf16 v[124:139], v[44:47], v[52:55], v[124:139]
    ds_read_b128 v[28:31], v113 offset:32768
    ds_read_b128 v[32:35], v113 offset:36864
    v_mfma_f32_32x32x16_bf16 v[140:155], v[44:47], v[56:59], v[140:155]
    ds_read_b64_tr_b16 v[36:37], v119 offset:57344
    ds_read_b64_tr_b16 v[38:39], v119 offset:58368
    v_mfma_f32_32x32x16_bf16 v[156:171], v[48:51], v[52:55], v[156:171]
    ds_read_b64_tr_b16 v[40:41], v122 offset:57344
    ds_read_b64_tr_b16 v[42:43], v122 offset:58368
    v_mfma_f32_32x32x16_bf16 v[172:187], v[48:51], v[56:59], v[172:187]
    s_waitcnt lgkmcnt(6)
    v_mfma_f32_32x32x16_bf16 v[124:139], v[60:63], v[68:71], v[124:139]
    ds_read_b128 v[44:47], v116 offset:32768
    ds_read_b128 v[48:51], v116 offset:36864
    v_mfma_f32_32x32x16_bf16 v[140:155], v[60:63], v[72:75], v[140:155]
    ds_read_b64_tr_b16 v[52:53], v119 offset:61440
    ds_read_b64_tr_b16 v[54:55], v119 offset:62464
    v_mfma_f32_32x32x16_bf16 v[156:171], v[64:67], v[68:71], v[156:171]
    ds_read_b64_tr_b16 v[56:57], v122 offset:61440
    ds_read_b64_tr_b16 v[58:59], v122 offset:62464
    v_mfma_f32_32x32x16_bf16 v[172:187], v[64:67], v[72:75], v[172:187]
    s_barrier
    s_waitcnt lgkmcnt(6)
    v_mfma_f32_32x32x16_bf16 v[124:139], v[28:31], v[36:39], v[124:139]
    ds_read_b128 v[60:63], v108 offset:0
    ds_read_b128 v[64:67], v108 offset:4096
    v_mfma_f32_32x32x16_bf16 v[140:155], v[28:31], v[40:43], v[140:155]
    ds_read_b64_tr_b16 v[68:69], v120 offset:16384
    ds_read_b64_tr_b16 v[70:71], v120 offset:17408
    v_mfma_f32_32x32x16_bf16 v[156:171], v[32:35], v[36:39], v[156:171]
    ds_read_b64_tr_b16 v[72:73], v123 offset:16384
    ds_read_b64_tr_b16 v[74:75], v123 offset:17408
    v_mfma_f32_32x32x16_bf16 v[172:187], v[32:35], v[40:43], v[172:187]
    s_waitcnt lgkmcnt(6)
    v_mfma_f32_32x32x16_bf16 v[124:139], v[44:47], v[52:55], v[124:139]
    ds_read_b128 v[28:31], v111 offset:0
    ds_read_b128 v[32:35], v111 offset:4096
    v_mfma_f32_32x32x16_bf16 v[140:155], v[44:47], v[56:59], v[140:155]
    ds_read_b64_tr_b16 v[36:37], v120 offset:20480
    ds_read_b64_tr_b16 v[38:39], v120 offset:21504
    v_mfma_f32_32x32x16_bf16 v[156:171], v[48:51], v[52:55], v[156:171]
    ds_read_b64_tr_b16 v[40:41], v123 offset:20480
    ds_read_b64_tr_b16 v[42:43], v123 offset:21504
    v_mfma_f32_32x32x16_bf16 v[172:187], v[48:51], v[56:59], v[172:187]
    s_waitcnt lgkmcnt(6)
    v_mfma_f32_32x32x16_bf16 v[124:139], v[60:63], v[68:71], v[124:139]
    ds_read_b128 v[44:47], v114 offset:0
    ds_read_b128 v[48:51], v114 offset:4096
    v_mfma_f32_32x32x16_bf16 v[140:155], v[60:63], v[72:75], v[140:155]
    ds_read_b64_tr_b16 v[52:53], v120 offset:24576
    ds_read_b64_tr_b16 v[54:55], v120 offset:25600
    v_mfma_f32_32x32x16_bf16 v[156:171], v[64:67], v[68:71], v[156:171]
    ds_read_b64_tr_b16 v[56:57], v123 offset:24576
    ds_read_b64_tr_b16 v[58:59], v123 offset:25600
    v_mfma_f32_32x32x16_bf16 v[172:187], v[64:67], v[72:75], v[172:187]
    s_waitcnt lgkmcnt(6)
    v_mfma_f32_32x32x16_bf16 v[124:139], v[28:31], v[36:39], v[124:139]
    ds_read_b128 v[60:63], v117 offset:0
    ds_read_b128 v[64:67], v117 offset:4096
    v_mfma_f32_32x32x16_bf16 v[140:155], v[28:31], v[40:43], v[140:155]
    ds_read_b64_tr_b16 v[68:69], v120 offset:28672
    ds_read_b64_tr_b16 v[70:71], v120 offset:29696
    v_mfma_f32_32x32x16_bf16 v[156:171], v[32:35], v[36:39], v[156:171]
    ds_read_b64_tr_b16 v[72:73], v123 offset:28672
    ds_read_b64_tr_b16 v[74:75], v123 offset:29696
    v_mfma_f32_32x32x16_bf16 v[172:187], v[32:35], v[40:43], v[172:187]
    s_barrier
    s_waitcnt lgkmcnt(6)
    v_mfma_f32_32x32x16_bf16 v[124:139], v[44:47], v[52:55], v[124:139]
    ds_read_b128 v[28:31], v106 offset:0
    ds_read_b128 v[32:35], v106 offset:4096
    v_mfma_f32_32x32x16_bf16 v[140:155], v[44:47], v[56:59], v[140:155]
    ds_read_b64_tr_b16 v[36:37], v118 offset:16384
    ds_read_b64_tr_b16 v[38:39], v118 offset:17408
    v_mfma_f32_32x32x16_bf16 v[156:171], v[48:51], v[52:55], v[156:171]
    ds_read_b64_tr_b16 v[40:41], v121 offset:16384
    ds_read_b64_tr_b16 v[42:43], v121 offset:17408
    v_mfma_f32_32x32x16_bf16 v[172:187], v[48:51], v[56:59], v[172:187]
    s_waitcnt lgkmcnt(6)
    v_mfma_f32_32x32x16_bf16 v[124:139], v[60:63], v[68:71], v[124:139]
    ds_read_b128 v[44:47], v109 offset:0
    ds_read_b128 v[48:51], v109 offset:4096
    v_mfma_f32_32x32x16_bf16 v[140:155], v[60:63], v[72:75], v[140:155]
    ds_read_b64_tr_b16 v[52:53], v118 offset:20480
    ds_read_b64_tr_b16 v[54:55], v118 offset:21504
    v_mfma_f32_32x32x16_bf16 v[156:171], v[64:67], v[68:71], v[156:171]
    ds_read_b64_tr_b16 v[56:57], v121 offset:20480
    ds_read_b64_tr_b16 v[58:59], v121 offset:21504
    v_mfma_f32_32x32x16_bf16 v[172:187], v[64:67], v[72:75], v[172:187]
    s_waitcnt lgkmcnt(6)
    v_mfma_f32_32x32x16_bf16 v[124:139], v[28:31], v[36:39], v[124:139]
    ds_read_b128 v[60:63], v112 offset:0
    ds_read_b128 v[64:67], v112 offset:4096
    v_mfma_f32_32x32x16_bf16 v[140:155], v[28:31], v[40:43], v[140:155]
    ds_read_b64_tr_b16 v[68:69], v118 offset:24576
    ds_read_b64_tr_b16 v[70:71], v118 offset:25600
    v_mfma_f32_32x32x16_bf16 v[156:171], v[32:35], v[36:39], v[156:171]
    ds_read_b64_tr_b16 v[72:73], v121 offset:24576
    ds_read_b64_tr_b16 v[74:75], v121 offset:25600
    v_mfma_f32_32x32x16_bf16 v[172:187], v[32:35], v[40:43], v[172:187]
    s_waitcnt lgkmcnt(6)
    v_mfma_f32_32x32x16_bf16 v[124:139], v[44:47], v[52:55], v[124:139]
    ds_read_b128 v[28:31], v115 offset:0
    ds_read_b128 v[32:35], v115 offset:4096
    v_mfma_f32_32x32x16_bf16 v[140:155], v[44:47], v[56:59], v[140:155]
    ds_read_b64_tr_b16 v[36:37], v118 offset:28672
    ds_read_b64_tr_b16 v[38:39], v118 offset:29696
    v_mfma_f32_32x32x16_bf16 v[156:171], v[48:51], v[52:55], v[156:171]
    ds_read_b64_tr_b16 v[40:41], v121 offset:28672
    ds_read_b64_tr_b16 v[42:43], v121 offset:29696
    v_mfma_f32_32x32x16_bf16 v[172:187], v[48:51], v[56:59], v[172:187]
    s_barrier
    s_waitcnt lgkmcnt(6)
    v_mfma_f32_32x32x16_bf16 v[124:139], v[60:63], v[68:71], v[124:139]
    ds_read_b128 v[44:47], v106 offset:32768
    ds_read_b128 v[48:51], v106 offset:36864
    v_mfma_f32_32x32x16_bf16 v[140:155], v[60:63], v[72:75], v[140:155]
    ds_read_b64_tr_b16 v[52:53], v118 offset:49152
    ds_read_b64_tr_b16 v[54:55], v118 offset:50176
    v_mfma_f32_32x32x16_bf16 v[156:171], v[64:67], v[68:71], v[156:171]
    ds_read_b64_tr_b16 v[56:57], v121 offset:49152
    ds_read_b64_tr_b16 v[58:59], v121 offset:50176
    v_mfma_f32_32x32x16_bf16 v[172:187], v[64:67], v[72:75], v[172:187]
    s_waitcnt lgkmcnt(6)
    v_mfma_f32_32x32x16_bf16 v[124:139], v[28:31], v[36:39], v[124:139]
    ds_read_b128 v[60:63], v109 offset:32768
    ds_read_b128 v[64:67], v109 offset:36864
    v_mfma_f32_32x32x16_bf16 v[140:155], v[28:31], v[40:43], v[140:155]
    ds_read_b64_tr_b16 v[68:69], v118 offset:53248
    ds_read_b64_tr_b16 v[70:71], v118 offset:54272
    v_mfma_f32_32x32x16_bf16 v[156:171], v[32:35], v[36:39], v[156:171]
    ds_read_b64_tr_b16 v[72:73], v121 offset:53248
    ds_read_b64_tr_b16 v[74:75], v121 offset:54272
    v_mfma_f32_32x32x16_bf16 v[172:187], v[32:35], v[40:43], v[172:187]
    s_waitcnt lgkmcnt(6)
    v_mfma_f32_32x32x16_bf16 v[124:139], v[44:47], v[52:55], v[124:139]
    ds_read_b128 v[28:31], v112 offset:32768
    ds_read_b128 v[32:35], v112 offset:36864
    v_mfma_f32_32x32x16_bf16 v[140:155], v[44:47], v[56:59], v[140:155]
    ds_read_b64_tr_b16 v[36:37], v118 offset:57344
    ds_read_b64_tr_b16 v[38:39], v118 offset:58368
    v_mfma_f32_32x32x16_bf16 v[156:171], v[48:51], v[52:55], v[156:171]
    ds_read_b64_tr_b16 v[40:41], v121 offset:57344
    ds_read_b64_tr_b16 v[42:43], v121 offset:58368
    v_mfma_f32_32x32x16_bf16 v[172:187], v[48:51], v[56:59], v[172:187]
    s_waitcnt lgkmcnt(6)
    v_mfma_f32_32x32x16_bf16 v[124:139], v[60:63], v[68:71], v[124:139]
    ds_read_b128 v[44:47], v115 offset:32768
    ds_read_b128 v[48:51], v115 offset:36864
    v_mfma_f32_32x32x16_bf16 v[140:155], v[60:63], v[72:75], v[140:155]
    ds_read_b64_tr_b16 v[52:53], v118 offset:61440
    ds_read_b64_tr_b16 v[54:55], v118 offset:62464
    v_mfma_f32_32x32x16_bf16 v[156:171], v[64:67], v[68:71], v[156:171]
    ds_read_b64_tr_b16 v[56:57], v121 offset:61440
    ds_read_b64_tr_b16 v[58:59], v121 offset:62464
    v_mfma_f32_32x32x16_bf16 v[172:187], v[64:67], v[72:75], v[172:187]
    s_barrier
    s_waitcnt lgkmcnt(6)
    v_mfma_f32_32x32x16_bf16 v[124:139], v[28:31], v[36:39], v[124:139]
    ds_read_b128 v[60:63], v107 offset:0
    ds_read_b128 v[64:67], v107 offset:4096
    v_mfma_f32_32x32x16_bf16 v[140:155], v[28:31], v[40:43], v[140:155]
    ds_read_b64_tr_b16 v[68:69], v119 offset:16384
    ds_read_b64_tr_b16 v[70:71], v119 offset:17408
    v_mfma_f32_32x32x16_bf16 v[156:171], v[32:35], v[36:39], v[156:171]
    ds_read_b64_tr_b16 v[72:73], v122 offset:16384
    ds_read_b64_tr_b16 v[74:75], v122 offset:17408
    v_mfma_f32_32x32x16_bf16 v[172:187], v[32:35], v[40:43], v[172:187]
    s_waitcnt lgkmcnt(6)
    v_mfma_f32_32x32x16_bf16 v[124:139], v[44:47], v[52:55], v[124:139]
    ds_read_b128 v[28:31], v110 offset:0
    ds_read_b128 v[32:35], v110 offset:4096
    v_mfma_f32_32x32x16_bf16 v[140:155], v[44:47], v[56:59], v[140:155]
    ds_read_b64_tr_b16 v[36:37], v119 offset:20480
    ds_read_b64_tr_b16 v[38:39], v119 offset:21504
    v_mfma_f32_32x32x16_bf16 v[156:171], v[48:51], v[52:55], v[156:171]
    ds_read_b64_tr_b16 v[40:41], v122 offset:20480
    ds_read_b64_tr_b16 v[42:43], v122 offset:21504
    v_mfma_f32_32x32x16_bf16 v[172:187], v[48:51], v[56:59], v[172:187]
    s_waitcnt lgkmcnt(6)
    v_mfma_f32_32x32x16_bf16 v[124:139], v[60:63], v[68:71], v[124:139]
    ds_read_b128 v[44:47], v113 offset:0
    ds_read_b128 v[48:51], v113 offset:4096
    v_mfma_f32_32x32x16_bf16 v[140:155], v[60:63], v[72:75], v[140:155]
    ds_read_b64_tr_b16 v[52:53], v119 offset:24576
    ds_read_b64_tr_b16 v[54:55], v119 offset:25600
    v_mfma_f32_32x32x16_bf16 v[156:171], v[64:67], v[68:71], v[156:171]
    ds_read_b64_tr_b16 v[56:57], v122 offset:24576
    ds_read_b64_tr_b16 v[58:59], v122 offset:25600
    v_mfma_f32_32x32x16_bf16 v[172:187], v[64:67], v[72:75], v[172:187]
    s_waitcnt lgkmcnt(6)
    v_mfma_f32_32x32x16_bf16 v[124:139], v[28:31], v[36:39], v[124:139]
    ds_read_b128 v[60:63], v116 offset:0
    ds_read_b128 v[64:67], v116 offset:4096
    v_mfma_f32_32x32x16_bf16 v[140:155], v[28:31], v[40:43], v[140:155]
    ds_read_b64_tr_b16 v[68:69], v119 offset:28672
    ds_read_b64_tr_b16 v[70:71], v119 offset:29696
    v_mfma_f32_32x32x16_bf16 v[156:171], v[32:35], v[36:39], v[156:171]
    ds_read_b64_tr_b16 v[72:73], v122 offset:28672
    ds_read_b64_tr_b16 v[74:75], v122 offset:29696
    v_mfma_f32_32x32x16_bf16 v[172:187], v[32:35], v[40:43], v[172:187]
    s_barrier
    s_waitcnt lgkmcnt(6)
    v_mfma_f32_32x32x16_bf16 v[124:139], v[44:47], v[52:55], v[124:139]
    ds_read_b128 v[28:31], v107 offset:32768
    ds_read_b128 v[32:35], v107 offset:36864
    v_mfma_f32_32x32x16_bf16 v[140:155], v[44:47], v[56:59], v[140:155]
    ds_read_b64_tr_b16 v[36:37], v119 offset:49152
    ds_read_b64_tr_b16 v[38:39], v119 offset:50176
    v_mfma_f32_32x32x16_bf16 v[156:171], v[48:51], v[52:55], v[156:171]
    ds_read_b64_tr_b16 v[40:41], v122 offset:49152
    ds_read_b64_tr_b16 v[42:43], v122 offset:50176
    v_mfma_f32_32x32x16_bf16 v[172:187], v[48:51], v[56:59], v[172:187]
    s_waitcnt lgkmcnt(6)
    v_mfma_f32_32x32x16_bf16 v[124:139], v[60:63], v[68:71], v[124:139]
    ds_read_b128 v[44:47], v110 offset:32768
    ds_read_b128 v[48:51], v110 offset:36864
    v_mfma_f32_32x32x16_bf16 v[140:155], v[60:63], v[72:75], v[140:155]
    ds_read_b64_tr_b16 v[52:53], v119 offset:53248
    ds_read_b64_tr_b16 v[54:55], v119 offset:54272
    v_mfma_f32_32x32x16_bf16 v[156:171], v[64:67], v[68:71], v[156:171]
    ds_read_b64_tr_b16 v[56:57], v122 offset:53248
    ds_read_b64_tr_b16 v[58:59], v122 offset:54272
    v_mfma_f32_32x32x16_bf16 v[172:187], v[64:67], v[72:75], v[172:187]
    s_waitcnt lgkmcnt(6)
    v_mfma_f32_32x32x16_bf16 v[124:139], v[28:31], v[36:39], v[124:139]
    ds_read_b128 v[60:63], v113 offset:32768
    ds_read_b128 v[64:67], v113 offset:36864
    v_mfma_f32_32x32x16_bf16 v[140:155], v[28:31], v[40:43], v[140:155]
    ds_read_b64_tr_b16 v[68:69], v119 offset:57344
    ds_read_b64_tr_b16 v[70:71], v119 offset:58368
    v_mfma_f32_32x32x16_bf16 v[156:171], v[32:35], v[36:39], v[156:171]
    ds_read_b64_tr_b16 v[72:73], v122 offset:57344
    ds_read_b64_tr_b16 v[74:75], v122 offset:58368
    v_mfma_f32_32x32x16_bf16 v[172:187], v[32:35], v[40:43], v[172:187]
    s_waitcnt lgkmcnt(6)
    v_mfma_f32_32x32x16_bf16 v[124:139], v[44:47], v[52:55], v[124:139]
    ds_read_b128 v[28:31], v116 offset:32768
    ds_read_b128 v[32:35], v116 offset:36864
    v_mfma_f32_32x32x16_bf16 v[140:155], v[44:47], v[56:59], v[140:155]
    ds_read_b64_tr_b16 v[36:37], v119 offset:61440
    ds_read_b64_tr_b16 v[38:39], v119 offset:62464
    v_mfma_f32_32x32x16_bf16 v[156:171], v[48:51], v[52:55], v[156:171]
    ds_read_b64_tr_b16 v[40:41], v122 offset:61440
    ds_read_b64_tr_b16 v[42:43], v122 offset:62464
    v_mfma_f32_32x32x16_bf16 v[172:187], v[48:51], v[56:59], v[172:187]
    s_barrier
    s_waitcnt lgkmcnt(6)
    v_mfma_f32_32x32x16_bf16 v[124:139], v[60:63], v[68:71], v[124:139]
    ds_read_b128 v[44:47], v108 offset:0
    ds_read_b128 v[48:51], v108 offset:4096
    v_mfma_f32_32x32x16_bf16 v[140:155], v[60:63], v[72:75], v[140:155]
    ds_read_b64_tr_b16 v[52:53], v120 offset:16384
    ds_read_b64_tr_b16 v[54:55], v120 offset:17408
    v_mfma_f32_32x32x16_bf16 v[156:171], v[64:67], v[68:71], v[156:171]
    ds_read_b64_tr_b16 v[56:57], v123 offset:16384
    ds_read_b64_tr_b16 v[58:59], v123 offset:17408
    v_mfma_f32_32x32x16_bf16 v[172:187], v[64:67], v[72:75], v[172:187]
    s_add_u32 m0, s21, 0
    v_mad_u32_u24 v250, v247, 0, v244
    buffer_load_dwordx4 v250, s[8:11], 0 offen sc1 lds
    s_add_u32 m0, s21, 1024
    v_mad_u32_u24 v250, v248, 0, v245
    buffer_load_dwordx4 v250, s[8:11], 0 offen sc1 lds
    s_waitcnt lgkmcnt(6)
    v_mfma_f32_32x32x16_bf16 v[124:139], v[28:31], v[36:39], v[124:139]
    ds_read_b128 v[60:63], v111 offset:0
    ds_read_b128 v[64:67], v111 offset:4096
    v_mfma_f32_32x32x16_bf16 v[140:155], v[28:31], v[40:43], v[140:155]
    ds_read_b64_tr_b16 v[68:69], v120 offset:20480
    ds_read_b64_tr_b16 v[70:71], v120 offset:21504
    v_mfma_f32_32x32x16_bf16 v[156:171], v[32:35], v[36:39], v[156:171]
    ds_read_b64_tr_b16 v[72:73], v123 offset:20480
    ds_read_b64_tr_b16 v[74:75], v123 offset:21504
    v_mfma_f32_32x32x16_bf16 v[172:187], v[32:35], v[40:43], v[172:187]
    s_add_u32 m0, s21, 2048
    v_mad_u32_u24 v250, v249, 0, v246
    s_mov_b32 exec_hi, 0xffff
    buffer_load_dwordx4 v250, s[8:11], 0 offen sc1 lds
    s_mov_b32 exec_hi, -1
    buffer_load_dwordx4 v[100:103], v236, s[8:11], s88 offen sc1
    s_waitcnt lgkmcnt(6)
    v_mfma_f32_32x32x16_bf16 v[124:139], v[44:47], v[52:55], v[124:139]
    ds_read_b128 v[28:31], v114 offset:0
    ds_read_b128 v[32:35], v114 offset:4096
    v_mfma_f32_32x32x16_bf16 v[140:155], v[44:47], v[56:59], v[140:155]
    ds_read_b64_tr_b16 v[36:37], v120 offset:24576
    ds_read_b64_tr_b16 v[38:39], v120 offset:25600
    v_mfma_f32_32x32x16_bf16 v[156:171], v[48:51], v[52:55], v[156:171]
    ds_read_b64_tr_b16 v[40:41], v123 offset:24576
    ds_read_b64_tr_b16 v[42:43], v123 offset:25600
    v_mfma_f32_32x32x16_bf16 v[172:187], v[48:51], v[56:59], v[172:187]
    v_mov_b32 v104, 0
    v_mov_b32 v105, 0
    s_mov_b32 exec_hi, 0
    buffer_load_dwordx2 v[104:105], v237, s[8:11], s89 offen sc1
    s_mov_b32 exec_hi, -1
    v_mov_b32 v20, 0
    buffer_load_dword v19, v20, s[44:47], 0 offen sc1
    s_waitcnt lgkmcnt(6)
    v_mfma_f32_32x32x16_bf16 v[124:139], v[60:63], v[68:71], v[124:139]
    ds_read_b128 v[44:47], v117 offset:0
    ds_read_b128 v[48:51], v117 offset:4096
    v_mfma_f32_32x32x16_bf16 v[140:155], v[60:63], v[72:75], v[140:155]
    ds_read_b64_tr_b16 v[52:53], v120 offset:28672
    ds_read_b64_tr_b16 v[54:55], v120 offset:29696
    v_mfma_f32_32x32x16_bf16 v[156:171], v[64:67], v[68:71], v[156:171]
    ds_read_b64_tr_b16 v[56:57], v123 offset:28672
    ds_read_b64_tr_b16 v[58:59], v123 offset:29696
    v_mfma_f32_32x32x16_bf16 v[172:187], v[64:67], v[72:75], v[172:187]
    s_waitcnt lgkmcnt(6)
    v_mfma_f32_32x32x16_bf16 v[124:139], v[28:31], v[36:39], v[124:139]
    v_mfma_f32_32x32x16_bf16 v[140:155], v[28:31], v[40:43], v[140:155]
    v_mfma_f32_32x32x16_bf16 v[156:171], v[32:35], v[36:39], v[156:171]
    v_mfma_f32_32x32x16_bf16 v[172:187], v[32:35], v[40:43], v[172:187]
    s_waitcnt lgkmcnt(0)
    v_mfma_f32_32x32x16_bf16 v[124:139], v[44:47], v[52:55], v[124:139]
    v_mfma_f32_32x32x16_bf16 v[140:155], v[44:47], v[56:59], v[140:155]
    v_mfma_f32_32x32x16_bf16 v[156:171], v[48:51], v[52:55], v[156:171]
    v_mfma_f32_32x32x16_bf16 v[172:187], v[48:51], v[56:59], v[172:187]
    s_setprio 0
    s_waitcnt vmcnt(0)
    s_nop 0
    v_readfirstlane_b32 s17, v19
    s_barrier
    s_add_u32 m0, s21, 22528
    v_mad_u32_u24 v250, v247, 1, v244
    buffer_load_dwordx4 v250, s[8:11], 0 offen sc1 lds
    s_add_u32 m0, s21, 23552
    v_mad_u32_u24 v250, v248, 1, v245
    buffer_load_dwordx4 v250, s[8:11], 0 offen sc1 lds
    s_add_u32 m0, s21, 24576
    v_mad_u32_u24 v250, v249, 1, v246
    s_mov_b32 exec_hi, 0xffff
    buffer_load_dwordx4 v250, s[8:11], 0 offen sc1 lds
    s_mov_b32 exec_hi, -1
    s_add_u32 m0, s21, 45056
    v_mad_u32_u24 v250, v247, 2, v244
    buffer_load_dwordx4 v250, s[8:11], 0 offen sc1 lds
    s_add_u32 m0, s21, 46080
    v_mad_u32_u24 v250, v248, 2, v245
    buffer_load_dwordx4 v250, s[8:11], 0 offen sc1 lds
    s_add_u32 m0, s21, 47104
    v_mad_u32_u24 v250, v249, 2, v246
    s_mov_b32 exec_hi, 0xffff
    buffer_load_dwordx4 v250, s[8:11], 0 offen sc1 lds
    s_mov_b32 exec_hi, -1
    s_lshl_b32 s80, s72, 7
    s_lshl_b32 s32, s74, 6
    s_add_u32 s80, s80, s32
    s_lshr_b32 s80, s80, 1
    v_mul_u32_u24 v21, 320, v3
    s_lshl_b32 s32, s79, 7
    s_lshl_b32 s33, s75, 6
    s_add_u32 s32, s32, s33
    v_add_u32 v22, s32, v2
    v_mul_u32_u24 v23, 3277, v22
    v_lshrrev_b32 v23, 16, v23
    v_mul_u32_u24 v24, 20, v23
    v_sub_u32 v24, v22, v24
    v_mul_u32_u24 v23, 81920, v23
    v_lshl_add_u32 v23, v24, 4, v23
    v_add_u32 v76, v23, v21
    v_add_u32 v22, s32, v2
    v_add_u32 v22, 32, v22
    v_mul_u32_u24 v23, 3277, v22
    v_lshrrev_b32 v23, 16, v23
    v_mul_u32_u24 v24, 20, v23
    v_sub_u32 v24, v22, v24
    v_mul_u32_u24 v23, 81920, v23
    v_lshl_add_u32 v23, v24, 4, v23
    v_add_u32 v77, v23, v21
    s_lshr_b32 s32, s80, 4
    s_mul_i32 s32, s32, 640
    s_add_u32 s81, s32, 13107200
    s_nop 7
    s_nop 3
    v_cvt_pk_bf16_f32 v188, v124, v126
    v_cvt_pk_bf16_f32 v189, v128, v130
    v_cvt_pk_bf16_f32 v190, v132, v134
    v_cvt_pk_bf16_f32 v191, v136, v138
    s_add_u32 s33, s81, 0
    buffer_store_dwordx4 v[188:191], v76, s[8:11], s33 offen sc1
    v_cvt_pk_bf16_f32 v192, v125, v127
    v_cvt_pk_bf16_f32 v193, v129, v131
    v_cvt_pk_bf16_f32 v194, v133, v135
    v_cvt_pk_bf16_f32 v195, v137, v139
    s_add_u32 s33, s81, 40960
    buffer_store_dwordx4 v[192:195], v76, s[8:11], s33 offen sc1
    v_cvt_pk_bf16_f32 v196, v140, v142
    v_cvt_pk_bf16_f32 v197, v144, v146
    v_cvt_pk_bf16_f32 v198, v148, v150
    v_cvt_pk_bf16_f32 v199, v152, v154
    s_add_u32 s33, s81, 0
    buffer_store_dwordx4 v[196:199], v77, s[8:11], s33 offen sc1
    v_cvt_pk_bf16_f32 v200, v141, v143
    v_cvt_pk_bf16_f32 v201, v145, v147
    v_cvt_pk_bf16_f32 v202, v149, v151
    v_cvt_pk_bf16_f32 v203, v153, v155
    s_add_u32 s33, s81, 40960
    buffer_store_dwordx4 v[200:203], v77, s[8:11], s33 offen sc1
    v_cvt_pk_bf16_f32 v204, v156, v158
    v_cvt_pk_bf16_f32 v205, v160, v162
    v_cvt_pk_bf16_f32 v206, v164, v166
    v_cvt_pk_bf16_f32 v207, v168, v170
    s_add_u32 s33, s81, 640
    buffer_store_dwordx4 v[204:207], v76, s[8:11], s33 offen sc1
    v_cvt_pk_bf16_f32 v208, v157, v159
    v_cvt_pk_bf16_f32 v209, v161, v163
    v_cvt_pk_bf16_f32 v210, v165, v167
    v_cvt_pk_bf16_f32 v211, v169, v171
    s_add_u32 s33, s81, 41600
    buffer_store_dwordx4 v[208:211], v76, s[8:11], s33 offen sc1
    v_cvt_pk_bf16_f32 v212, v172, v174
    v_cvt_pk_bf16_f32 v213, v176, v178
    v_cvt_pk_bf16_f32 v214, v180, v182
    v_cvt_pk_bf16_f32 v215, v184, v186
    s_add_u32 s33, s81, 640
    buffer_store_dwordx4 v[212:215], v77, s[8:11], s33 offen sc1
    v_cvt_pk_bf16_f32 v216, v173, v175
    v_cvt_pk_bf16_f32 v217, v177, v179
    v_cvt_pk_bf16_f32 v218, v181, v183
    v_cvt_pk_bf16_f32 v219, v185, v187
    s_add_u32 s33, s81, 41600
    buffer_store_dwordx4 v[216:219], v77, s[8:11], s33 offen sc1
    s_nop 3
    s_cmp_lg_u32 s17, 0
    s_cbranch_scc1 L_nonce1n_ok
    s_mov_b32 s42, 0
L_nonce1n_spin:
    s_sleep 1
    v_mov_b32 v20, 0
    buffer_load_dword v19, v20, s[44:47], 0 offen sc1
    s_add_u32 s42, s42, 1
    s_cmp_ge_u32 s42, 1048576
    s_cbranch_scc1 L_nonce1n_ok
    s_waitcnt vmcnt(0)
    v_readfirstlane_b32 s17, v19
    s_nop 3
    s_cmp_eq_u32 s17, 0
    s_cbranch_scc1 L_nonce1n_spin
L_nonce1n_ok:
L_attn:
    ds_read_b128 v[108:111], v4 offset:0
    ds_read_b64 v[112:113], v8 offset:8192
    s_add_u32 m0, s21, 67584
    v_mad_u32_u24 v250, v247, 3, v244
    buffer_load_dwordx4 v250, s[8:11], 0 offen sc1 lds
    s_add_u32 m0, s21, 68608
    v_mad_u32_u24 v250, v248, 3, v245
    buffer_load_dwordx4 v250, s[8:11], 0 offen sc1 lds
    s_add_u32 m0, s21, 69632
    v_mad_u32_u24 v250, v249, 3, v246
    s_mov_b32 exec_hi, 0xffff
    buffer_load_dwordx4 v250, s[8:11], 0 offen sc1 lds
    s_mov_b32 exec_hi, -1
    v_cmp_gt_u32 vcc, 20, v2
    v_mov_b32 v20, 0
    v_mov_b32 v21, 5120
    v_cndmask_b32 v20, v20, v21, vcc
    v_add_u32 v232, v12, v20
    v_add_u32 v233, v13, v20
    v_add_u32 v236, v14, v20
    v_add_u32 v237, v15, v20
    v_cmp_eq_u32 vcc, 20, v2
    v_mov_b32 v26, 0
    v_mov_b32 v27, 0x3f803f80
    v_cndmask_b32 v26, v26, v27, vcc
    v_mov_b32 v148, v26
    v_mov_b32 v149, v26
    v_mov_b32 v150, v26
    v_mov_b32 v151, v26
    v_mov_b32 v152, v26
    v_mov_b32 v153, v26
    v_mov_b32 v154, v26
    v_mov_b32 v155, v26
    v_mov_b32 v156, v26
    v_mov_b32 v157, v26
    v_mov_b32 v158, v26
    v_mov_b32 v159, v26
    v_mov_b32 v128, 0
    v_mov_b32 v129, 0
    s_waitcnt lgkmcnt(0)
    v_mfma_f32_32x32x16_bf16 v[28:43], v[108:111], v[100:103], 0
    v_mfma_f32_32x32x8_bf16 v[28:43], v[112:113], v[104:105], v[28:43]
    s_nop 7
    s_nop 5
    v_max3_f32 v20, v28, v29, v30
    v_max3_f32 v20, v20, v31, v32
    v_max3_f32 v20, v20, v33, v34
    v_max3_f32 v20, v20, v35, v36
    v_max3_f32 v20, v20, v37, v38
    v_max3_f32 v20, v20, v39, v40
    v_max3_f32 v20, v20, v41, v42
    v_max_f32 v20, v20, v43
    v_mov_b32 v21, v20
    s_nop 1
    v_permlane32_swap_b32 v20, v21
    s_nop 1
    v_max_f32 v20, v20, v21
    v_sub_f32 v60, 0, v20
    v_sub_f32 v61, 0, v20
    v_sub_f32 v62, 0, v20
    v_sub_f32 v63, 0, v20
    v_sub_f32 v64, 0, v20
    v_sub_f32 v65, 0, v20
    v_sub_f32 v66, 0, v20
    v_sub_f32 v67, 0, v20
    v_sub_f32 v68, 0, v20
    v_sub_f32 v69, 0, v20
    v_sub_f32 v70, 0, v20
    v_sub_f32 v71, 0, v20
    v_sub_f32 v72, 0, v20
    v_sub_f32 v73, 0, v20
    v_sub_f32 v74, 0, v20
    v_sub_f32 v75, 0, v20
    s_nop 1
    v_mfma_f32_32x32x16_bf16 v[28:43], v[108:111], v[100:103], v[60:75]
    v_mfma_f32_32x32x8_bf16 v[28:43], v[112:113], v[104:105], v[28:43]
    ds_read_b128 v[108:111], v4 offset:512
    ds_read_b64 v[112:113], v8 offset:8704
    ds_read_b128 v[116:119], v12 offset:0
    s_nop 7
    s_nop 3
    s_waitcnt lgkmcnt(2)
    v_mfma_f32_32x32x16_bf16 v[44:59], v[108:111], v[100:103], v[60:75]
    ds_read_b128 v[108:111], v4 offset:1024
    v_exp_f32 v28, v28
    v_exp_f32 v29, v29
    v_exp_f32 v30, v30
    v_exp_f32 v31, v31
    v_cvt_pk_bf16_f32 v92, v28, v29
    v_cvt_pk_bf16_f32 v93, v30, v31
    ds_read_b128 v[120:123], v12 offset:640
    v_exp_f32 v32, v32
    v_exp_f32 v33, v33
    v_exp_f32 v34, v34
    v_exp_f32 v35, v35
    v_cvt_pk_bf16_f32 v94, v32, v33
    v_cvt_pk_bf16_f32 v95, v34, v35
    s_waitcnt lgkmcnt(3)
    v_mfma_f32_32x32x8_bf16 v[44:59], v[112:113], v[104:105], v[44:59]
    ds_read_b64 v[112:113], v8 offset:9216
    v_exp_f32 v36, v36
    v_exp_f32 v37, v37
    v_exp_f32 v38, v38
    v_exp_f32 v39, v39
    v_cvt_pk_bf16_f32 v96, v36, v37
    v_cvt_pk_bf16_f32 v97, v38, v39
    s_waitcnt lgkmcnt(3)
    v_mfma_f32_32x32x16_bf16 v[76:91], v[116:119], v[92:95], 0
    ds_read_b128 v[116:119], v12 offset:1280
    v_exp_f32 v40, v40
    v_exp_f32 v41, v41
    v_exp_f32 v42, v42
    v_exp_f32 v43, v43
    v_cvt_pk_bf16_f32 v98, v40, v41
    v_cvt_pk_bf16_f32 v99, v42, v43
    s_waitcnt lgkmcnt(3)
    v_mfma_f32_32x32x16_bf16 v[28:43], v[108:111], v[100:103], v[60:75]
    ds_read_b128 v[108:111], v4 offset:1536
    v_exp_f32 v44, v44
    v_exp_f32 v45, v45
    v_exp_f32 v46, v46
    v_exp_f32 v47, v47
    v_cvt_pk_bf16_f32 v92, v44, v45
    v_cvt_pk_bf16_f32 v93, v46, v47
    s_waitcnt lgkmcnt(3)
    v_mfma_f32_32x32x16_bf16 v[76:91], v[120:123], v[96:99], v[76:91]
    ds_read_b128 v[120:123], v12 offset:1920
    v_exp_f32 v48, v48
    v_exp_f32 v49, v49
    v_exp_f32 v50, v50
    v_exp_f32 v51, v51
    v_cvt_pk_bf16_f32 v94, v48, v49
    v_cvt_pk_bf16_f32 v95, v50, v51
    s_waitcnt lgkmcnt(3)
    v_mfma_f32_32x32x8_bf16 v[28:43], v[112:113], v[104:105], v[28:43]
    ds_read_b64 v[112:113], v8 offset:9728
    v_exp_f32 v52, v52
    v_exp_f32 v53, v53
    v_exp_f32 v54, v54
    v_exp_f32 v55, v55
    v_cvt_pk_bf16_f32 v96, v52, v53
    v_cvt_pk_bf16_f32 v97, v54, v55
    s_waitcnt lgkmcnt(3)
    v_mfma_f32_32x32x16_bf16 v[76:91], v[116:119], v[92:95], v[76:91]
    ds_read_b128 v[116:119], v12 offset:2560
    v_exp_f32 v56, v56
    v_exp_f32 v57, v57
    v_exp_f32 v58, v58
    v_exp_f32 v59, v59
    v_cvt_pk_bf16_f32 v98, v56, v57
    v_cvt_pk_bf16_f32 v99, v58, v59
    s_waitcnt lgkmcnt(3)
    v_mfma_f32_32x32x16_bf16 v[44:59], v[108:111], v[100:103], v[60:75]
    ds_read_b128 v[108:111], v4 offset:2048
    v_exp_f32 v28, v28
    v_exp_f32 v29, v29
    v_exp_f32 v30, v30
    v_exp_f32 v31, v31
    v_cvt_pk_bf16_f32 v92, v28, v29
    v_cvt_pk_bf16_f32 v93, v30, v31
    s_waitcnt lgkmcnt(3)
    v_mfma_f32_32x32x16_bf16 v[76:91], v[120:123], v[96:99], v[76:91]
    ds_read_b128 v[120:123], v12 offset:3200
    v_exp_f32 v32, v32
    v_exp_f32 v33, v33
    v_exp_f32 v34, v34
    v_exp_f32 v35, v35
    v_cvt_pk_bf16_f32 v94, v32, v33
    v_cvt_pk_bf16_f32 v95, v34, v35
    s_waitcnt lgkmcnt(3)
    v_mfma_f32_32x32x8_bf16 v[44:59], v[112:113], v[104:105], v[44:59]
    ds_read_b64 v[112:113], v8 offset:10240
    v_exp_f32 v36, v36
    v_exp_f32 v37, v37
    v_exp_f32 v38, v38
    v_exp_f32 v39, v39
    v_cvt_pk_bf16_f32 v96, v36, v37
    v_cvt_pk_bf16_f32 v97, v38, v39
    s_waitcnt lgkmcnt(3)
    v_mfma_f32_32x32x16_bf16 v[76:91], v[116:119], v[92:95], v[76:91]
    ds_read_b128 v[116:119], v12 offset:3840
    v_exp_f32 v40, v40
    v_exp_f32 v41, v41
    v_exp_f32 v42, v42
    v_exp_f32 v43, v43
    v_cvt_pk_bf16_f32 v98, v40, v41
    v_cvt_pk_bf16_f32 v99, v42, v43
    s_waitcnt lgkmcnt(3)
    v_mfma_f32_32x32x16_bf16 v[28:43], v[108:111], v[100:103], v[60:75]
    ds_read_b128 v[108:111], v4 offset:2560
    v_exp_f32 v44, v44
    v_exp_f32 v45, v45
    v_exp_f32 v46, v46
    v_exp_f32 v47, v47
    v_cvt_pk_bf16_f32 v92, v44, v45
    v_cvt_pk_bf16_f32 v93, v46, v47
    s_waitcnt lgkmcnt(3)
    v_mfma_f32_32x32x16_bf16 v[76:91], v[120:123], v[96:99], v[76:91]
    ds_read_b128 v[120:123], v12 offset:4480
    v_exp_f32 v48, v48
    v_exp_f32 v49, v49
    v_exp_f32 v50, v50
    v_exp_f32 v51, v51
    v_cvt_pk_bf16_f32 v94, v48, v49
    v_cvt_pk_bf16_f32 v95, v50, v51
    s_waitcnt lgkmcnt(3)
    v_mfma_f32_32x32x8_bf16 v[28:43], v[112:113], v[104:105], v[28:43]
    ds_read_b64 v[112:113], v8 offset:10752
    v_exp_f32 v52, v52
    v_exp_f32 v53, v53
    v_exp_f32 v54, v54
    v_exp_f32 v55, v55
    v_cvt_pk_bf16_f32 v96, v52, v53
    v_cvt_pk_bf16_f32 v97, v54, v55
    s_waitcnt lgkmcnt(3)
    v_mfma_f32_32x32x16_bf16 v[76:91], v[116:119], v[92:95], v[76:91]
    ds_read_b128 v[116:119], v232 offset:0
    v_exp_f32 v56, v56
    v_exp_f32 v57, v57
    v_exp_f32 v58, v58
    v_exp_f32 v59, v59
    v_cvt_pk_bf16_f32 v98, v56, v57
    v_cvt_pk_bf16_f32 v99, v58, v59
    s_waitcnt lgkmcnt(3)
    v_mfma_f32_32x32x16_bf16 v[44:59], v[108:111], v[100:103], v[60:75]
    ds_read_b128 v[108:111], v4 offset:3072
    v_exp_f32 v28, v28
    v_exp_f32 v29, v29
    v_exp_f32 v30, v30
    v_exp_f32 v31, v31
    v_cvt_pk_bf16_f32 v92, v28, v29
    v_cvt_pk_bf16_f32 v93, v30, v31
    s_waitcnt lgkmcnt(3)
    v_mfma_f32_32x32x16_bf16 v[76:91], v[120:123], v[96:99], v[76:91]
    ds_read_b128 v[120:123], v232 offset:640
    v_exp_f32 v32, v32
    v_exp_f32 v33, v33
    v_exp_f32 v34, v34
    v_exp_f32 v35, v35
    v_cvt_pk_bf16_f32 v94, v32, v33
    v_cvt_pk_bf16_f32 v95, v34, v35
    s_waitcnt lgkmcnt(3)
    v_mfma_f32_32x32x8_bf16 v[44:59], v[112:113], v[104:105], v[44:59]
    ds_read_b64 v[112:113], v8 offset:11264
    v_exp_f32 v36, v36
    v_exp_f32 v37, v37
    v_exp_f32 v38, v38
    v_exp_f32 v39, v39
    v_cvt_pk_bf16_f32 v96, v36, v37
    v_cvt_pk_bf16_f32 v97, v38, v39
    s_waitcnt lgkmcnt(3)
    v_mfma_f32_32x32x16_bf16 v[76:91], v[116:119], v[92:95], v[76:91]
    ds_read_b128 v[116:119], v232 offset:1280
    v_exp_f32 v40, v40
    v_exp_f32 v41, v41
    v_exp_f32 v42, v42
    v_exp_f32 v43, v43
    v_cvt_pk_bf16_f32 v98, v40, v41
    v_cvt_pk_bf16_f32 v99, v42, v43
    s_waitcnt lgkmcnt(3)
    v_mfma_f32_32x32x16_bf16 v[28:43], v[108:111], v[100:103], v[60:75]
    ds_read_b128 v[108:111], v4 offset:3584
    v_exp_f32 v44, v44
    v_exp_f32 v45, v45
    v_exp_f32 v46, v46
    v_exp_f32 v47, v47
    v_cvt_pk_bf16_f32 v92, v44, v45
    v_cvt_pk_bf16_f32 v93, v46, v47
    s_waitcnt lgkmcnt(3)
    v_mfma_f32_32x32x16_bf16 v[76:91], v[120:123], v[96:99], v[76:91]
    ds_read_b128 v[120:123], v232 offset:1920
    v_exp_f32 v48, v48
    v_exp_f32 v49, v49
    v_exp_f32 v50, v50
    v_exp_f32 v51, v51
    v_cvt_pk_bf16_f32 v94, v48, v49
    v_cvt_pk_bf16_f32 v95, v50, v51
    s_waitcnt lgkmcnt(3)
    v_mfma_f32_32x32x8_bf16 v[28:43], v[112:113], v[104:105], v[28:43]
    ds_read_b64 v[112:113], v8 offset:11776
    v_exp_f32 v52, v52
    v_exp_f32 v53, v53
    v_exp_f32 v54, v54
    v_exp_f32 v55, v55
    v_cvt_pk_bf16_f32 v96, v52, v53
    v_cvt_pk_bf16_f32 v97, v54, v55
    s_waitcnt lgkmcnt(3)
    v_mfma_f32_32x32x16_bf16 v[76:91], v[116:119], v[92:95], v[76:91]
    ds_read_b128 v[116:119], v232 offset:2560
    v_exp_f32 v56, v56
    v_exp_f32 v57, v57
    v_exp_f32 v58, v58
    v_exp_f32 v59, v59
    v_cvt_pk_bf16_f32 v98, v56, v57
    v_cvt_pk_bf16_f32 v99, v58, v59
    s_waitcnt vmcnt(0)
    s_barrier
    s_cmp_lg_u32 s16, 0
    s_cbranch_scc1 L_w0_pubb
    v_mov_b32 v20, s17
    v_mov_b32 v21, 0
    s_add_u32 s32, s91, 22635520
    s_mov_b64 exec, 1
    buffer_store_dword v20, v21, s[8:11], s32 offen sc1
    s_mov_b64 exec, -1
L_w0_pubb:
    s_waitcnt lgkmcnt(3)
    v_mfma_f32_32x32x16_bf16 v[44:59], v[108:111], v[100:103], v[60:75]
    ds_read_b128 v[108:111], v5 offset:0
    v_exp_f32 v28, v28
    v_exp_f32 v29, v29
    v_exp_f32 v30, v30
    v_exp_f32 v31, v31
    v_cvt_pk_bf16_f32 v92, v28, v29
    v_cvt_pk_bf16_f32 v93, v30, v31
    s_waitcnt lgkmcnt(3)
    v_mfma_f32_32x32x16_bf16 v[76:91], v[120:123], v[96:99], v[76:91]
    ds_read_b128 v[120:123], v232 offset:3200
    v_exp_f32 v32, v32
    v_exp_f32 v33, v33
    v_exp_f32 v34, v34
    v_exp_f32 v35, v35
    v_cvt_pk_bf16_f32 v94, v32, v33
    v_cvt_pk_bf16_f32 v95, v34, v35
    s_waitcnt lgkmcnt(3)
    v_mfma_f32_32x32x8_bf16 v[44:59], v[112:113], v[104:105], v[44:59]
    ds_read_b64 v[112:113], v9 offset:8192
    v_exp_f32 v36, v36
    v_exp_f32 v37, v37
    v_exp_f32 v38, v38
    v_exp_f32 v39, v39
    v_cvt_pk_bf16_f32 v96, v36, v37
    v_cvt_pk_bf16_f32 v97, v38, v39
    s_waitcnt lgkmcnt(3)
    v_mfma_f32_32x32x16_bf16 v[76:91], v[116:119], v[92:95], v[76:91]
    ds_read_b128 v[116:119], v232 offset:3840
    v_exp_f32 v40, v40
    v_exp_f32 v41, v41
    v_exp_f32 v42, v42
    v_exp_f32 v43, v43
    v_cvt_pk_bf16_f32 v98, v40, v41
    v_cvt_pk_bf16_f32 v99, v42, v43
    s_waitcnt lgkmcnt(3)
    v_mfma_f32_32x32x16_bf16 v[28:43], v[108:111], v[100:103], v[60:75]
    ds_read_b128 v[108:111], v5 offset:512
    v_exp_f32 v44, v44
    v_exp_f32 v45, v45
    v_exp_f32 v46, v46
    v_exp_f32 v47, v47
    v_cvt_pk_bf16_f32 v92, v44, v45
    v_cvt_pk_bf16_f32 v93, v46, v47
    s_waitcnt lgkmcnt(3)
    v_mfma_f32_32x32x16_bf16 v[76:91], v[120:123], v[96:99], v[76:91]
    ds_read_b128 v[120:123], v232 offset:4480
    v_exp_f32 v48, v48
    v_exp_f32 v49, v49
    v_exp_f32 v50, v50
    v_exp_f32 v51, v51
    v_cvt_pk_bf16_f32 v94, v48, v49
    v_cvt_pk_bf16_f32 v95, v50, v51
    s_waitcnt lgkmcnt(3)
    v_mfma_f32_32x32x8_bf16 v[28:43], v[112:113], v[104:105], v[28:43]
    ds_read_b64 v[112:113], v9 offset:8704
    v_exp_f32 v52, v52
    v_exp_f32 v53, v53
    v_exp_f32 v54, v54
    v_exp_f32 v55, v55
    v_cvt_pk_bf16_f32 v96, v52, v53
    v_cvt_pk_bf16_f32 v97, v54, v55
    s_waitcnt lgkmcnt(3)
    v_mfma_f32_32x32x16_bf16 v[76:91], v[116:119], v[92:95], v[76:91]
    ds_read_b128 v[116:119], v13 offset:0
    v_exp_f32 v56, v56
    v_exp_f32 v57, v57
    v_exp_f32 v58, v58
    v_exp_f32 v59, v59
    v_cvt_pk_bf16_f32 v98, v56, v57
    v_cvt_pk_bf16_f32 v99, v58, v59
    s_waitcnt lgkmcnt(3)
    v_mfma_f32_32x32x16_bf16 v[44:59], v[108:111], v[100:103], v[60:75]
    ds_read_b128 v[108:111], v5 offset:1024
    v_exp_f32 v28, v28
    v_exp_f32 v29, v29
    v_exp_f32 v30, v30
    v_exp_f32 v31, v31
    v_cvt_pk_bf16_f32 v92, v28, v29
    v_cvt_pk_bf16_f32 v93, v30, v31
    s_waitcnt lgkmcnt(3)
    v_mfma_f32_32x32x16_bf16 v[76:91], v[120:123], v[96:99], v[76:91]
    ds_read_b128 v[120:123], v13 offset:640
    v_exp_f32 v32, v32
    v_exp_f32 v33, v33
    v_exp_f32 v34, v34
    v_exp_f32 v35, v35
    v_cvt_pk_bf16_f32 v94, v32, v33
    v_cvt_pk_bf16_f32 v95, v34, v35
    s_waitcnt lgkmcnt(3)
    v_mfma_f32_32x32x8_bf16 v[44:59], v[112:113], v[104:105], v[44:59]
    ds_read_b64 v[112:113], v9 offset:9216
    v_exp_f32 v36, v36
    v_exp_f32 v37, v37
    v_exp_f32 v38, v38
    v_exp_f32 v39, v39
    v_cvt_pk_bf16_f32 v96, v36, v37
    v_cvt_pk_bf16_f32 v97, v38, v39
    s_waitcnt lgkmcnt(3)
    v_mfma_f32_32x32x16_bf16 v[76:91], v[116:119], v[92:95], v[76:91]
    ds_read_b128 v[116:119], v13 offset:1280
    v_exp_f32 v40, v40
    v_exp_f32 v41, v41
    v_exp_f32 v42, v42
    v_exp_f32 v43, v43
    v_cvt_pk_bf16_f32 v98, v40, v41
    v_cvt_pk_bf16_f32 v99, v42, v43
    s_waitcnt lgkmcnt(3)
    v_mfma_f32_32x32x16_bf16 v[28:43], v[108:111], v[100:103], v[60:75]
    ds_read_b128 v[108:111], v5 offset:1536
    v_exp_f32 v44, v44
    v_exp_f32 v45, v45
    v_exp_f32 v46, v46
    v_exp_f32 v47, v47
    v_cvt_pk_bf16_f32 v92, v44, v45
    v_cvt_pk_bf16_f32 v93, v46, v47
    s_waitcnt lgkmcnt(3)
    v_mfma_f32_32x32x16_bf16 v[76:91], v[120:123], v[96:99], v[76:91]
    ds_read_b128 v[120:123], v13 offset:1920
    v_exp_f32 v48, v48
    v_exp_f32 v49, v49
    v_exp_f32 v50, v50
    v_exp_f32 v51, v51
    v_cvt_pk_bf16_f32 v94, v48, v49
    v_cvt_pk_bf16_f32 v95, v50, v51
    s_waitcnt lgkmcnt(3)
    v_mfma_f32_32x32x8_bf16 v[28:43], v[112:113], v[104:105], v[28:43]
    ds_read_b64 v[112:113], v9 offset:9728
    v_exp_f32 v52, v52
    v_exp_f32 v53, v53
    v_exp_f32 v54, v54
    v_exp_f32 v55, v55
    v_cvt_pk_bf16_f32 v96, v52, v53
    v_cvt_pk_bf16_f32 v97, v54, v55
    s_waitcnt lgkmcnt(3)
    v_mfma_f32_32x32x16_bf16 v[76:91], v[116:119], v[92:95], v[76:91]
    ds_read_b128 v[116:119], v13 offset:2560
    v_exp_f32 v56, v56
    v_exp_f32 v57, v57
    v_exp_f32 v58, v58
    v_exp_f32 v59, v59
    v_cvt_pk_bf16_f32 v98, v56, v57
    v_cvt_pk_bf16_f32 v99, v58, v59
    s_waitcnt lgkmcnt(3)
    v_mfma_f32_32x32x16_bf16 v[44:59], v[108:111], v[100:103], v[60:75]
    ds_read_b128 v[108:111], v5 offset:2048
    v_exp_f32 v28, v28
    v_exp_f32 v29, v29
    v_exp_f32 v30, v30
    v_exp_f32 v31, v31
    v_cvt_pk_bf16_f32 v92, v28, v29
    v_cvt_pk_bf16_f32 v93, v30, v31
    s_waitcnt lgkmcnt(3)
    v_mfma_f32_32x32x16_bf16 v[76:91], v[120:123], v[96:99], v[76:91]
    ds_read_b128 v[120:123], v13 offset:3200
    v_exp_f32 v32, v32
    v_exp_f32 v33, v33
    v_exp_f32 v34, v34
    v_exp_f32 v35, v35
    v_cvt_pk_bf16_f32 v94, v32, v33
    v_cvt_pk_bf16_f32 v95, v34, v35
    s_waitcnt lgkmcnt(3)
    v_mfma_f32_32x32x8_bf16 v[44:59], v[112:113], v[104:105], v[44:59]
    ds_read_b64 v[112:113], v9 offset:10240
    v_exp_f32 v36, v36
    v_exp_f32 v37, v37
    v_exp_f32 v38, v38
    v_exp_f32 v39, v39
    v_cvt_pk_bf16_f32 v96, v36, v37
    v_cvt_pk_bf16_f32 v97, v38, v39
    s_waitcnt lgkmcnt(3)
    v_mfma_f32_32x32x16_bf16 v[76:91], v[116:119], v[92:95], v[76:91]
    ds_read_b128 v[116:119], v13 offset:3840
    v_exp_f32 v40, v40
    v_exp_f32 v41, v41
    v_exp_f32 v42, v42
    v_exp_f32 v43, v43
    v_cvt_pk_bf16_f32 v98, v40, v41
    v_cvt_pk_bf16_f32 v99, v42, v43
    s_waitcnt lgkmcnt(3)
    v_mfma_f32_32x32x16_bf16 v[28:43], v[108:111], v[100:103], v[60:75]
    ds_read_b128 v[108:111], v5 offset:2560
    v_exp_f32 v44, v44
    v_exp_f32 v45, v45
    v_exp_f32 v46, v46
    v_exp_f32 v47, v47
    v_cvt_pk_bf16_f32 v92, v44, v45
    v_cvt_pk_bf16_f32 v93, v46, v47
    s_waitcnt lgkmcnt(3)
    v_mfma_f32_32x32x16_bf16 v[76:91], v[120:123], v[96:99], v[76:91]
    ds_read_b128 v[120:123], v13 offset:4480
    v_exp_f32 v48, v48
    v_exp_f32 v49, v49
    v_exp_f32 v50, v50
    v_exp_f32 v51, v51
    v_cvt_pk_bf16_f32 v94, v48, v49
    v_cvt_pk_bf16_f32 v95, v50, v51
    s_waitcnt lgkmcnt(3)
    v_mfma_f32_32x32x8_bf16 v[28:43], v[112:113], v[104:105], v[28:43]
    ds_read_b64 v[112:113], v9 offset:10752
    v_exp_f32 v52, v52
    v_exp_f32 v53, v53
    v_exp_f32 v54, v54
    v_exp_f32 v55, v55
    v_cvt_pk_bf16_f32 v96, v52, v53
    v_cvt_pk_bf16_f32 v97, v54, v55
    s_waitcnt lgkmcnt(3)
    v_mfma_f32_32x32x16_bf16 v[76:91], v[116:119], v[92:95], v[76:91]
    ds_read_b128 v[116:119], v233 offset:0
    v_exp_f32 v56, v56
    v_exp_f32 v57, v57
    v_exp_f32 v58, v58
    v_exp_f32 v59, v59
    v_cvt_pk_bf16_f32 v98, v56, v57
    v_cvt_pk_bf16_f32 v99, v58, v59
    s_waitcnt lgkmcnt(3)
    v_mfma_f32_32x32x16_bf16 v[44:59], v[108:111], v[100:103], v[60:75]
    ds_read_b128 v[108:111], v5 offset:3072
    v_exp_f32 v28, v28
    v_exp_f32 v29, v29
    v_exp_f32 v30, v30
    v_exp_f32 v31, v31
    v_cvt_pk_bf16_f32 v92, v28, v29
    v_cvt_pk_bf16_f32 v93, v30, v31
    s_waitcnt lgkmcnt(3)
    v_mfma_f32_32x32x16_bf16 v[76:91], v[120:123], v[96:99], v[76:91]
    ds_read_b128 v[120:123], v233 offset:640
    v_exp_f32 v32, v32
    v_exp_f32 v33, v33
    v_exp_f32 v34, v34
    v_exp_f32 v35, v35
    v_cvt_pk_bf16_f32 v94, v32, v33
    v_cvt_pk_bf16_f32 v95, v34, v35
    s_waitcnt lgkmcnt(3)
    v_mfma_f32_32x32x8_bf16 v[44:59], v[112:113], v[104:105], v[44:59]
    ds_read_b64 v[112:113], v9 offset:11264
    v_exp_f32 v36, v36
    v_exp_f32 v37, v37
    v_exp_f32 v38, v38
    v_exp_f32 v39, v39
    v_cvt_pk_bf16_f32 v96, v36, v37
    v_cvt_pk_bf16_f32 v97, v38, v39
    s_waitcnt lgkmcnt(3)
    v_mfma_f32_32x32x16_bf16 v[76:91], v[116:119], v[92:95], v[76:91]
    ds_read_b128 v[116:119], v233 offset:1280
    v_exp_f32 v40, v40
    v_exp_f32 v41, v41
    v_exp_f32 v42, v42
    v_exp_f32 v43, v43
    v_cvt_pk_bf16_f32 v98, v40, v41
    v_cvt_pk_bf16_f32 v99, v42, v43
    s_cmp_lg_u32 s16, 0
    s_cbranch_scc1 L_w0_f1b_i
    s_mov_b32 s32, 22635520
    buffer_load_dword v19, v234, s[8:11], s32 offen sc1
    s_mov_b32 s32, 22634496
    buffer_load_dword v235, v241, s[8:11], s32 offen sc1
L_w0_f1b_i:
    s_waitcnt lgkmcnt(3)
    v_mfma_f32_32x32x16_bf16 v[28:43], v[108:111], v[100:103], v[60:75]
    ds_read_b128 v[108:111], v5 offset:3584
    v_exp_f32 v44, v44
    v_exp_f32 v45, v45
    v_exp_f32 v46, v46
    v_exp_f32 v47, v47
    v_cvt_pk_bf16_f32 v92, v44, v45
    v_cvt_pk_bf16_f32 v93, v46, v47
    s_waitcnt lgkmcnt(3)
    v_mfma_f32_32x32x16_bf16 v[76:91], v[120:123], v[96:99], v[76:91]
    ds_read_b128 v[120:123], v233 offset:1920
    v_exp_f32 v48, v48
    v_exp_f32 v49, v49
    v_exp_f32 v50, v50
    v_exp_f32 v51, v51
    v_cvt_pk_bf16_f32 v94, v48, v49
    v_cvt_pk_bf16_f32 v95, v50, v51
    s_waitcnt lgkmcnt(3)
    v_mfma_f32_32x32x8_bf16 v[28:43], v[112:113], v[104:105], v[28:43]
    ds_read_b64 v[112:113], v9 offset:11776
    v_exp_f32 v52, v52
    v_exp_f32 v53, v53
    v_exp_f32 v54, v54
    v_exp_f32 v55, v55
    v_cvt_pk_bf16_f32 v96, v52, v53
    v_cvt_pk_bf16_f32 v97, v54, v55
    s_waitcnt lgkmcnt(3)
    v_mfma_f32_32x32x16_bf16 v[76:91], v[116:119], v[92:95], v[76:91]
    ds_read_b128 v[116:119], v233 offset:2560
    v_exp_f32 v56, v56
    v_exp_f32 v57, v57
    v_exp_f32 v58, v58
    v_exp_f32 v59, v59
    v_cvt_pk_bf16_f32 v98, v56, v57
    v_cvt_pk_bf16_f32 v99, v58, v59
    s_barrier
    s_waitcnt lgkmcnt(3)
    v_mfma_f32_32x32x16_bf16 v[44:59], v[108:111], v[100:103], v[60:75]
    ds_read_b128 v[108:111], v6 offset:0
    v_exp_f32 v28, v28
    v_exp_f32 v29, v29
    v_exp_f32 v30, v30
    v_exp_f32 v31, v31
    v_cvt_pk_bf16_f32 v92, v28, v29
    v_cvt_pk_bf16_f32 v93, v30, v31
    s_waitcnt lgkmcnt(3)
    v_mfma_f32_32x32x16_bf16 v[76:91], v[120:123], v[96:99], v[76:91]
    ds_read_b128 v[120:123], v233 offset:3200
    v_exp_f32 v32, v32
    v_exp_f32 v33, v33
    v_exp_f32 v34, v34
    v_exp_f32 v35, v35
    v_cvt_pk_bf16_f32 v94, v32, v33
    v_cvt_pk_bf16_f32 v95, v34, v35
    s_waitcnt lgkmcnt(3)
    v_mfma_f32_32x32x8_bf16 v[44:59], v[112:113], v[104:105], v[44:59]
    ds_read_b64 v[112:113], v10 offset:8192
    v_exp_f32 v36, v36
    v_exp_f32 v37, v37
    v_exp_f32 v38, v38
    v_exp_f32 v39, v39
    v_cvt_pk_bf16_f32 v96, v36, v37
    v_cvt_pk_bf16_f32 v97, v38, v39
    s_waitcnt lgkmcnt(3)
    v_mfma_f32_32x32x16_bf16 v[76:91], v[116:119], v[92:95], v[76:91]
    ds_read_b128 v[116:119], v233 offset:3840
    v_exp_f32 v40, v40
    v_exp_f32 v41, v41
    v_exp_f32 v42, v42
    v_exp_f32 v43, v43
    v_cvt_pk_bf16_f32 v98, v40, v41
    v_cvt_pk_bf16_f32 v99, v42, v43
    s_waitcnt lgkmcnt(3)
    v_mfma_f32_32x32x16_bf16 v[28:43], v[108:111], v[100:103], v[60:75]
    ds_read_b128 v[108:111], v6 offset:512
    v_exp_f32 v44, v44
    v_exp_f32 v45, v45
    v_exp_f32 v46, v46
    v_exp_f32 v47, v47
    v_cvt_pk_bf16_f32 v92, v44, v45
    v_cvt_pk_bf16_f32 v93, v46, v47
    s_waitcnt lgkmcnt(3)
    v_mfma_f32_32x32x16_bf16 v[76:91], v[120:123], v[96:99], v[76:91]
    ds_read_b128 v[120:123], v233 offset:4480
    v_exp_f32 v48, v48
    v_exp_f32 v49, v49
    v_exp_f32 v50, v50
    v_exp_f32 v51, v51
    v_cvt_pk_bf16_f32 v94, v48, v49
    v_cvt_pk_bf16_f32 v95, v50, v51
    s_add_u32 m0, s21, 0
    v_mad_u32_u24 v250, v247, 4, v244
    buffer_load_dwordx4 v250, s[8:11], 0 offen sc1 lds
    s_waitcnt lgkmcnt(3)
    v_mfma_f32_32x32x8_bf16 v[28:43], v[112:113], v[104:105], v[28:43]
    ds_read_b64 v[112:113], v10 offset:8704
    v_exp_f32 v52, v52
    v_exp_f32 v53, v53
    v_exp_f32 v54, v54
    v_exp_f32 v55, v55
    v_cvt_pk_bf16_f32 v96, v52, v53
    v_cvt_pk_bf16_f32 v97, v54, v55
    s_waitcnt lgkmcnt(3)
    v_mfma_f32_32x32x16_bf16 v[76:91], v[116:119], v[92:95], v[76:91]
    ds_read_b128 v[116:119], v14 offset:0
    v_exp_f32 v56, v56
    v_exp_f32 v57, v57
    v_exp_f32 v58, v58
    v_exp_f32 v59, v59
    v_cvt_pk_bf16_f32 v98, v56, v57
    v_cvt_pk_bf16_f32 v99, v58, v59
    s_add_u32 m0, s21, 1024
    v_mad_u32_u24 v250, v248, 4, v245
    buffer_load_dwordx4 v250, s[8:11], 0 offen sc1 lds
    s_waitcnt lgkmcnt(3)
    v_mfma_f32_32x32x16_bf16 v[44:59], v[108:111], v[100:103], v[60:75]
    ds_read_b128 v[108:111], v6 offset:1024
    v_exp_f32 v28, v28
    v_exp_f32 v29, v29
    v_exp_f32 v30, v30
    v_exp_f32 v31, v31
    v_cvt_pk_bf16_f32 v92, v28, v29
    v_cvt_pk_bf16_f32 v93, v30, v31
    s_waitcnt lgkmcnt(3)
    v_mfma_f32_32x32x16_bf16 v[76:91], v[120:123], v[96:99], v[76:91]
    ds_read_b128 v[120:123], v14 offset:640
    v_exp_f32 v32, v32
    v_exp_f32 v33, v33
    v_exp_f32 v34, v34
    v_exp_f32 v35, v35
    v_cvt_pk_bf16_f32 v94, v32, v33
    v_cvt_pk_bf16_f32 v95, v34, v35
    s_add_u32 m0, s21, 2048
    v_mad_u32_u24 v250, v249, 4, v246
    s_mov_b32 exec_hi, 0xffff
    buffer_load_dwordx4 v250, s[8:11], 0 offen sc1 lds
    s_mov_b32 exec_hi, -1
    s_waitcnt lgkmcnt(3)
    v_mfma_f32_32x32x8_bf16 v[44:59], v[112:113], v[104:105], v[44:59]
    ds_read_b64 v[112:113], v10 offset:9216
    v_exp_f32 v36, v36
    v_exp_f32 v37, v37
    v_exp_f32 v38, v38
    v_exp_f32 v39, v39
    v_cvt_pk_bf16_f32 v96, v36, v37
    v_cvt_pk_bf16_f32 v97, v38, v39
    s_waitcnt lgkmcnt(3)
    v_mfma_f32_32x32x16_bf16 v[76:91], v[116:119], v[92:95], v[76:91]
    ds_read_b128 v[116:119], v14 offset:1280
    v_exp_f32 v40, v40
    v_exp_f32 v41, v41
    v_exp_f32 v42, v42
    v_exp_f32 v43, v43
    v_cvt_pk_bf16_f32 v98, v40, v41
    v_cvt_pk_bf16_f32 v99, v42, v43
    s_waitcnt lgkmcnt(3)
    v_mfma_f32_32x32x16_bf16 v[28:43], v[108:111], v[100:103], v[60:75]
    ds_read_b128 v[108:111], v6 offset:1536
    v_exp_f32 v44, v44
    v_exp_f32 v45, v45
    v_exp_f32 v46, v46
    v_exp_f32 v47, v47
    v_cvt_pk_bf16_f32 v92, v44, v45
    v_cvt_pk_bf16_f32 v93, v46, v47
    s_waitcnt lgkmcnt(3)
    v_mfma_f32_32x32x16_bf16 v[76:91], v[120:123], v[96:99], v[76:91]
    ds_read_b128 v[120:123], v14 offset:1920
    v_exp_f32 v48, v48
    v_exp_f32 v49, v49
    v_exp_f32 v50, v50
    v_exp_f32 v51, v51
    v_cvt_pk_bf16_f32 v94, v48, v49
    v_cvt_pk_bf16_f32 v95, v50, v51
    s_waitcnt lgkmcnt(3)
    v_mfma_f32_32x32x8_bf16 v[28:43], v[112:113], v[104:105], v[28:43]
    ds_read_b64 v[112:113], v10 offset:9728
    v_exp_f32 v52, v52
    v_exp_f32 v53, v53
    v_exp_f32 v54, v54
    v_exp_f32 v55, v55
    v_cvt_pk_bf16_f32 v96, v52, v53
    v_cvt_pk_bf16_f32 v97, v54, v55
    s_waitcnt lgkmcnt(3)
    v_mfma_f32_32x32x16_bf16 v[76:91], v[116:119], v[92:95], v[76:91]
    ds_read_b128 v[116:119], v14 offset:2560
    v_exp_f32 v56, v56
    v_exp_f32 v57, v57
    v_exp_f32 v58, v58
    v_exp_f32 v59, v59
    v_cvt_pk_bf16_f32 v98, v56, v57
    v_cvt_pk_bf16_f32 v99, v58, v59
    s_waitcnt lgkmcnt(3)
    v_mfma_f32_32x32x16_bf16 v[44:59], v[108:111], v[100:103], v[60:75]
    ds_read_b128 v[108:111], v6 offset:2048
    v_exp_f32 v28, v28
    v_exp_f32 v29, v29
    v_exp_f32 v30, v30
    v_exp_f32 v31, v31
    v_cvt_pk_bf16_f32 v92, v28, v29
    v_cvt_pk_bf16_f32 v93, v30, v31
    s_waitcnt lgkmcnt(3)
    v_mfma_f32_32x32x16_bf16 v[76:91], v[120:123], v[96:99], v[76:91]
    ds_read_b128 v[120:123], v14 offset:3200
    v_exp_f32 v32, v32
    v_exp_f32 v33, v33
    v_exp_f32 v34, v34
    v_exp_f32 v35, v35
    v_cvt_pk_bf16_f32 v94, v32, v33
    v_cvt_pk_bf16_f32 v95, v34, v35
    s_waitcnt lgkmcnt(3)
    v_mfma_f32_32x32x8_bf16 v[44:59], v[112:113], v[104:105], v[44:59]
    ds_read_b64 v[112:113], v10 offset:10240
    v_exp_f32 v36, v36
    v_exp_f32 v37, v37
    v_exp_f32 v38, v38
    v_exp_f32 v39, v39
    v_cvt_pk_bf16_f32 v96, v36, v37
    v_cvt_pk_bf16_f32 v97, v38, v39
    s_waitcnt lgkmcnt(3)
    v_mfma_f32_32x32x16_bf16 v[76:91], v[116:119], v[92:95], v[76:91]
    ds_read_b128 v[116:119], v14 offset:3840
    v_exp_f32 v40, v40
    v_exp_f32 v41, v41
    v_exp_f32 v42, v42
    v_exp_f32 v43, v43
    v_cvt_pk_bf16_f32 v98, v40, v41
    v_cvt_pk_bf16_f32 v99, v42, v43
    s_waitcnt lgkmcnt(3)
    v_mfma_f32_32x32x16_bf16 v[28:43], v[108:111], v[100:103], v[60:75]
    ds_read_b128 v[108:111], v6 offset:2560
    v_exp_f32 v44, v44
    v_exp_f32 v45, v45
    v_exp_f32 v46, v46
    v_exp_f32 v47, v47
    v_cvt_pk_bf16_f32 v92, v44, v45
    v_cvt_pk_bf16_f32 v93, v46, v47
    s_waitcnt lgkmcnt(3)
    v_mfma_f32_32x32x16_bf16 v[76:91], v[120:123], v[96:99], v[76:91]
    ds_read_b128 v[120:123], v14 offset:4480
    v_exp_f32 v48, v48
    v_exp_f32 v49, v49
    v_exp_f32 v50, v50
    v_exp_f32 v51, v51
    v_cvt_pk_bf16_f32 v94, v48, v49
    v_cvt_pk_bf16_f32 v95, v50, v51
    s_waitcnt lgkmcnt(3)
    v_mfma_f32_32x32x8_bf16 v[28:43], v[112:113], v[104:105], v[28:43]
    ds_read_b64 v[112:113], v10 offset:10752
    v_exp_f32 v52, v52
    v_exp_f32 v53, v53
    v_exp_f32 v54, v54
    v_exp_f32 v55, v55
    v_cvt_pk_bf16_f32 v96, v52, v53
    v_cvt_pk_bf16_f32 v97, v54, v55
    s_waitcnt lgkmcnt(3)
    v_mfma_f32_32x32x16_bf16 v[76:91], v[116:119], v[92:95], v[76:91]
    ds_read_b128 v[116:119], v236 offset:0
    v_exp_f32 v56, v56
    v_exp_f32 v57, v57
    v_exp_f32 v58, v58
    v_exp_f32 v59, v59
    v_cvt_pk_bf16_f32 v98, v56, v57
    v_cvt_pk_bf16_f32 v99, v58, v59
    s_waitcnt lgkmcnt(3)
    v_mfma_f32_32x32x16_bf16 v[44:59], v[108:111], v[100:103], v[60:75]
    ds_read_b128 v[108:111], v6 offset:3072
    v_exp_f32 v28, v28
    v_exp_f32 v29, v29
    v_exp_f32 v30, v30
    v_exp_f32 v31, v31
    v_cvt_pk_bf16_f32 v92, v28, v29
    v_cvt_pk_bf16_f32 v93, v30, v31
    s_waitcnt lgkmcnt(3)
    v_mfma_f32_32x32x16_bf16 v[76:91], v[120:123], v[96:99], v[76:91]
    ds_read_b128 v[120:123], v236 offset:640
    v_exp_f32 v32, v32
    v_exp_f32 v33, v33
    v_exp_f32 v34, v34
    v_exp_f32 v35, v35
    v_cvt_pk_bf16_f32 v94, v32, v33
    v_cvt_pk_bf16_f32 v95, v34, v35
    s_waitcnt lgkmcnt(3)
    v_mfma_f32_32x32x8_bf16 v[44:59], v[112:113], v[104:105], v[44:59]
    ds_read_b64 v[112:113], v10 offset:11264
    v_exp_f32 v36, v36
    v_exp_f32 v37, v37
    v_exp_f32 v38, v38
    v_exp_f32 v39, v39
    v_cvt_pk_bf16_f32 v96, v36, v37
    v_cvt_pk_bf16_f32 v97, v38, v39
    s_waitcnt lgkmcnt(3)
    v_mfma_f32_32x32x16_bf16 v[76:91], v[116:119], v[92:95], v[76:91]
    ds_read_b128 v[116:119], v236 offset:1280
    v_exp_f32 v40, v40
    v_exp_f32 v41, v41
    v_exp_f32 v42, v42
    v_exp_f32 v43, v43
    v_cvt_pk_bf16_f32 v98, v40, v41
    v_cvt_pk_bf16_f32 v99, v42, v43
    s_waitcnt lgkmcnt(3)
    v_mfma_f32_32x32x16_bf16 v[28:43], v[108:111], v[100:103], v[60:75]
    ds_read_b128 v[108:111], v6 offset:3584
    v_exp_f32 v44, v44
    v_exp_f32 v45, v45
    v_exp_f32 v46, v46
    v_exp_f32 v47, v47
    v_cvt_pk_bf16_f32 v92, v44, v45
    v_cvt_pk_bf16_f32 v93, v46, v47
    s_waitcnt lgkmcnt(3)
    v_mfma_f32_32x32x16_bf16 v[76:91], v[120:123], v[96:99], v[76:91]
    ds_read_b128 v[120:123], v236 offset:1920
    v_exp_f32 v48, v48
    v_exp_f32 v49, v49
    v_exp_f32 v50, v50
    v_exp_f32 v51, v51
    v_cvt_pk_bf16_f32 v94, v48, v49
    v_cvt_pk_bf16_f32 v95, v50, v51
    s_waitcnt lgkmcnt(3)
    v_mfma_f32_32x32x8_bf16 v[28:43], v[112:113], v[104:105], v[28:43]
    ds_read_b64 v[112:113], v10 offset:11776
    v_exp_f32 v52, v52
    v_exp_f32 v53, v53
    v_exp_f32 v54, v54
    v_exp_f32 v55, v55
    v_cvt_pk_bf16_f32 v96, v52, v53
    v_cvt_pk_bf16_f32 v97, v54, v55
    s_waitcnt lgkmcnt(3)
    v_mfma_f32_32x32x16_bf16 v[76:91], v[116:119], v[92:95], v[76:91]
    ds_read_b128 v[116:119], v236 offset:2560
    v_exp_f32 v56, v56
    v_exp_f32 v57, v57
    v_exp_f32 v58, v58
    v_exp_f32 v59, v59
    v_cvt_pk_bf16_f32 v98, v56, v57
    v_cvt_pk_bf16_f32 v99, v58, v59
    s_waitcnt vmcnt(0)
    s_cmp_lg_u32 s16, 0
    s_cbranch_scc1 L_w0_f1b_c
    s_waitcnt vmcnt(0)
    v_cmp_eq_u32 vcc, s17, v19
    v_cmp_eq_u32 s[36:37], s17, v235
    s_nop 3
    s_and_b64 vcc, vcc, s[36:37]
    s_nop 3
    s_cmp_eq_u64 vcc, exec
    s_cbranch_scc1 L_f1b_ok
    s_mov_b32 s42, 0
L_f1b_spin:
    s_sleep 2
    s_mov_b32 s32, 22635520
    buffer_load_dword v19, v234, s[8:11], s32 offen sc1
    s_mov_b32 s32, 22634496
    buffer_load_dword v235, v241, s[8:11], s32 offen sc1
    s_add_u32 s42, s42, 1
    s_cmp_ge_u32 s42, 1048576
    s_cbranch_scc1 L_f1b_ok
    s_waitcnt vmcnt(0)
    v_cmp_eq_u32 vcc, s17, v19
    v_cmp_eq_u32 s[36:37], s17, v235
    s_nop 3
    s_and_b64 vcc, vcc, s[36:37]
    s_nop 3
    s_cmp_eq_u64 vcc, exec
    s_cbranch_scc0 L_f1b_spin
L_f1b_ok:
L_w0_f1b_c:
    s_barrier
    s_waitcnt lgkmcnt(3)
    v_mfma_f32_32x32x16_bf16 v[44:59], v[108:111], v[100:103], v[60:75]
    ds_read_b128 v[108:111], v7 offset:0
    v_exp_f32 v28, v28
    v_exp_f32 v29, v29
    v_exp_f32 v30, v30
    v_exp_f32 v31, v31
    v_cvt_pk_bf16_f32 v92, v28, v29
    v_cvt_pk_bf16_f32 v93, v30, v31
    s_waitcnt lgkmcnt(3)
    v_mfma_f32_32x32x16_bf16 v[76:91], v[120:123], v[96:99], v[76:91]
    ds_read_b128 v[120:123], v236 offset:3200
    v_exp_f32 v32, v32
    v_exp_f32 v33, v33
    v_exp_f32 v34, v34
    v_exp_f32 v35, v35
    v_cvt_pk_bf16_f32 v94, v32, v33
    v_cvt_pk_bf16_f32 v95, v34, v35
    buffer_load_dword v17, v238, s[8:11], s90 offen sc1
    s_waitcnt lgkmcnt(3)
    v_mfma_f32_32x32x8_bf16 v[44:59], v[112:113], v[104:105], v[44:59]
    ds_read_b64 v[112:113], v11 offset:8192
    v_exp_f32 v36, v36
    v_exp_f32 v37, v37
    v_exp_f32 v38, v38
    v_exp_f32 v39, v39
    v_cvt_pk_bf16_f32 v96, v36, v37
    v_cvt_pk_bf16_f32 v97, v38, v39
    s_waitcnt lgkmcnt(3)
    v_mfma_f32_32x32x16_bf16 v[76:91], v[116:119], v[92:95], v[76:91]
    ds_read_b128 v[116:119], v236 offset:3840
    v_exp_f32 v40, v40
    v_exp_f32 v41, v41
    v_exp_f32 v42, v42
    v_exp_f32 v43, v43
    v_cvt_pk_bf16_f32 v98, v40, v41
    v_cvt_pk_bf16_f32 v99, v42, v43
    buffer_load_dwordx4 v[124:127], v220, s[8:11], s48 offen sc1
    s_waitcnt lgkmcnt(3)
    v_mfma_f32_32x32x16_bf16 v[28:43], v[108:111], v[100:103], v[60:75]
    ds_read_b128 v[108:111], v7 offset:512
    v_exp_f32 v44, v44
    v_exp_f32 v45, v45
    v_exp_f32 v46, v46
    v_exp_f32 v47, v47
    v_cvt_pk_bf16_f32 v92, v44, v45
    v_cvt_pk_bf16_f32 v93, v46, v47
    s_waitcnt lgkmcnt(3)
    v_mfma_f32_32x32x16_bf16 v[76:91], v[120:123], v[96:99], v[76:91]
    ds_read_b128 v[120:123], v236 offset:4480
    v_exp_f32 v48, v48
    v_exp_f32 v49, v49
    v_exp_f32 v50, v50
    v_exp_f32 v51, v51
    v_cvt_pk_bf16_f32 v94, v48, v49
    v_cvt_pk_bf16_f32 v95, v50, v51
    buffer_load_dwordx4 v[132:135], v222, s[8:11], s50 offen sc1
    s_add_u32 m0, s21, 22528
    v_mad_u32_u24 v250, v247, 5, v244
    buffer_load_dwordx4 v250, s[8:11], 0 offen sc1 lds
    s_waitcnt lgkmcnt(3)
    v_mfma_f32_32x32x8_bf16 v[28:43], v[112:113], v[104:105], v[28:43]
    ds_read_b64 v[112:113], v11 offset:8704
    v_exp_f32 v52, v52
    v_exp_f32 v53, v53
    v_exp_f32 v54, v54
    v_exp_f32 v55, v55
    v_cvt_pk_bf16_f32 v96, v52, v53
    v_cvt_pk_bf16_f32 v97, v54, v55
    s_waitcnt lgkmcnt(3)
    v_mfma_f32_32x32x16_bf16 v[76:91], v[116:119], v[92:95], v[76:91]
    ds_read_b128 v[116:119], v15 offset:0
    v_exp_f32 v56, v56
    v_exp_f32 v57, v57
    v_exp_f32 v58, v58
    v_exp_f32 v59, v59
    v_cvt_pk_bf16_f32 v98, v56, v57
    v_cvt_pk_bf16_f32 v99, v58, v59
    buffer_load_dwordx2 v[136:137], v223, s[8:11], s51 offen sc1
    s_add_u32 m0, s21, 23552
    v_mad_u32_u24 v250, v248, 5, v245
    buffer_load_dwordx4 v250, s[8:11], 0 offen sc1 lds
    s_waitcnt lgkmcnt(3)
    v_mfma_f32_32x32x16_bf16 v[44:59], v[108:111], v[100:103], v[60:75]
    ds_read_b128 v[108:111], v7 offset:1024
    v_exp_f32 v28, v28
    v_exp_f32 v29, v29
    v_exp_f32 v30, v30
    v_exp_f32 v31, v31
    v_cvt_pk_bf16_f32 v92, v28, v29
    v_cvt_pk_bf16_f32 v93, v30, v31
    s_waitcnt lgkmcnt(3)
    v_mfma_f32_32x32x16_bf16 v[76:91], v[120:123], v[96:99], v[76:91]
    ds_read_b128 v[120:123], v15 offset:640
    v_exp_f32 v32, v32
    v_exp_f32 v33, v33
    v_exp_f32 v34, v34
    v_exp_f32 v35, v35
    v_cvt_pk_bf16_f32 v94, v32, v33
    v_cvt_pk_bf16_f32 v95, v34, v35
    buffer_load_dwordx4 v[140:143], v222, s[8:11], s53 offen sc1
    s_add_u32 m0, s21, 24576
    v_mad_u32_u24 v250, v249, 5, v246
    s_mov_b32 exec_hi, 0xffff
    buffer_load_dwordx4 v250, s[8:11], 0 offen sc1 lds
    s_mov_b32 exec_hi, -1
    s_waitcnt lgkmcnt(3)
    v_mfma_f32_32x32x8_bf16 v[44:59], v[112:113], v[104:105], v[44:59]
    ds_read_b64 v[112:113], v11 offset:9216
    v_exp_f32 v36, v36
    v_exp_f32 v37, v37
    v_exp_f32 v38, v38
    v_exp_f32 v39, v39
    v_cvt_pk_bf16_f32 v96, v36, v37
    v_cvt_pk_bf16_f32 v97, v38, v39
    s_waitcnt lgkmcnt(3)
    v_mfma_f32_32x32x16_bf16 v[76:91], v[116:119], v[92:95], v[76:91]
    ds_read_b128 v[116:119], v15 offset:1280
    v_exp_f32 v40, v40
    v_exp_f32 v41, v41
    v_exp_f32 v42, v42
    v_exp_f32 v43, v43
    v_cvt_pk_bf16_f32 v98, v40, v41
    v_cvt_pk_bf16_f32 v99, v42, v43
    buffer_load_dwordx2 v[144:145], v223, s[8:11], s54 offen sc1
    s_waitcnt lgkmcnt(3)
    v_mfma_f32_32x32x16_bf16 v[28:43], v[108:111], v[100:103], v[60:75]
    ds_read_b128 v[108:111], v7 offset:1536
    v_exp_f32 v44, v44
    v_exp_f32 v45, v45
    v_exp_f32 v46, v46
    v_exp_f32 v47, v47
    v_cvt_pk_bf16_f32 v92, v44, v45
    v_cvt_pk_bf16_f32 v93, v46, v47
    s_waitcnt lgkmcnt(3)
    v_mfma_f32_32x32x16_bf16 v[76:91], v[120:123], v[96:99], v[76:91]
    ds_read_b128 v[120:123], v15 offset:1920
    v_exp_f32 v48, v48
    v_exp_f32 v49, v49
    v_exp_f32 v50, v50
    v_exp_f32 v51, v51
    v_cvt_pk_bf16_f32 v94, v48, v49
    v_cvt_pk_bf16_f32 v95, v50, v51
    v_lshlrev_b32 v250, 1, v238
    buffer_load_dword v18, v250, s[8:11], s56 offen sc1
    s_waitcnt lgkmcnt(3)
    v_mfma_f32_32x32x8_bf16 v[28:43], v[112:113], v[104:105], v[28:43]
    ds_read_b64 v[112:113], v11 offset:9728
    v_exp_f32 v52, v52
    v_exp_f32 v53, v53
    v_exp_f32 v54, v54
    v_exp_f32 v55, v55
    v_cvt_pk_bf16_f32 v96, v52, v53
    v_cvt_pk_bf16_f32 v97, v54, v55
    s_waitcnt lgkmcnt(3)
    v_mfma_f32_32x32x16_bf16 v[76:91], v[116:119], v[92:95], v[76:91]
    ds_read_b128 v[116:119], v15 offset:2560
    v_exp_f32 v56, v56
    v_exp_f32 v57, v57
    v_exp_f32 v58, v58
    v_exp_f32 v59, v59
    v_cvt_pk_bf16_f32 v98, v56, v57
    v_cvt_pk_bf16_f32 v99, v58, v59
    s_mov_b32 exec_hi, 0
    buffer_load_dwordx2 v[128:129], v221, s[8:11], s49 offen sc1
    s_mov_b64 exec, -1
    s_waitcnt lgkmcnt(3)
    v_mfma_f32_32x32x16_bf16 v[44:59], v[108:111], v[100:103], v[60:75]
    ds_read_b128 v[108:111], v7 offset:2048
    v_exp_f32 v28, v28
    v_exp_f32 v29, v29
    v_exp_f32 v30, v30
    v_exp_f32 v31, v31
    v_cvt_pk_bf16_f32 v92, v28, v29
    v_cvt_pk_bf16_f32 v93, v30, v31
    s_waitcnt lgkmcnt(3)
    v_mfma_f32_32x32x16_bf16 v[76:91], v[120:123], v[96:99], v[76:91]
    ds_read_b128 v[120:123], v15 offset:3200
    v_exp_f32 v32, v32
    v_exp_f32 v33, v33
    v_exp_f32 v34, v34
    v_exp_f32 v35, v35
    v_cvt_pk_bf16_f32 v94, v32, v33
    v_cvt_pk_bf16_f32 v95, v34, v35
    s_mov_b64 exec, s[40:41]
    buffer_load_dwordx4 v[148:151], v224, s[8:11], s52 offen sc1
    s_mov_b64 exec, -1
    s_waitcnt lgkmcnt(3)
    v_mfma_f32_32x32x8_bf16 v[44:59], v[112:113], v[104:105], v[44:59]
    ds_read_b64 v[112:113], v11 offset:10240
    v_exp_f32 v36, v36
    v_exp_f32 v37, v37
    v_exp_f32 v38, v38
    v_exp_f32 v39, v39
    v_cvt_pk_bf16_f32 v96, v36, v37
    v_cvt_pk_bf16_f32 v97, v38, v39
    s_waitcnt lgkmcnt(3)
    v_mfma_f32_32x32x16_bf16 v[76:91], v[116:119], v[92:95], v[76:91]
    ds_read_b128 v[116:119], v15 offset:3840
    v_exp_f32 v40, v40
    v_exp_f32 v41, v41
    v_exp_f32 v42, v42
    v_exp_f32 v43, v43
    v_cvt_pk_bf16_f32 v98, v40, v41
    v_cvt_pk_bf16_f32 v99, v42, v43
    s_mov_b64 exec, s[40:41]
    buffer_load_dwordx4 v[152:155], v224, s[8:11], s52 offen offset:640 sc1
    s_mov_b64 exec, -1
    s_waitcnt lgkmcnt(3)
    v_mfma_f32_32x32x16_bf16 v[28:43], v[108:111], v[100:103], v[60:75]
    ds_read_b128 v[108:111], v7 offset:2560
    v_exp_f32 v44, v44
    v_exp_f32 v45, v45
    v_exp_f32 v46, v46
    v_exp_f32 v47, v47
    v_cvt_pk_bf16_f32 v92, v44, v45
    v_cvt_pk_bf16_f32 v93, v46, v47
    s_waitcnt lgkmcnt(3)
    v_mfma_f32_32x32x16_bf16 v[76:91], v[120:123], v[96:99], v[76:91]
    ds_read_b128 v[120:123], v15 offset:4480
    v_exp_f32 v48, v48
    v_exp_f32 v49, v49
    v_exp_f32 v50, v50
    v_exp_f32 v51, v51
    v_cvt_pk_bf16_f32 v94, v48, v49
    v_cvt_pk_bf16_f32 v95, v50, v51
    s_mov_b64 exec, s[40:41]
    buffer_load_dwordx4 v[156:159], v224, s[8:11], s55 offen offset:640 sc1
    s_mov_b64 exec, -1
    s_waitcnt lgkmcnt(3)
    v_mfma_f32_32x32x8_bf16 v[28:43], v[112:113], v[104:105], v[28:43]
    ds_read_b64 v[112:113], v11 offset:10752
    v_exp_f32 v52, v52
    v_exp_f32 v53, v53
    v_exp_f32 v54, v54
    v_exp_f32 v55, v55
    v_cvt_pk_bf16_f32 v96, v52, v53
    v_cvt_pk_bf16_f32 v97, v54, v55
    s_waitcnt lgkmcnt(3)
    v_mfma_f32_32x32x16_bf16 v[76:91], v[116:119], v[92:95], v[76:91]
    ds_read_b128 v[116:119], v237 offset:0
    v_exp_f32 v56, v56
    v_exp_f32 v57, v57
    v_exp_f32 v58, v58
    v_exp_f32 v59, v59
    v_cvt_pk_bf16_f32 v98, v56, v57
    v_cvt_pk_bf16_f32 v99, v58, v59
    s_waitcnt lgkmcnt(3)
    v_mfma_f32_32x32x16_bf16 v[44:59], v[108:111], v[100:103], v[60:75]
    ds_read_b128 v[108:111], v7 offset:3072
    v_exp_f32 v28, v28
    v_exp_f32 v29, v29
    v_exp_f32 v30, v30
    v_exp_f32 v31, v31
    v_cvt_pk_bf16_f32 v92, v28, v29
    v_cvt_pk_bf16_f32 v93, v30, v31
    s_waitcnt lgkmcnt(3)
    v_mfma_f32_32x32x16_bf16 v[76:91], v[120:123], v[96:99], v[76:91]
    ds_read_b128 v[120:123], v237 offset:640
    v_exp_f32 v32, v32
    v_exp_f32 v33, v33
    v_exp_f32 v34, v34
    v_exp_f32 v35, v35
    v_cvt_pk_bf16_f32 v94, v32, v33
    v_cvt_pk_bf16_f32 v95, v34, v35
    s_waitcnt lgkmcnt(3)
    v_mfma_f32_32x32x8_bf16 v[44:59], v[112:113], v[104:105], v[44:59]
    ds_read_b64 v[112:113], v11 offset:11264
    v_exp_f32 v36, v36
    v_exp_f32 v37, v37
    v_exp_f32 v38, v38
    v_exp_f32 v39, v39
    v_cvt_pk_bf16_f32 v96, v36, v37
    v_cvt_pk_bf16_f32 v97, v38, v39
    s_waitcnt lgkmcnt(3)
    v_mfma_f32_32x32x16_bf16 v[76:91], v[116:119], v[92:95], v[76:91]
    ds_read_b128 v[116:119], v237 offset:1280
    v_exp_f32 v40, v40
    v_exp_f32 v41, v41
    v_exp_f32 v42, v42
    v_exp_f32 v43, v43
    v_cvt_pk_bf16_f32 v98, v40, v41
    v_cvt_pk_bf16_f32 v99, v42, v43
    s_waitcnt lgkmcnt(3)
    v_mfma_f32_32x32x16_bf16 v[28:43], v[108:111], v[100:103], v[60:75]
    ds_read_b128 v[108:111], v7 offset:3584
    v_exp_f32 v44, v44
    v_exp_f32 v45, v45
    v_exp_f32 v46, v46
    v_exp_f32 v47, v47
    v_cvt_pk_bf16_f32 v92, v44, v45
    v_cvt_pk_bf16_f32 v93, v46, v47
    s_waitcnt lgkmcnt(3)
    v_mfma_f32_32x32x16_bf16 v[76:91], v[120:123], v[96:99], v[76:91]
    ds_read_b128 v[120:123], v237 offset:1920
    v_exp_f32 v48, v48
    v_exp_f32 v49, v49
    v_exp_f32 v50, v50
    v_exp_f32 v51, v51
    v_cvt_pk_bf16_f32 v94, v48, v49
    v_cvt_pk_bf16_f32 v95, v50, v51
    s_waitcnt lgkmcnt(3)
    v_mfma_f32_32x32x8_bf16 v[28:43], v[112:113], v[104:105], v[28:43]
    ds_read_b64 v[112:113], v11 offset:11776
    v_exp_f32 v52, v52
    v_exp_f32 v53, v53
    v_exp_f32 v54, v54
    v_exp_f32 v55, v55
    v_cvt_pk_bf16_f32 v96, v52, v53
    v_cvt_pk_bf16_f32 v97, v54, v55
    s_waitcnt lgkmcnt(3)
    v_mfma_f32_32x32x16_bf16 v[76:91], v[116:119], v[92:95], v[76:91]
    ds_read_b128 v[116:119], v237 offset:2560
    v_exp_f32 v56, v56
    v_exp_f32 v57, v57
    v_exp_f32 v58, v58
    v_exp_f32 v59, v59
    v_cvt_pk_bf16_f32 v98, v56, v57
    v_cvt_pk_bf16_f32 v99, v58, v59
    s_barrier
    s_waitcnt lgkmcnt(3)
    v_mfma_f32_32x32x16_bf16 v[44:59], v[108:111], v[100:103], v[60:75]
    ds_read_b128 v[108:111], v4 offset:0
    v_exp_f32 v28, v28
    v_exp_f32 v29, v29
    v_exp_f32 v30, v30
    v_exp_f32 v31, v31
    v_cvt_pk_bf16_f32 v92, v28, v29
    v_cvt_pk_bf16_f32 v93, v30, v31
    s_waitcnt lgkmcnt(3)
    v_mfma_f32_32x32x16_bf16 v[76:91], v[120:123], v[96:99], v[76:91]
    ds_read_b128 v[120:123], v237 offset:3200
    v_exp_f32 v32, v32
    v_exp_f32 v33, v33
    v_exp_f32 v34, v34
    v_exp_f32 v35, v35
    v_cvt_pk_bf16_f32 v94, v32, v33
    v_cvt_pk_bf16_f32 v95, v34, v35
    s_waitcnt lgkmcnt(3)
    v_mfma_f32_32x32x8_bf16 v[44:59], v[112:113], v[104:105], v[44:59]
    ds_read_b64 v[112:113], v8 offset:8192
    v_exp_f32 v36, v36
    v_exp_f32 v37, v37
    v_exp_f32 v38, v38
    v_exp_f32 v39, v39
    v_cvt_pk_bf16_f32 v96, v36, v37
    v_cvt_pk_bf16_f32 v97, v38, v39
    s_waitcnt lgkmcnt(3)
    v_mfma_f32_32x32x16_bf16 v[76:91], v[116:119], v[92:95], v[76:91]
    ds_read_b128 v[116:119], v237 offset:3840
    v_exp_f32 v40, v40
    v_exp_f32 v41, v41
    v_exp_f32 v42, v42
    v_exp_f32 v43, v43
    v_cvt_pk_bf16_f32 v98, v40, v41
    v_cvt_pk_bf16_f32 v99, v42, v43
    s_waitcnt vmcnt(0)
    v_mfma_f32_32x32x16_bf16 v[160:175], v[132:135], v[124:127], 0
    v_mfma_f32_32x32x16_bf16 v[176:191], v[140:143], v[124:127], 0
    v_mfma_f32_32x32x8_bf16 v[160:175], v[136:137], v[128:129], v[160:175]
    v_mfma_f32_32x32x8_bf16 v[176:191], v[144:145], v[128:129], v[176:191]
    v_mov_b32 v20, 0xf149f2ca
    s_cmp_eq_u32 s31, 0
    s_cselect_b32 s35, 0, -1
    s_nop 7
    s_nop 5
    s_mov_b32 s38, 0xff
    s_mov_b32 s39, 0x3fc
    v_cndmask_b32 v160, v20, v160, s[38:39]
    s_mov_b32 s38, 0x1fe
    s_mov_b32 s39, 0x7f8
    v_cndmask_b32 v161, v20, v161, s[38:39]
    s_mov_b32 s38, 0xff0
    s_mov_b32 s39, 0x3fc0
    v_cndmask_b32 v162, v20, v162, s[38:39]
    s_mov_b32 s38, 0x1fe0
    s_mov_b32 s39, 0x7f80
    v_cndmask_b32 v163, v20, v163, s[38:39]
    s_mov_b32 s38, 0xff00
    s_mov_b32 s39, 0x3fc00
    v_cndmask_b32 v164, v20, v164, s[38:39]
    s_mov_b32 s38, 0x1fe00
    s_mov_b32 s39, 0x7f800
    v_cndmask_b32 v165, v20, v165, s[38:39]
    s_mov_b32 s38, 0xff000
    s_mov_b32 s39, 0x3fc000
    v_cndmask_b32 v166, v20, v166, s[38:39]
    s_mov_b32 s38, 0x1fe000
    s_mov_b32 s39, 0x7f8000
    v_cndmask_b32 v167, v20, v167, s[38:39]
    s_mov_b32 s38, 0xff0000
    s_mov_b32 s39, 0x3fc0000
    v_cndmask_b32 v168, v20, v168, s[38:39]
    s_mov_b32 s38, 0x1fe0000
    s_mov_b32 s39, 0x7f80000
    v_cndmask_b32 v169, v20, v169, s[38:39]
    s_mov_b32 s38, 0xff00000
    s_mov_b32 s39, 0x3fc00000
    v_cndmask_b32 v170, v20, v170, s[38:39]
    s_mov_b32 s38, 0x1fe00000
    s_mov_b32 s39, 0x7f800000
    v_cndmask_b32 v171, v20, v171, s[38:39]
    s_mov_b32 s38, 0xff000000
    s_mov_b32 s39, 0xfc000000
    v_cndmask_b32 v172, v20, v172, s[38:39]
    s_mov_b32 s38, 0xfe000000
    s_mov_b32 s39, 0xf8000000
    v_cndmask_b32 v173, v20, v173, s[38:39]
    s_mov_b32 s38, 0xf0000000
    s_mov_b32 s39, 0xc0000000
    v_cndmask_b32 v174, v20, v174, s[38:39]
    s_mov_b32 s38, 0xe0000000
    s_mov_b32 s39, 0x80000000
    v_cndmask_b32 v175, v20, v175, s[38:39]
    s_and_b32 s38, s35, 0x0
    s_and_b32 s39, s35, 0x3
    v_cndmask_b32 v188, v20, v188, s[38:39]
    s_and_b32 s38, s35, 0x1
    s_and_b32 s39, s35, 0x7
    v_cndmask_b32 v189, v20, v189, s[38:39]
    s_and_b32 s38, s35, 0xf
    s_and_b32 s39, s35, 0x3f
    v_cndmask_b32 v190, v20, v190, s[38:39]
    s_and_b32 s38, s35, 0x1f
    s_and_b32 s39, s35, 0x7f
    v_cndmask_b32 v191, v20, v191, s[38:39]
    v_max3_f32 v21, v160, v161, v162
    v_max3_f32 v21, v21, v163, v164
    v_max3_f32 v21, v21, v165, v166
    v_max3_f32 v21, v21, v167, v168
    v_max3_f32 v21, v21, v169, v170
    v_max3_f32 v21, v21, v171, v172
    v_max3_f32 v21, v21, v173, v174
    v_max_f32 v21, v21, v175
    v_max3_f32 v21, v21, v188, v189
    v_max3_f32 v21, v21, v190, v191
    v_mov_b32 v22, v21
    s_nop 1
    v_permlane32_swap_b32 v21, v22
    s_nop 1
    v_max_f32 v21, v21, v22
    v_sub_f32 v160, v160, v21
    v_sub_f32 v161, v161, v21
    v_sub_f32 v162, v162, v21
    v_sub_f32 v163, v163, v21
    v_sub_f32 v164, v164, v21
    v_sub_f32 v165, v165, v21
    v_sub_f32 v166, v166, v21
    v_sub_f32 v167, v167, v21
    v_sub_f32 v168, v168, v21
    v_sub_f32 v169, v169, v21
    v_sub_f32 v170, v170, v21
    v_sub_f32 v171, v171, v21
    v_sub_f32 v172, v172, v21
    v_sub_f32 v173, v173, v21
    v_sub_f32 v174, v174, v21
    v_sub_f32 v175, v175, v21
    v_sub_f32 v188, v188, v21
    v_sub_f32 v189, v189, v21
    v_sub_f32 v190, v190, v21
    v_sub_f32 v191, v191, v21
    v_exp_f32 v160, v160
    v_exp_f32 v161, v161
    v_exp_f32 v162, v162
    v_exp_f32 v163, v163
    v_cvt_pk_bf16_f32 v208, v160, v161
    v_cvt_pk_bf16_f32 v209, v162, v163
    v_exp_f32 v164, v164
    v_exp_f32 v165, v165
    v_exp_f32 v166, v166
    v_exp_f32 v167, v167
    v_cvt_pk_bf16_f32 v210, v164, v165
    v_cvt_pk_bf16_f32 v211, v166, v167
    v_exp_f32 v168, v168
    v_exp_f32 v169, v169
    v_exp_f32 v170, v170
    v_exp_f32 v171, v171
    v_cvt_pk_bf16_f32 v212, v168, v169
    v_cvt_pk_bf16_f32 v213, v170, v171
    v_exp_f32 v172, v172
    v_exp_f32 v173, v173
    v_exp_f32 v174, v174
    v_exp_f32 v175, v175
    v_cvt_pk_bf16_f32 v214, v172, v173
    v_cvt_pk_bf16_f32 v215, v174, v175
    v_exp_f32 v188, v188
    v_exp_f32 v189, v189
    v_exp_f32 v190, v190
    v_exp_f32 v191, v191
    v_mov_b32 v216, 0
    v_mov_b32 v217, 0
    v_cvt_pk_bf16_f32 v218, v188, v189
    v_cvt_pk_bf16_f32 v219, v190, v191
    s_nop 1
    v_mfma_f32_32x32x16_bf16 v[192:207], v[148:151], v[208:211], 0
    v_mfma_f32_32x32x16_bf16 v[192:207], v[152:155], v[212:215], v[192:207]
    v_mfma_f32_32x32x16_bf16 v[192:207], v[156:159], v[216:219], v[192:207]
    s_nop 7
    s_nop 3
    v_mov_b32 v20, v200
    v_mov_b32 v21, v200
    s_nop 1
    v_permlane32_swap_b32 v20, v21
    s_nop 1
    v_rcp_f32 v22, v21
    s_lshl_b32 s32, s30, 4
    s_add_u32 s32, s32, 18350080
    v_sub_f32 v20, 1.0, v18
    v_mul_f32 v22, v22, v20
    v_mov_b32 v23, v22
    v_pk_mul_f32 v[192:193], v[192:193], v[22:23]
    v_pk_mul_f32 v[194:195], v[194:195], v[22:23]
    v_pk_mul_f32 v[196:197], v[196:197], v[22:23]
    v_pk_mul_f32 v[198:199], v[198:199], v[22:23]
    v_pk_mul_f32 v[200:201], v[200:201], v[22:23]
    v_pk_mul_f32 v[202:203], v[202:203], v[22:23]
    v_cvt_pk_bf16_f32 v192, v192, v193
    v_cvt_pk_bf16_f32 v193, v194, v195
    v_cvt_pk_bf16_f32 v194, v196, v197
    v_cvt_pk_bf16_f32 v195, v198, v199
    v_cvt_pk_bf16_f32 v200, v200, v201
    v_cvt_pk_bf16_f32 v201, v202, v203
    v_permlane32_swap_b32 v192, v194
    v_permlane32_swap_b32 v193, v195
    buffer_store_dwordx4 v[192:195], v253, s[8:11], s32 offen sc1
    s_mov_b32 exec_hi, 0
    buffer_store_dwordx2 v[200:201], v255, s[8:11], s32 offen sc1
    s_mov_b64 exec, -1
    s_waitcnt lgkmcnt(3)
    v_mfma_f32_32x32x16_bf16 v[28:43], v[108:111], v[100:103], v[60:75]
    ds_read_b128 v[108:111], v4 offset:512
    v_exp_f32 v44, v44
    v_exp_f32 v45, v45
    v_exp_f32 v46, v46
    v_exp_f32 v47, v47
    v_cvt_pk_bf16_f32 v92, v44, v45
    v_cvt_pk_bf16_f32 v93, v46, v47
    s_waitcnt lgkmcnt(3)
    v_mfma_f32_32x32x16_bf16 v[76:91], v[120:123], v[96:99], v[76:91]
    ds_read_b128 v[120:123], v237 offset:4480
    v_exp_f32 v48, v48
    v_exp_f32 v49, v49
    v_exp_f32 v50, v50
    v_exp_f32 v51, v51
    v_cvt_pk_bf16_f32 v94, v48, v49
    v_cvt_pk_bf16_f32 v95, v50, v51
    s_waitcnt lgkmcnt(3)
    v_mfma_f32_32x32x8_bf16 v[28:43], v[112:113], v[104:105], v[28:43]
    ds_read_b64 v[112:113], v8 offset:8704
    v_exp_f32 v52, v52
    v_exp_f32 v53, v53
    v_exp_f32 v54, v54
    v_exp_f32 v55, v55
    v_cvt_pk_bf16_f32 v96, v52, v53
    v_cvt_pk_bf16_f32 v97, v54, v55
    s_waitcnt lgkmcnt(3)
    v_mfma_f32_32x32x16_bf16 v[76:91], v[116:119], v[92:95], v[76:91]
    ds_read_b128 v[116:119], v12 offset:0
    v_exp_f32 v56, v56
    v_exp_f32 v57, v57
    v_exp_f32 v58, v58
    v_exp_f32 v59, v59
    v_cvt_pk_bf16_f32 v98, v56, v57
    v_cvt_pk_bf16_f32 v99, v58, v59
    s_waitcnt lgkmcnt(3)
    v_mfma_f32_32x32x16_bf16 v[44:59], v[108:111], v[100:103], v[60:75]
    ds_read_b128 v[108:111], v4 offset:1024
    v_exp_f32 v28, v28
    v_exp_f32 v29, v29
    v_exp_f32 v30, v30
    v_exp_f32 v31, v31
    v_cvt_pk_bf16_f32 v92, v28, v29
    v_cvt_pk_bf16_f32 v93, v30, v31
    s_waitcnt lgkmcnt(3)
    v_mfma_f32_32x32x16_bf16 v[76:91], v[120:123], v[96:99], v[76:91]
    ds_read_b128 v[120:123], v12 offset:640
    v_exp_f32 v32, v32
    v_exp_f32 v33, v33
    v_exp_f32 v34, v34
    v_exp_f32 v35, v35
    v_cvt_pk_bf16_f32 v94, v32, v33
    v_cvt_pk_bf16_f32 v95, v34, v35
    s_add_u32 m0, s21, 45056
    v_mad_u32_u24 v250, v247, 6, v244
    buffer_load_dwordx4 v250, s[8:11], 0 offen sc1 lds
    s_waitcnt lgkmcnt(3)
    v_mfma_f32_32x32x8_bf16 v[44:59], v[112:113], v[104:105], v[44:59]
    ds_read_b64 v[112:113], v8 offset:9216
    v_exp_f32 v36, v36
    v_exp_f32 v37, v37
    v_exp_f32 v38, v38
    v_exp_f32 v39, v39
    v_cvt_pk_bf16_f32 v96, v36, v37
    v_cvt_pk_bf16_f32 v97, v38, v39
    s_waitcnt lgkmcnt(3)
    v_mfma_f32_32x32x16_bf16 v[76:91], v[116:119], v[92:95], v[76:91]
    ds_read_b128 v[116:119], v12 offset:1280
    v_exp_f32 v40, v40
    v_exp_f32 v41, v41
    v_exp_f32 v42, v42
    v_exp_f32 v43, v43
    v_cvt_pk_bf16_f32 v98, v40, v41
    v_cvt_pk_bf16_f32 v99, v42, v43
    s_add_u32 m0, s21, 46080
    v_mad_u32_u24 v250, v248, 6, v245
    buffer_load_dwordx4 v250, s[8:11], 0 offen sc1 lds
    s_waitcnt lgkmcnt(3)
    v_mfma_f32_32x32x16_bf16 v[28:43], v[108:111], v[100:103], v[60:75]
    ds_read_b128 v[108:111], v4 offset:1536
    v_exp_f32 v44, v44
    v_exp_f32 v45, v45
    v_exp_f32 v46, v46
    v_exp_f32 v47, v47
    v_cvt_pk_bf16_f32 v92, v44, v45
    v_cvt_pk_bf16_f32 v93, v46, v47
    s_waitcnt lgkmcnt(3)
    v_mfma_f32_32x32x16_bf16 v[76:91], v[120:123], v[96:99], v[76:91]
    ds_read_b128 v[120:123], v12 offset:1920
    v_exp_f32 v48, v48
    v_exp_f32 v49, v49
    v_exp_f32 v50, v50
    v_exp_f32 v51, v51
    v_cvt_pk_bf16_f32 v94, v48, v49
    v_cvt_pk_bf16_f32 v95, v50, v51
    s_add_u32 m0, s21, 47104
    v_mad_u32_u24 v250, v249, 6, v246
    s_mov_b32 exec_hi, 0xffff
    buffer_load_dwordx4 v250, s[8:11], 0 offen sc1 lds
    s_mov_b32 exec_hi, -1
    s_waitcnt lgkmcnt(3)
    v_mfma_f32_32x32x8_bf16 v[28:43], v[112:113], v[104:105], v[28:43]
    ds_read_b64 v[112:113], v8 offset:9728
    v_exp_f32 v52, v52
    v_exp_f32 v53, v53
    v_exp_f32 v54, v54
    v_exp_f32 v55, v55
    v_cvt_pk_bf16_f32 v96, v52, v53
    v_cvt_pk_bf16_f32 v97, v54, v55
    s_waitcnt lgkmcnt(3)
    v_mfma_f32_32x32x16_bf16 v[76:91], v[116:119], v[92:95], v[76:91]
    ds_read_b128 v[116:119], v12 offset:2560
    v_exp_f32 v56, v56
    v_exp_f32 v57, v57
    v_exp_f32 v58, v58
    v_exp_f32 v59, v59
    v_cvt_pk_bf16_f32 v98, v56, v57
    v_cvt_pk_bf16_f32 v99, v58, v59
    s_waitcnt lgkmcnt(3)
    v_mfma_f32_32x32x16_bf16 v[44:59], v[108:111], v[100:103], v[60:75]
    ds_read_b128 v[108:111], v4 offset:2048
    v_exp_f32 v28, v28
    v_exp_f32 v29, v29
    v_exp_f32 v30, v30
    v_exp_f32 v31, v31
    v_cvt_pk_bf16_f32 v92, v28, v29
    v_cvt_pk_bf16_f32 v93, v30, v31
    s_waitcnt lgkmcnt(3)
    v_mfma_f32_32x32x16_bf16 v[76:91], v[120:123], v[96:99], v[76:91]
    ds_read_b128 v[120:123], v12 offset:3200
    v_exp_f32 v32, v32
    v_exp_f32 v33, v33
    v_exp_f32 v34, v34
    v_exp_f32 v35, v35
    v_cvt_pk_bf16_f32 v94, v32, v33
    v_cvt_pk_bf16_f32 v95, v34, v35
    s_waitcnt lgkmcnt(3)
    v_mfma_f32_32x32x8_bf16 v[44:59], v[112:113], v[104:105], v[44:59]
    ds_read_b64 v[112:113], v8 offset:10240
    v_exp_f32 v36, v36
    v_exp_f32 v37, v37
    v_exp_f32 v38, v38
    v_exp_f32 v39, v39
    v_cvt_pk_bf16_f32 v96, v36, v37
    v_cvt_pk_bf16_f32 v97, v38, v39
    s_waitcnt lgkmcnt(3)
    v_mfma_f32_32x32x16_bf16 v[76:91], v[116:119], v[92:95], v[76:91]
    ds_read_b128 v[116:119], v12 offset:3840
    v_exp_f32 v40, v40
    v_exp_f32 v41, v41
    v_exp_f32 v42, v42
    v_exp_f32 v43, v43
    v_cvt_pk_bf16_f32 v98, v40, v41
    v_cvt_pk_bf16_f32 v99, v42, v43
    s_waitcnt lgkmcnt(3)
    v_mfma_f32_32x32x16_bf16 v[28:43], v[108:111], v[100:103], v[60:75]
    ds_read_b128 v[108:111], v4 offset:2560
    v_exp_f32 v44, v44
    v_exp_f32 v45, v45
    v_exp_f32 v46, v46
    v_exp_f32 v47, v47
    v_cvt_pk_bf16_f32 v92, v44, v45
    v_cvt_pk_bf16_f32 v93, v46, v47
    s_waitcnt lgkmcnt(3)
    v_mfma_f32_32x32x16_bf16 v[76:91], v[120:123], v[96:99], v[76:91]
    ds_read_b128 v[120:123], v12 offset:4480
    v_exp_f32 v48, v48
    v_exp_f32 v49, v49
    v_exp_f32 v50, v50
    v_exp_f32 v51, v51
    v_cvt_pk_bf16_f32 v94, v48, v49
    v_cvt_pk_bf16_f32 v95, v50, v51
    s_waitcnt lgkmcnt(3)
    v_mfma_f32_32x32x8_bf16 v[28:43], v[112:113], v[104:105], v[28:43]
    ds_read_b64 v[112:113], v8 offset:10752
    v_exp_f32 v52, v52
    v_exp_f32 v53, v53
    v_exp_f32 v54, v54
    v_exp_f32 v55, v55
    v_cvt_pk_bf16_f32 v96, v52, v53
    v_cvt_pk_bf16_f32 v97, v54, v55
    s_waitcnt lgkmcnt(3)
    v_mfma_f32_32x32x16_bf16 v[76:91], v[116:119], v[92:95], v[76:91]
    ds_read_b128 v[116:119], v232 offset:0
    v_exp_f32 v56, v56
    v_exp_f32 v57, v57
    v_exp_f32 v58, v58
    v_exp_f32 v59, v59
    v_cvt_pk_bf16_f32 v98, v56, v57
    v_cvt_pk_bf16_f32 v99, v58, v59
    s_waitcnt lgkmcnt(3)
    v_mfma_f32_32x32x16_bf16 v[44:59], v[108:111], v[100:103], v[60:75]
    ds_read_b128 v[108:111], v4 offset:3072
    v_exp_f32 v28, v28
    v_exp_f32 v29, v29
    v_exp_f32 v30, v30
    v_exp_f32 v31, v31
    v_cvt_pk_bf16_f32 v92, v28, v29
    v_cvt_pk_bf16_f32 v93, v30, v31
    s_waitcnt lgkmcnt(3)
    v_mfma_f32_32x32x16_bf16 v[76:91], v[120:123], v[96:99], v[76:91]
    ds_read_b128 v[120:123], v232 offset:640
    v_exp_f32 v32, v32
    v_exp_f32 v33, v33
    v_exp_f32 v34, v34
    v_exp_f32 v35, v35
    v_cvt_pk_bf16_f32 v94, v32, v33
    v_cvt_pk_bf16_f32 v95, v34, v35
    s_waitcnt lgkmcnt(3)
    v_mfma_f32_32x32x8_bf16 v[44:59], v[112:113], v[104:105], v[44:59]
    ds_read_b64 v[112:113], v8 offset:11264
    v_exp_f32 v36, v36
    v_exp_f32 v37, v37
    v_exp_f32 v38, v38
    v_exp_f32 v39, v39
    v_cvt_pk_bf16_f32 v96, v36, v37
    v_cvt_pk_bf16_f32 v97, v38, v39
    s_waitcnt lgkmcnt(3)
    v_mfma_f32_32x32x16_bf16 v[76:91], v[116:119], v[92:95], v[76:91]
    ds_read_b128 v[116:119], v232 offset:1280
    v_exp_f32 v40, v40
    v_exp_f32 v41, v41
    v_exp_f32 v42, v42
    v_exp_f32 v43, v43
    v_cvt_pk_bf16_f32 v98, v40, v41
    v_cvt_pk_bf16_f32 v99, v42, v43
    s_waitcnt lgkmcnt(3)
    v_mfma_f32_32x32x16_bf16 v[28:43], v[108:111], v[100:103], v[60:75]
    ds_read_b128 v[108:111], v4 offset:3584
    v_exp_f32 v44, v44
    v_exp_f32 v45, v45
    v_exp_f32 v46, v46
    v_exp_f32 v47, v47
    v_cvt_pk_bf16_f32 v92, v44, v45
    v_cvt_pk_bf16_f32 v93, v46, v47
    s_waitcnt lgkmcnt(3)
    v_mfma_f32_32x32x16_bf16 v[76:91], v[120:123], v[96:99], v[76:91]
    ds_read_b128 v[120:123], v232 offset:1920
    v_exp_f32 v48, v48
    v_exp_f32 v49, v49
    v_exp_f32 v50, v50
    v_exp_f32 v51, v51
    v_cvt_pk_bf16_f32 v94, v48, v49
    v_cvt_pk_bf16_f32 v95, v50, v51
    s_waitcnt lgkmcnt(3)
    v_mfma_f32_32x32x8_bf16 v[28:43], v[112:113], v[104:105], v[28:43]
    ds_read_b64 v[112:113], v8 offset:11776
    v_exp_f32 v52, v52
    v_exp_f32 v53, v53
    v_exp_f32 v54, v54
    v_exp_f32 v55, v55
    v_cvt_pk_bf16_f32 v96, v52, v53
    v_cvt_pk_bf16_f32 v97, v54, v55
    s_waitcnt lgkmcnt(3)
    v_mfma_f32_32x32x16_bf16 v[76:91], v[116:119], v[92:95], v[76:91]
    ds_read_b128 v[116:119], v232 offset:2560
    v_exp_f32 v56, v56
    v_exp_f32 v57, v57
    v_exp_f32 v58, v58
    v_exp_f32 v59, v59
    v_cvt_pk_bf16_f32 v98, v56, v57
    v_cvt_pk_bf16_f32 v99, v58, v59
    s_barrier
    s_waitcnt lgkmcnt(3)
    v_mfma_f32_32x32x16_bf16 v[44:59], v[108:111], v[100:103], v[60:75]
    ds_read_b128 v[108:111], v5 offset:0
    v_exp_f32 v28, v28
    v_exp_f32 v29, v29
    v_exp_f32 v30, v30
    v_exp_f32 v31, v31
    v_cvt_pk_bf16_f32 v92, v28, v29
    v_cvt_pk_bf16_f32 v93, v30, v31
    s_waitcnt lgkmcnt(3)
    v_mfma_f32_32x32x16_bf16 v[76:91], v[120:123], v[96:99], v[76:91]
    ds_read_b128 v[120:123], v232 offset:3200
    v_exp_f32 v32, v32
    v_exp_f32 v33, v33
    v_exp_f32 v34, v34
    v_exp_f32 v35, v35
    v_cvt_pk_bf16_f32 v94, v32, v33
    v_cvt_pk_bf16_f32 v95, v34, v35
    s_waitcnt vmcnt(0)
    v_mov_b32 v20, s17
    v_mov_b32 v21, 0
    s_add_u32 s32, s26, 22626304
    s_mov_b64 exec, 1
    buffer_store_dword v20, v21, s[8:11], s32 offen sc1
    s_mov_b64 exec, -1
    s_waitcnt lgkmcnt(3)
    v_mfma_f32_32x32x8_bf16 v[44:59], v[112:113], v[104:105], v[44:59]
    ds_read_b64 v[112:113], v9 offset:8192
    v_exp_f32 v36, v36
    v_exp_f32 v37, v37
    v_exp_f32 v38, v38
    v_exp_f32 v39, v39
    v_cvt_pk_bf16_f32 v96, v36, v37
    v_cvt_pk_bf16_f32 v97, v38, v39
    s_waitcnt lgkmcnt(3)
    v_mfma_f32_32x32x16_bf16 v[76:91], v[116:119], v[92:95], v[76:91]
    ds_read_b128 v[116:119], v232 offset:3840
    v_exp_f32 v40, v40
    v_exp_f32 v41, v41
    v_exp_f32 v42, v42
    v_exp_f32 v43, v43
    v_cvt_pk_bf16_f32 v98, v40, v41
    v_cvt_pk_bf16_f32 v99, v42, v43
    s_waitcnt lgkmcnt(3)
    v_mfma_f32_32x32x16_bf16 v[28:43], v[108:111], v[100:103], v[60:75]
    ds_read_b128 v[108:111], v5 offset:512
    v_exp_f32 v44, v44
    v_exp_f32 v45, v45
    v_exp_f32 v46, v46
    v_exp_f32 v47, v47
    v_cvt_pk_bf16_f32 v92, v44, v45
    v_cvt_pk_bf16_f32 v93, v46, v47
    s_waitcnt lgkmcnt(3)
    v_mfma_f32_32x32x16_bf16 v[76:91], v[120:123], v[96:99], v[76:91]
    ds_read_b128 v[120:123], v232 offset:4480
    v_exp_f32 v48, v48
    v_exp_f32 v49, v49
    v_exp_f32 v50, v50
    v_exp_f32 v51, v51
    v_cvt_pk_bf16_f32 v94, v48, v49
    v_cvt_pk_bf16_f32 v95, v50, v51
    s_add_u32 m0, s21, 67584
    v_mad_u32_u24 v250, v247, 7, v244
    buffer_load_dwordx4 v250, s[8:11], 0 offen sc1 lds
    s_waitcnt lgkmcnt(3)
    v_mfma_f32_32x32x8_bf16 v[28:43], v[112:113], v[104:105], v[28:43]
    ds_read_b64 v[112:113], v9 offset:8704
    v_exp_f32 v52, v52
    v_exp_f32 v53, v53
    v_exp_f32 v54, v54
    v_exp_f32 v55, v55
    v_cvt_pk_bf16_f32 v96, v52, v53
    v_cvt_pk_bf16_f32 v97, v54, v55
    s_waitcnt lgkmcnt(3)
    v_mfma_f32_32x32x16_bf16 v[76:91], v[116:119], v[92:95], v[76:91]
    ds_read_b128 v[116:119], v13 offset:0
    v_exp_f32 v56, v56
    v_exp_f32 v57, v57
    v_exp_f32 v58, v58
    v_exp_f32 v59, v59
    v_cvt_pk_bf16_f32 v98, v56, v57
    v_cvt_pk_bf16_f32 v99, v58, v59
    s_add_u32 m0, s21, 68608
    v_mad_u32_u24 v250, v248, 7, v245
    buffer_load_dwordx4 v250, s[8:11], 0 offen sc1 lds
    s_waitcnt lgkmcnt(3)
    v_mfma_f32_32x32x16_bf16 v[44:59], v[108:111], v[100:103], v[60:75]
    ds_read_b128 v[108:111], v5 offset:1024
    v_exp_f32 v28, v28
    v_exp_f32 v29, v29
    v_exp_f32 v30, v30
    v_exp_f32 v31, v31
    v_cvt_pk_bf16_f32 v92, v28, v29
    v_cvt_pk_bf16_f32 v93, v30, v31
    s_waitcnt lgkmcnt(3)
    v_mfma_f32_32x32x16_bf16 v[76:91], v[120:123], v[96:99], v[76:91]
    ds_read_b128 v[120:123], v13 offset:640
    v_exp_f32 v32, v32
    v_exp_f32 v33, v33
    v_exp_f32 v34, v34
    v_exp_f32 v35, v35
    v_cvt_pk_bf16_f32 v94, v32, v33
    v_cvt_pk_bf16_f32 v95, v34, v35
    s_add_u32 m0, s21, 69632
    v_mad_u32_u24 v250, v249, 7, v246
    s_mov_b32 exec_hi, 0xffff
    buffer_load_dwordx4 v250, s[8:11], 0 offen sc1 lds
    s_mov_b32 exec_hi, -1
    s_waitcnt lgkmcnt(3)
    v_mfma_f32_32x32x8_bf16 v[44:59], v[112:113], v[104:105], v[44:59]
    ds_read_b64 v[112:113], v9 offset:9216
    v_exp_f32 v36, v36
    v_exp_f32 v37, v37
    v_exp_f32 v38, v38
    v_exp_f32 v39, v39
    v_cvt_pk_bf16_f32 v96, v36, v37
    v_cvt_pk_bf16_f32 v97, v38, v39
    s_waitcnt lgkmcnt(3)
    v_mfma_f32_32x32x16_bf16 v[76:91], v[116:119], v[92:95], v[76:91]
    ds_read_b128 v[116:119], v13 offset:1280
    v_exp_f32 v40, v40
    v_exp_f32 v41, v41
    v_exp_f32 v42, v42
    v_exp_f32 v43, v43
    v_cvt_pk_bf16_f32 v98, v40, v41
    v_cvt_pk_bf16_f32 v99, v42, v43
    s_waitcnt lgkmcnt(3)
    v_mfma_f32_32x32x16_bf16 v[28:43], v[108:111], v[100:103], v[60:75]
    ds_read_b128 v[108:111], v5 offset:1536
    v_exp_f32 v44, v44
    v_exp_f32 v45, v45
    v_exp_f32 v46, v46
    v_exp_f32 v47, v47
    v_cvt_pk_bf16_f32 v92, v44, v45
    v_cvt_pk_bf16_f32 v93, v46, v47
    s_waitcnt lgkmcnt(3)
    v_mfma_f32_32x32x16_bf16 v[76:91], v[120:123], v[96:99], v[76:91]
    ds_read_b128 v[120:123], v13 offset:1920
    v_exp_f32 v48, v48
    v_exp_f32 v49, v49
    v_exp_f32 v50, v50
    v_exp_f32 v51, v51
    v_cvt_pk_bf16_f32 v94, v48, v49
    v_cvt_pk_bf16_f32 v95, v50, v51
    s_waitcnt lgkmcnt(3)
    v_mfma_f32_32x32x8_bf16 v[28:43], v[112:113], v[104:105], v[28:43]
    ds_read_b64 v[112:113], v9 offset:9728
    v_exp_f32 v52, v52
    v_exp_f32 v53, v53
    v_exp_f32 v54, v54
    v_exp_f32 v55, v55
    v_cvt_pk_bf16_f32 v96, v52, v53
    v_cvt_pk_bf16_f32 v97, v54, v55
    s_waitcnt lgkmcnt(3)
    v_mfma_f32_32x32x16_bf16 v[76:91], v[116:119], v[92:95], v[76:91]
    ds_read_b128 v[116:119], v13 offset:2560
    v_exp_f32 v56, v56
    v_exp_f32 v57, v57
    v_exp_f32 v58, v58
    v_exp_f32 v59, v59
    v_cvt_pk_bf16_f32 v98, v56, v57
    v_cvt_pk_bf16_f32 v99, v58, v59
    s_add_u32 m0, s22, 100864
    s_add_u32 s32, s23, 819200
    buffer_load_dwordx4 v225, s[8:11], s32 offen sc1 lds
    s_waitcnt lgkmcnt(3)
    v_mfma_f32_32x32x16_bf16 v[44:59], v[108:111], v[100:103], v[60:75]
    ds_read_b128 v[108:111], v5 offset:2048
    v_exp_f32 v28, v28
    v_exp_f32 v29, v29
    v_exp_f32 v30, v30
    v_exp_f32 v31, v31
    v_cvt_pk_bf16_f32 v92, v28, v29
    v_cvt_pk_bf16_f32 v93, v30, v31
    s_waitcnt lgkmcnt(3)
    v_mfma_f32_32x32x16_bf16 v[76:91], v[120:123], v[96:99], v[76:91]
    ds_read_b128 v[120:123], v13 offset:3200
    v_exp_f32 v32, v32
    v_exp_f32 v33, v33
    v_exp_f32 v34, v34
    v_exp_f32 v35, v35
    v_cvt_pk_bf16_f32 v94, v32, v33
    v_cvt_pk_bf16_f32 v95, v34, v35
    s_add_u32 m0, s22, 101888
    s_add_u32 s32, s23, 819200
    buffer_load_dwordx4 v226, s[8:11], s32 offen sc1 lds
    s_waitcnt lgkmcnt(3)
    v_mfma_f32_32x32x8_bf16 v[44:59], v[112:113], v[104:105], v[44:59]
    ds_read_b64 v[112:113], v9 offset:10240
    v_exp_f32 v36, v36
    v_exp_f32 v37, v37
    v_exp_f32 v38, v38
    v_exp_f32 v39, v39
    v_cvt_pk_bf16_f32 v96, v36, v37
    v_cvt_pk_bf16_f32 v97, v38, v39
    s_waitcnt lgkmcnt(3)
    v_mfma_f32_32x32x16_bf16 v[76:91], v[116:119], v[92:95], v[76:91]
    ds_read_b128 v[116:119], v13 offset:3840
    v_exp_f32 v40, v40
    v_exp_f32 v41, v41
    v_exp_f32 v42, v42
    v_exp_f32 v43, v43
    v_cvt_pk_bf16_f32 v98, v40, v41
    v_cvt_pk_bf16_f32 v99, v42, v43
    s_add_u32 m0, s22, 102912
    s_add_u32 s32, s23, 819200
    s_mov_b32 exec_hi, 0
    buffer_load_dwordx4 v227, s[8:11], s32 offen sc1 lds
    s_mov_b32 exec_hi, -1
    s_waitcnt lgkmcnt(3)
    v_mfma_f32_32x32x16_bf16 v[28:43], v[108:111], v[100:103], v[60:75]
    ds_read_b128 v[108:111], v5 offset:2560
    v_exp_f32 v44, v44
    v_exp_f32 v45, v45
    v_exp_f32 v46, v46
    v_exp_f32 v47, v47
    v_cvt_pk_bf16_f32 v92, v44, v45
    v_cvt_pk_bf16_f32 v93, v46, v47
    s_waitcnt lgkmcnt(3)
    v_mfma_f32_32x32x16_bf16 v[76:91], v[120:123], v[96:99], v[76:91]
    ds_read_b128 v[120:123], v13 offset:4480
    v_exp_f32 v48, v48
    v_exp_f32 v49, v49
    v_exp_f32 v50, v50
    v_exp_f32 v51, v51
    v_cvt_pk_bf16_f32 v94, v48, v49
    v_cvt_pk_bf16_f32 v95, v50, v51
    s_add_u32 m0, s22, 121344
    s_add_u32 s32, s23, 983040
    buffer_load_dwordx4 v225, s[8:11], s32 offen sc1 lds
    s_waitcnt lgkmcnt(3)
    v_mfma_f32_32x32x8_bf16 v[28:43], v[112:113], v[104:105], v[28:43]
    ds_read_b64 v[112:113], v9 offset:10752
    v_exp_f32 v52, v52
    v_exp_f32 v53, v53
    v_exp_f32 v54, v54
    v_exp_f32 v55, v55
    v_cvt_pk_bf16_f32 v96, v52, v53
    v_cvt_pk_bf16_f32 v97, v54, v55
    s_waitcnt lgkmcnt(3)
    v_mfma_f32_32x32x16_bf16 v[76:91], v[116:119], v[92:95], v[76:91]
    ds_read_b128 v[116:119], v233 offset:0
    v_exp_f32 v56, v56
    v_exp_f32 v57, v57
    v_exp_f32 v58, v58
    v_exp_f32 v59, v59
    v_cvt_pk_bf16_f32 v98, v56, v57
    v_cvt_pk_bf16_f32 v99, v58, v59
    s_add_u32 m0, s22, 122368
    s_add_u32 s32, s23, 983040
    buffer_load_dwordx4 v226, s[8:11], s32 offen sc1 lds
    s_waitcnt lgkmcnt(3)
    v_mfma_f32_32x32x16_bf16 v[44:59], v[108:111], v[100:103], v[60:75]
    ds_read_b128 v[108:111], v5 offset:3072
    v_exp_f32 v28, v28
    v_exp_f32 v29, v29
    v_exp_f32 v30, v30
    v_exp_f32 v31, v31
    v_cvt_pk_bf16_f32 v92, v28, v29
    v_cvt_pk_bf16_f32 v93, v30, v31
    s_waitcnt lgkmcnt(3)
    v_mfma_f32_32x32x16_bf16 v[76:91], v[120:123], v[96:99], v[76:91]
    ds_read_b128 v[120:123], v233 offset:640
    v_exp_f32 v32, v32
    v_exp_f32 v33, v33
    v_exp_f32 v34, v34
    v_exp_f32 v35, v35
    v_cvt_pk_bf16_f32 v94, v32, v33
    v_cvt_pk_bf16_f32 v95, v34, v35
    s_add_u32 m0, s22, 123392
    s_add_u32 s32, s23, 983040
    s_mov_b32 exec_hi, 0
    buffer_load_dwordx4 v227, s[8:11], s32 offen sc1 lds
    s_mov_b32 exec_hi, -1
    s_waitcnt lgkmcnt(3)
    v_mfma_f32_32x32x8_bf16 v[44:59], v[112:113], v[104:105], v[44:59]
    ds_read_b64 v[112:113], v9 offset:11264
    v_exp_f32 v36, v36
    v_exp_f32 v37, v37
    v_exp_f32 v38, v38
    v_exp_f32 v39, v39
    v_cvt_pk_bf16_f32 v96, v36, v37
    v_cvt_pk_bf16_f32 v97, v38, v39
    s_waitcnt lgkmcnt(3)
    v_mfma_f32_32x32x16_bf16 v[76:91], v[116:119], v[92:95], v[76:91]
    ds_read_b128 v[116:119], v233 offset:1280
    v_exp_f32 v40, v40
    v_exp_f32 v41, v41
    v_exp_f32 v42, v42
    v_exp_f32 v43, v43
    v_cvt_pk_bf16_f32 v98, v40, v41
    v_cvt_pk_bf16_f32 v99, v42, v43
    s_add_u32 m0, s22, 141824
    s_add_u32 s32, s23, 1146880
    buffer_load_dwordx4 v225, s[8:11], s32 offen sc1 lds
    s_waitcnt lgkmcnt(3)
    v_mfma_f32_32x32x16_bf16 v[28:43], v[108:111], v[100:103], v[60:75]
    ds_read_b128 v[108:111], v5 offset:3584
    v_exp_f32 v44, v44
    v_exp_f32 v45, v45
    v_exp_f32 v46, v46
    v_exp_f32 v47, v47
    v_cvt_pk_bf16_f32 v92, v44, v45
    v_cvt_pk_bf16_f32 v93, v46, v47
    s_waitcnt lgkmcnt(3)
    v_mfma_f32_32x32x16_bf16 v[76:91], v[120:123], v[96:99], v[76:91]
    ds_read_b128 v[120:123], v233 offset:1920
    v_exp_f32 v48, v48
    v_exp_f32 v49, v49
    v_exp_f32 v50, v50
    v_exp_f32 v51, v51
    v_cvt_pk_bf16_f32 v94, v48, v49
    v_cvt_pk_bf16_f32 v95, v50, v51
    s_add_u32 m0, s22, 142848
    s_add_u32 s32, s23, 1146880
    buffer_load_dwordx4 v226, s[8:11], s32 offen sc1 lds
    s_waitcnt lgkmcnt(3)
    v_mfma_f32_32x32x8_bf16 v[28:43], v[112:113], v[104:105], v[28:43]
    ds_read_b64 v[112:113], v9 offset:11776
    v_exp_f32 v52, v52
    v_exp_f32 v53, v53
    v_exp_f32 v54, v54
    v_exp_f32 v55, v55
    v_cvt_pk_bf16_f32 v96, v52, v53
    v_cvt_pk_bf16_f32 v97, v54, v55
    s_waitcnt lgkmcnt(3)
    v_mfma_f32_32x32x16_bf16 v[76:91], v[116:119], v[92:95], v[76:91]
    ds_read_b128 v[116:119], v233 offset:2560
    v_exp_f32 v56, v56
    v_exp_f32 v57, v57
    v_exp_f32 v58, v58
    v_exp_f32 v59, v59
    v_cvt_pk_bf16_f32 v98, v56, v57
    v_cvt_pk_bf16_f32 v99, v58, v59
    s_barrier
    s_add_u32 m0, s22, 143872
    s_add_u32 s32, s23, 1146880
    s_mov_b32 exec_hi, 0
    buffer_load_dwordx4 v227, s[8:11], s32 offen sc1 lds
    s_mov_b32 exec_hi, -1
    s_waitcnt lgkmcnt(3)
    v_mfma_f32_32x32x16_bf16 v[44:59], v[108:111], v[100:103], v[60:75]
    ds_read_b128 v[108:111], v6 offset:0
    v_exp_f32 v28, v28
    v_exp_f32 v29, v29
    v_exp_f32 v30, v30
    v_exp_f32 v31, v31
    v_cvt_pk_bf16_f32 v92, v28, v29
    v_cvt_pk_bf16_f32 v93, v30, v31
    s_waitcnt lgkmcnt(3)
    v_mfma_f32_32x32x16_bf16 v[76:91], v[120:123], v[96:99], v[76:91]
    ds_read_b128 v[120:123], v233 offset:3200
    v_exp_f32 v32, v32
    v_exp_f32 v33, v33
    v_exp_f32 v34, v34
    v_exp_f32 v35, v35
    v_cvt_pk_bf16_f32 v94, v32, v33
    v_cvt_pk_bf16_f32 v95, v34, v35
    s_waitcnt lgkmcnt(3)
    v_mfma_f32_32x32x8_bf16 v[44:59], v[112:113], v[104:105], v[44:59]
    ds_read_b64 v[112:113], v10 offset:8192
    v_exp_f32 v36, v36
    v_exp_f32 v37, v37
    v_exp_f32 v38, v38
    v_exp_f32 v39, v39
    v_cvt_pk_bf16_f32 v96, v36, v37
    v_cvt_pk_bf16_f32 v97, v38, v39
    s_waitcnt lgkmcnt(3)
    v_mfma_f32_32x32x16_bf16 v[76:91], v[116:119], v[92:95], v[76:91]
    ds_read_b128 v[116:119], v233 offset:3840
    v_exp_f32 v40, v40
    v_exp_f32 v41, v41
    v_exp_f32 v42, v42
    v_exp_f32 v43, v43
    v_cvt_pk_bf16_f32 v98, v40, v41
    v_cvt_pk_bf16_f32 v99, v42, v43
    s_waitcnt lgkmcnt(3)
    v_mfma_f32_32x32x16_bf16 v[28:43], v[108:111], v[100:103], v[60:75]
    ds_read_b128 v[108:111], v6 offset:512
    v_exp_f32 v44, v44
    v_exp_f32 v45, v45
    v_exp_f32 v46, v46
    v_exp_f32 v47, v47
    v_cvt_pk_bf16_f32 v92, v44, v45
    v_cvt_pk_bf16_f32 v93, v46, v47
    s_waitcnt lgkmcnt(3)
    v_mfma_f32_32x32x16_bf16 v[76:91], v[120:123], v[96:99], v[76:91]
    ds_read_b128 v[120:123], v233 offset:4480
    v_exp_f32 v48, v48
    v_exp_f32 v49, v49
    v_exp_f32 v50, v50
    v_exp_f32 v51, v51
    v_cvt_pk_bf16_f32 v94, v48, v49
    v_cvt_pk_bf16_f32 v95, v50, v51
    s_waitcnt lgkmcnt(3)
    v_mfma_f32_32x32x8_bf16 v[28:43], v[112:113], v[104:105], v[28:43]
    ds_read_b64 v[112:113], v10 offset:8704
    v_exp_f32 v52, v52
    v_exp_f32 v53, v53
    v_exp_f32 v54, v54
    v_exp_f32 v55, v55
    v_cvt_pk_bf16_f32 v96, v52, v53
    v_cvt_pk_bf16_f32 v97, v54, v55
    s_waitcnt lgkmcnt(3)
    v_mfma_f32_32x32x16_bf16 v[76:91], v[116:119], v[92:95], v[76:91]
    ds_read_b128 v[116:119], v14 offset:0
    v_exp_f32 v56, v56
    v_exp_f32 v57, v57
    v_exp_f32 v58, v58
    v_exp_f32 v59, v59
    v_cvt_pk_bf16_f32 v98, v56, v57
    v_cvt_pk_bf16_f32 v99, v58, v59
    s_cmp_lg_u32 s16, 0
    s_cbranch_scc1 L_w0_fb_i
    s_add_u32 s32, s25, 22626304
    buffer_load_dword v19, v231, s[8:11], s32 offen sc1
L_w0_fb_i:
    s_waitcnt lgkmcnt(3)
    v_mfma_f32_32x32x16_bf16 v[44:59], v[108:111], v[100:103], v[60:75]
    ds_read_b128 v[108:111], v6 offset:1024
    v_exp_f32 v28, v28
    v_exp_f32 v29, v29
    v_exp_f32 v30, v30
    v_exp_f32 v31, v31
    v_cvt_pk_bf16_f32 v92, v28, v29
    v_cvt_pk_bf16_f32 v93, v30, v31
    s_waitcnt lgkmcnt(3)
    v_mfma_f32_32x32x16_bf16 v[76:91], v[120:123], v[96:99], v[76:91]
    ds_read_b128 v[120:123], v14 offset:640
    v_exp_f32 v32, v32
    v_exp_f32 v33, v33
    v_exp_f32 v34, v34
    v_exp_f32 v35, v35
    v_cvt_pk_bf16_f32 v94, v32, v33
    v_cvt_pk_bf16_f32 v95, v34, v35
    s_waitcnt lgkmcnt(3)
    v_mfma_f32_32x32x8_bf16 v[44:59], v[112:113], v[104:105], v[44:59]
    ds_read_b64 v[112:113], v10 offset:9216
    v_exp_f32 v36, v36
    v_exp_f32 v37, v37
    v_exp_f32 v38, v38
    v_exp_f32 v39, v39
    v_cvt_pk_bf16_f32 v96, v36, v37
    v_cvt_pk_bf16_f32 v97, v38, v39
    s_waitcnt lgkmcnt(3)
    v_mfma_f32_32x32x16_bf16 v[76:91], v[116:119], v[92:95], v[76:91]
    ds_read_b128 v[116:119], v14 offset:1280
    v_exp_f32 v40, v40
    v_exp_f32 v41, v41
    v_exp_f32 v42, v42
    v_exp_f32 v43, v43
    v_cvt_pk_bf16_f32 v98, v40, v41
    v_cvt_pk_bf16_f32 v99, v42, v43
    s_waitcnt lgkmcnt(3)
    v_mfma_f32_32x32x16_bf16 v[28:43], v[108:111], v[100:103], v[60:75]
    ds_read_b128 v[108:111], v6 offset:1536
    v_exp_f32 v44, v44
    v_exp_f32 v45, v45
    v_exp_f32 v46, v46
    v_exp_f32 v47, v47
    v_cvt_pk_bf16_f32 v92, v44, v45
    v_cvt_pk_bf16_f32 v93, v46, v47
    s_waitcnt lgkmcnt(3)
    v_mfma_f32_32x32x16_bf16 v[76:91], v[120:123], v[96:99], v[76:91]
    ds_read_b128 v[120:123], v14 offset:1920
    v_exp_f32 v48, v48
    v_exp_f32 v49, v49
    v_exp_f32 v50, v50
    v_exp_f32 v51, v51
    v_cvt_pk_bf16_f32 v94, v48, v49
    v_cvt_pk_bf16_f32 v95, v50, v51
    s_waitcnt lgkmcnt(3)
    v_mfma_f32_32x32x8_bf16 v[28:43], v[112:113], v[104:105], v[28:43]
    ds_read_b64 v[112:113], v10 offset:9728
    v_exp_f32 v52, v52
    v_exp_f32 v53, v53
    v_exp_f32 v54, v54
    v_exp_f32 v55, v55
    v_cvt_pk_bf16_f32 v96, v52, v53
    v_cvt_pk_bf16_f32 v97, v54, v55
    s_waitcnt lgkmcnt(3)
    v_mfma_f32_32x32x16_bf16 v[76:91], v[116:119], v[92:95], v[76:91]
    ds_read_b128 v[116:119], v14 offset:2560
    v_exp_f32 v56, v56
    v_exp_f32 v57, v57
    v_exp_f32 v58, v58
    v_exp_f32 v59, v59
    v_cvt_pk_bf16_f32 v98, v56, v57
    v_cvt_pk_bf16_f32 v99, v58, v59
    s_waitcnt lgkmcnt(3)
    v_mfma_f32_32x32x16_bf16 v[44:59], v[108:111], v[100:103], v[60:75]
    ds_read_b128 v[108:111], v6 offset:2048
    v_exp_f32 v28, v28
    v_exp_f32 v29, v29
    v_exp_f32 v30, v30
    v_exp_f32 v31, v31
    v_cvt_pk_bf16_f32 v92, v28, v29
    v_cvt_pk_bf16_f32 v93, v30, v31
    s_waitcnt lgkmcnt(3)
    v_mfma_f32_32x32x16_bf16 v[76:91], v[120:123], v[96:99], v[76:91]
    ds_read_b128 v[120:123], v14 offset:3200
    v_exp_f32 v32, v32
    v_exp_f32 v33, v33
    v_exp_f32 v34, v34
    v_exp_f32 v35, v35
    v_cvt_pk_bf16_f32 v94, v32, v33
    v_cvt_pk_bf16_f32 v95, v34, v35
    s_waitcnt lgkmcnt(3)
    v_mfma_f32_32x32x8_bf16 v[44:59], v[112:113], v[104:105], v[44:59]
    ds_read_b64 v[112:113], v10 offset:10240
    v_exp_f32 v36, v36
    v_exp_f32 v37, v37
    v_exp_f32 v38, v38
    v_exp_f32 v39, v39
    v_cvt_pk_bf16_f32 v96, v36, v37
    v_cvt_pk_bf16_f32 v97, v38, v39
    s_waitcnt lgkmcnt(3)
    v_mfma_f32_32x32x16_bf16 v[76:91], v[116:119], v[92:95], v[76:91]
    ds_read_b128 v[116:119], v14 offset:3840
    v_exp_f32 v40, v40
    v_exp_f32 v41, v41
    v_exp_f32 v42, v42
    v_exp_f32 v43, v43
    v_cvt_pk_bf16_f32 v98, v40, v41
    v_cvt_pk_bf16_f32 v99, v42, v43
    s_waitcnt lgkmcnt(3)
    v_mfma_f32_32x32x16_bf16 v[28:43], v[108:111], v[100:103], v[60:75]
    ds_read_b128 v[108:111], v6 offset:2560
    v_exp_f32 v44, v44
    v_exp_f32 v45, v45
    v_exp_f32 v46, v46
    v_exp_f32 v47, v47
    v_cvt_pk_bf16_f32 v92, v44, v45
    v_cvt_pk_bf16_f32 v93, v46, v47
    s_waitcnt lgkmcnt(3)
    v_mfma_f32_32x32x16_bf16 v[76:91], v[120:123], v[96:99], v[76:91]
    ds_read_b128 v[120:123], v14 offset:4480
    v_exp_f32 v48, v48
    v_exp_f32 v49, v49
    v_exp_f32 v50, v50
    v_exp_f32 v51, v51
    v_cvt_pk_bf16_f32 v94, v48, v49
    v_cvt_pk_bf16_f32 v95, v50, v51
    s_waitcnt lgkmcnt(3)
    v_mfma_f32_32x32x8_bf16 v[28:43], v[112:113], v[104:105], v[28:43]
    ds_read_b64 v[112:113], v10 offset:10752
    v_exp_f32 v52, v52
    v_exp_f32 v53, v53
    v_exp_f32 v54, v54
    v_exp_f32 v55, v55
    v_cvt_pk_bf16_f32 v96, v52, v53
    v_cvt_pk_bf16_f32 v97, v54, v55
    s_waitcnt lgkmcnt(3)
    v_mfma_f32_32x32x16_bf16 v[76:91], v[116:119], v[92:95], v[76:91]
    ds_read_b128 v[116:119], v236 offset:0
    v_exp_f32 v56, v56
    v_exp_f32 v57, v57
    v_exp_f32 v58, v58
    v_exp_f32 v59, v59
    v_cvt_pk_bf16_f32 v98, v56, v57
    v_cvt_pk_bf16_f32 v99, v58, v59
    s_waitcnt lgkmcnt(3)
    v_mfma_f32_32x32x16_bf16 v[44:59], v[108:111], v[100:103], v[60:75]
    ds_read_b128 v[108:111], v6 offset:3072
    v_exp_f32 v28, v28
    v_exp_f32 v29, v29
    v_exp_f32 v30, v30
    v_exp_f32 v31, v31
    v_cvt_pk_bf16_f32 v92, v28, v29
    v_cvt_pk_bf16_f32 v93, v30, v31
    s_waitcnt lgkmcnt(3)
    v_mfma_f32_32x32x16_bf16 v[76:91], v[120:123], v[96:99], v[76:91]
    ds_read_b128 v[120:123], v236 offset:640
    v_exp_f32 v32, v32
    v_exp_f32 v33, v33
    v_exp_f32 v34, v34
    v_exp_f32 v35, v35
    v_cvt_pk_bf16_f32 v94, v32, v33
    v_cvt_pk_bf16_f32 v95, v34, v35
    s_waitcnt lgkmcnt(3)
    v_mfma_f32_32x32x8_bf16 v[44:59], v[112:113], v[104:105], v[44:59]
    ds_read_b64 v[112:113], v10 offset:11264
    v_exp_f32 v36, v36
    v_exp_f32 v37, v37
    v_exp_f32 v38, v38
    v_exp_f32 v39, v39
    v_cvt_pk_bf16_f32 v96, v36, v37
    v_cvt_pk_bf16_f32 v97, v38, v39
    s_waitcnt lgkmcnt(3)
    v_mfma_f32_32x32x16_bf16 v[76:91], v[116:119], v[92:95], v[76:91]
    ds_read_b128 v[116:119], v236 offset:1280
    v_exp_f32 v40, v40
    v_exp_f32 v41, v41
    v_exp_f32 v42, v42
    v_exp_f32 v43, v43
    v_cvt_pk_bf16_f32 v98, v40, v41
    v_cvt_pk_bf16_f32 v99, v42, v43
    s_waitcnt lgkmcnt(3)
    v_mfma_f32_32x32x16_bf16 v[28:43], v[108:111], v[100:103], v[60:75]
    ds_read_b128 v[108:111], v6 offset:3584
    v_exp_f32 v44, v44
    v_exp_f32 v45, v45
    v_exp_f32 v46, v46
    v_exp_f32 v47, v47
    v_cvt_pk_bf16_f32 v92, v44, v45
    v_cvt_pk_bf16_f32 v93, v46, v47
    s_waitcnt lgkmcnt(3)
    v_mfma_f32_32x32x16_bf16 v[76:91], v[120:123], v[96:99], v[76:91]
    ds_read_b128 v[120:123], v236 offset:1920
    v_exp_f32 v48, v48
    v_exp_f32 v49, v49
    v_exp_f32 v50, v50
    v_exp_f32 v51, v51
    v_cvt_pk_bf16_f32 v94, v48, v49
    v_cvt_pk_bf16_f32 v95, v50, v51
    s_waitcnt lgkmcnt(3)
    v_mfma_f32_32x32x8_bf16 v[28:43], v[112:113], v[104:105], v[28:43]
    ds_read_b64 v[112:113], v10 offset:11776
    v_exp_f32 v52, v52
    v_exp_f32 v53, v53
    v_exp_f32 v54, v54
    v_exp_f32 v55, v55
    v_cvt_pk_bf16_f32 v96, v52, v53
    v_cvt_pk_bf16_f32 v97, v54, v55
    s_waitcnt lgkmcnt(3)
    v_mfma_f32_32x32x16_bf16 v[76:91], v[116:119], v[92:95], v[76:91]
    ds_read_b128 v[116:119], v236 offset:2560
    v_exp_f32 v56, v56
    v_exp_f32 v57, v57
    v_exp_f32 v58, v58
    v_exp_f32 v59, v59
    v_cvt_pk_bf16_f32 v98, v56, v57
    v_cvt_pk_bf16_f32 v99, v58, v59
    s_waitcnt vmcnt(9)
    s_cmp_lg_u32 s16, 0
    s_cbranch_scc1 L_w0_fb_c
    s_waitcnt vmcnt(0)
    v_cmp_eq_u32 vcc, s17, v19
    s_nop 3
    s_cmp_eq_u64 vcc, exec
    s_cbranch_scc1 L_fb_ok
    s_mov_b32 s42, 0
L_fb_spin:
    s_sleep 2
    s_add_u32 s32, s25, 22626304
    buffer_load_dword v19, v231, s[8:11], s32 offen sc1
    s_add_u32 s42, s42, 1
    s_cmp_ge_u32 s42, 1048576
    s_cbranch_scc1 L_fb_ok
    s_waitcnt vmcnt(0)
    v_cmp_eq_u32 vcc, s17, v19
    s_nop 3
    s_cmp_eq_u64 vcc, exec
    s_cbranch_scc0 L_fb_spin
L_fb_ok:
L_w0_fb_c:
    s_barrier
    s_waitcnt lgkmcnt(3)
    v_mfma_f32_32x32x16_bf16 v[44:59], v[108:111], v[100:103], v[60:75]
    ds_read_b128 v[108:111], v7 offset:0
    v_exp_f32 v28, v28
    v_exp_f32 v29, v29
    v_exp_f32 v30, v30
    v_exp_f32 v31, v31
    v_cvt_pk_bf16_f32 v92, v28, v29
    v_cvt_pk_bf16_f32 v93, v30, v31
    s_waitcnt lgkmcnt(3)
    v_mfma_f32_32x32x16_bf16 v[76:91], v[120:123], v[96:99], v[76:91]
    ds_read_b128 v[120:123], v236 offset:3200
    v_exp_f32 v32, v32
    v_exp_f32 v33, v33
    v_exp_f32 v34, v34
    v_exp_f32 v35, v35
    v_cvt_pk_bf16_f32 v94, v32, v33
    v_cvt_pk_bf16_f32 v95, v34, v35
    s_waitcnt lgkmcnt(3)
    v_mfma_f32_32x32x8_bf16 v[44:59], v[112:113], v[104:105], v[44:59]
    ds_read_b64 v[112:113], v11 offset:8192
    v_exp_f32 v36, v36
    v_exp_f32 v37, v37
    v_exp_f32 v38, v38
    v_exp_f32 v39, v39
    v_cvt_pk_bf16_f32 v96, v36, v37
    v_cvt_pk_bf16_f32 v97, v38, v39
    s_waitcnt lgkmcnt(3)
    v_mfma_f32_32x32x16_bf16 v[76:91], v[116:119], v[92:95], v[76:91]
    ds_read_b128 v[116:119], v236 offset:3840
    v_exp_f32 v40, v40
    v_exp_f32 v41, v41
    v_exp_f32 v42, v42
    v_exp_f32 v43, v43
    v_cvt_pk_bf16_f32 v98, v40, v41
    v_cvt_pk_bf16_f32 v99, v42, v43
    s_add_u32 s32, s24, 2621440
    buffer_load_dwordx4 v[124:127], v228, s[8:11], s32 offen sc1
    s_waitcnt lgkmcnt(3)
    v_mfma_f32_32x32x16_bf16 v[28:43], v[108:111], v[100:103], v[60:75]
    ds_read_b128 v[108:111], v7 offset:512
    v_exp_f32 v44, v44
    v_exp_f32 v45, v45
    v_exp_f32 v46, v46
    v_exp_f32 v47, v47
    v_cvt_pk_bf16_f32 v92, v44, v45
    v_cvt_pk_bf16_f32 v93, v46, v47
    s_waitcnt lgkmcnt(3)
    v_mfma_f32_32x32x16_bf16 v[76:91], v[120:123], v[96:99], v[76:91]
    ds_read_b128 v[120:123], v236 offset:4480
    v_exp_f32 v48, v48
    v_exp_f32 v49, v49
    v_exp_f32 v50, v50
    v_exp_f32 v51, v51
    v_cvt_pk_bf16_f32 v94, v48, v49
    v_cvt_pk_bf16_f32 v95, v50, v51
    s_add_u32 s32, s24, 2752512
    buffer_load_dwordx4 v[128:131], v228, s[8:11], s32 offen sc1
    s_waitcnt lgkmcnt(3)
    v_mfma_f32_32x32x8_bf16 v[28:43], v[112:113], v[104:105], v[28:43]
    ds_read_b64 v[112:113], v11 offset:8704
    v_exp_f32 v52, v52
    v_exp_f32 v53, v53
    v_exp_f32 v54, v54
    v_exp_f32 v55, v55
    v_cvt_pk_bf16_f32 v96, v52, v53
    v_cvt_pk_bf16_f32 v97, v54, v55
    s_waitcnt lgkmcnt(3)
    v_mfma_f32_32x32x16_bf16 v[76:91], v[116:119], v[92:95], v[76:91]
    ds_read_b128 v[116:119], v15 offset:0
    v_exp_f32 v56, v56
    v_exp_f32 v57, v57
    v_exp_f32 v58, v58
    v_exp_f32 v59, v59
    v_cvt_pk_bf16_f32 v98, v56, v57
    v_cvt_pk_bf16_f32 v99, v58, v59
    s_add_u32 s32, s24, 2883584
    buffer_load_dwordx4 v[132:135], v228, s[8:11], s32 offen sc1
    s_waitcnt lgkmcnt(3)
    v_mfma_f32_32x32x16_bf16 v[44:59], v[108:111], v[100:103], v[60:75]
    ds_read_b128 v[108:111], v7 offset:1024
    v_exp_f32 v28, v28
    v_exp_f32 v29, v29
    v_exp_f32 v30, v30
    v_exp_f32 v31, v31
    v_cvt_pk_bf16_f32 v92, v28, v29
    v_cvt_pk_bf16_f32 v93, v30, v31
    s_waitcnt lgkmcnt(3)
    v_mfma_f32_32x32x16_bf16 v[76:91], v[120:123], v[96:99], v[76:91]
    ds_read_b128 v[120:123], v15 offset:640
    v_exp_f32 v32, v32
    v_exp_f32 v33, v33
    v_exp_f32 v34, v34
    v_exp_f32 v35, v35
    v_cvt_pk_bf16_f32 v94, v32, v33
    v_cvt_pk_bf16_f32 v95, v34, v35
    s_add_u32 s32, s24, 3014656
    buffer_load_dwordx4 v[136:139], v228, s[8:11], s32 offen sc1
    s_waitcnt lgkmcnt(3)
    v_mfma_f32_32x32x8_bf16 v[44:59], v[112:113], v[104:105], v[44:59]
    ds_read_b64 v[112:113], v11 offset:9216
    v_exp_f32 v36, v36
    v_exp_f32 v37, v37
    v_exp_f32 v38, v38
    v_exp_f32 v39, v39
    v_cvt_pk_bf16_f32 v96, v36, v37
    v_cvt_pk_bf16_f32 v97, v38, v39
    s_waitcnt lgkmcnt(3)
    v_mfma_f32_32x32x16_bf16 v[76:91], v[116:119], v[92:95], v[76:91]
    ds_read_b128 v[116:119], v15 offset:1280
    v_exp_f32 v40, v40
    v_exp_f32 v41, v41
    v_exp_f32 v42, v42
    v_exp_f32 v43, v43
    v_cvt_pk_bf16_f32 v98, v40, v41
    v_cvt_pk_bf16_f32 v99, v42, v43
    s_add_u32 s32, s24, 3145728
    buffer_load_dwordx4 v[140:143], v228, s[8:11], s32 offen sc1
    s_add_u32 m0, s22, 1024
    s_add_u32 s32, s23, 1310720
    buffer_load_dwordx4 v226, s[8:11], s32 offen sc1 lds
    s_waitcnt lgkmcnt(3)
    v_mfma_f32_32x32x16_bf16 v[28:43], v[108:111], v[100:103], v[60:75]
    ds_read_b128 v[108:111], v7 offset:1536
    v_exp_f32 v44, v44
    v_exp_f32 v45, v45
    v_exp_f32 v46, v46
    v_exp_f32 v47, v47
    v_cvt_pk_bf16_f32 v92, v44, v45
    v_cvt_pk_bf16_f32 v93, v46, v47
    s_waitcnt lgkmcnt(3)
    v_mfma_f32_32x32x16_bf16 v[76:91], v[120:123], v[96:99], v[76:91]
    ds_read_b128 v[120:123], v15 offset:1920
    v_exp_f32 v48, v48
    v_exp_f32 v49, v49
    v_exp_f32 v50, v50
    v_exp_f32 v51, v51
    v_cvt_pk_bf16_f32 v94, v48, v49
    v_cvt_pk_bf16_f32 v95, v50, v51
    s_add_u32 s32, s24, 3276800
    buffer_load_dwordx4 v[144:147], v228, s[8:11], s32 offen sc1
    s_add_u32 m0, s22, 0
    s_add_u32 s32, s23, 1310720
    buffer_load_dwordx4 v225, s[8:11], s32 offen sc1 lds
    s_waitcnt lgkmcnt(3)
    v_mfma_f32_32x32x8_bf16 v[28:43], v[112:113], v[104:105], v[28:43]
    ds_read_b64 v[112:113], v11 offset:9728
    v_exp_f32 v52, v52
    v_exp_f32 v53, v53
    v_exp_f32 v54, v54
    v_exp_f32 v55, v55
    v_cvt_pk_bf16_f32 v96, v52, v53
    v_cvt_pk_bf16_f32 v97, v54, v55
    s_waitcnt lgkmcnt(3)
    v_mfma_f32_32x32x16_bf16 v[76:91], v[116:119], v[92:95], v[76:91]
    ds_read_b128 v[116:119], v15 offset:2560
    v_exp_f32 v56, v56
    v_exp_f32 v57, v57
    v_exp_f32 v58, v58
    v_exp_f32 v59, v59
    v_cvt_pk_bf16_f32 v98, v56, v57
    v_cvt_pk_bf16_f32 v99, v58, v59
    s_add_u32 s32, s24, 3407872
    buffer_load_dwordx4 v[148:151], v228, s[8:11], s32 offen sc1
    s_add_u32 m0, s22, 22528
    s_add_u32 s32, s23, 1474560
    buffer_load_dwordx4 v225, s[8:11], s32 offen sc1 lds
    s_waitcnt lgkmcnt(3)
    v_mfma_f32_32x32x16_bf16 v[44:59], v[108:111], v[100:103], v[60:75]
    ds_read_b128 v[108:111], v7 offset:2048
    v_exp_f32 v28, v28
    v_exp_f32 v29, v29
    v_exp_f32 v30, v30
    v_exp_f32 v31, v31
    v_cvt_pk_bf16_f32 v92, v28, v29
    v_cvt_pk_bf16_f32 v93, v30, v31
    s_waitcnt lgkmcnt(3)
    v_mfma_f32_32x32x16_bf16 v[76:91], v[120:123], v[96:99], v[76:91]
    ds_read_b128 v[120:123], v15 offset:3200
    v_exp_f32 v32, v32
    v_exp_f32 v33, v33
    v_exp_f32 v34, v34
    v_exp_f32 v35, v35
    v_cvt_pk_bf16_f32 v94, v32, v33
    v_cvt_pk_bf16_f32 v95, v34, v35
    s_add_u32 s32, s24, 3538944
    buffer_load_dwordx4 v[152:155], v228, s[8:11], s32 offen sc1
    s_add_u32 m0, s22, 2048
    s_add_u32 s32, s23, 1310720
    s_mov_b32 exec_hi, 0
    buffer_load_dwordx4 v227, s[8:11], s32 offen sc1 lds
    s_mov_b32 exec_hi, -1
    s_waitcnt lgkmcnt(3)
    v_mfma_f32_32x32x8_bf16 v[44:59], v[112:113], v[104:105], v[44:59]
    ds_read_b64 v[112:113], v11 offset:10240
    v_exp_f32 v36, v36
    v_exp_f32 v37, v37
    v_exp_f32 v38, v38
    v_exp_f32 v39, v39
    v_cvt_pk_bf16_f32 v96, v36, v37
    v_cvt_pk_bf16_f32 v97, v38, v39
    s_waitcnt lgkmcnt(3)
    v_mfma_f32_32x32x16_bf16 v[76:91], v[116:119], v[92:95], v[76:91]
    ds_read_b128 v[116:119], v15 offset:3840
    v_exp_f32 v40, v40
    v_exp_f32 v41, v41
    v_exp_f32 v42, v42
    v_exp_f32 v43, v43
    v_cvt_pk_bf16_f32 v98, v40, v41
    v_cvt_pk_bf16_f32 v99, v42, v43
    s_add_u32 s32, s24, 3670016
    buffer_load_dwordx4 v[156:159], v228, s[8:11], s32 offen sc1
    s_add_u32 m0, s22, 24576
    s_add_u32 s32, s23, 1474560
    s_mov_b32 exec_hi, 0
    buffer_load_dwordx4 v227, s[8:11], s32 offen sc1 lds
    s_mov_b32 exec_hi, -1
    s_waitcnt lgkmcnt(3)
    v_mfma_f32_32x32x16_bf16 v[28:43], v[108:111], v[100:103], v[60:75]
    ds_read_b128 v[108:111], v7 offset:2560
    v_exp_f32 v44, v44
    v_exp_f32 v45, v45
    v_exp_f32 v46, v46
    v_exp_f32 v47, v47
    v_cvt_pk_bf16_f32 v92, v44, v45
    v_cvt_pk_bf16_f32 v93, v46, v47
    s_waitcnt lgkmcnt(3)
    v_mfma_f32_32x32x16_bf16 v[76:91], v[120:123], v[96:99], v[76:91]
    ds_read_b128 v[120:123], v15 offset:4480
    v_exp_f32 v48, v48
    v_exp_f32 v49, v49
    v_exp_f32 v50, v50
    v_exp_f32 v51, v51
    v_cvt_pk_bf16_f32 v94, v48, v49
    v_cvt_pk_bf16_f32 v95, v50, v51
    s_add_u32 s32, s24, 3801088
    buffer_load_dwordx4 v[160:163], v228, s[8:11], s32 offen sc1
    s_add_u32 m0, s22, 23552
    s_add_u32 s32, s23, 1474560
    buffer_load_dwordx4 v226, s[8:11], s32 offen sc1 lds
    s_waitcnt lgkmcnt(3)
    v_mfma_f32_32x32x8_bf16 v[28:43], v[112:113], v[104:105], v[28:43]
    ds_read_b64 v[112:113], v11 offset:10752
    v_exp_f32 v52, v52
    v_exp_f32 v53, v53
    v_exp_f32 v54, v54
    v_exp_f32 v55, v55
    v_cvt_pk_bf16_f32 v96, v52, v53
    v_cvt_pk_bf16_f32 v97, v54, v55
    s_waitcnt lgkmcnt(3)
    v_mfma_f32_32x32x16_bf16 v[76:91], v[116:119], v[92:95], v[76:91]
    ds_read_b128 v[116:119], v237 offset:0
    v_exp_f32 v56, v56
    v_exp_f32 v57, v57
    v_exp_f32 v58, v58
    v_exp_f32 v59, v59
    v_cvt_pk_bf16_f32 v98, v56, v57
    v_cvt_pk_bf16_f32 v99, v58, v59
    s_waitcnt lgkmcnt(3)
    v_mfma_f32_32x32x16_bf16 v[44:59], v[108:111], v[100:103], v[60:75]
    ds_read_b128 v[108:111], v7 offset:3072
    v_exp_f32 v28, v28
    v_exp_f32 v29, v29
    v_exp_f32 v30, v30
    v_exp_f32 v31, v31
    v_cvt_pk_bf16_f32 v92, v28, v29
    v_cvt_pk_bf16_f32 v93, v30, v31
    s_waitcnt lgkmcnt(3)
    v_mfma_f32_32x32x16_bf16 v[76:91], v[120:123], v[96:99], v[76:91]
    ds_read_b128 v[120:123], v237 offset:640
    v_exp_f32 v32, v32
    v_exp_f32 v33, v33
    v_exp_f32 v34, v34
    v_exp_f32 v35, v35
    v_cvt_pk_bf16_f32 v94, v32, v33
    v_cvt_pk_bf16_f32 v95, v34, v35
    s_waitcnt lgkmcnt(3)
    v_mfma_f32_32x32x8_bf16 v[44:59], v[112:113], v[104:105], v[44:59]
    ds_read_b64 v[112:113], v11 offset:11264
    v_exp_f32 v36, v36
    v_exp_f32 v37, v37
    v_exp_f32 v38, v38
    v_exp_f32 v39, v39
    v_cvt_pk_bf16_f32 v96, v36, v37
    v_cvt_pk_bf16_f32 v97, v38, v39
    s_waitcnt lgkmcnt(3)
    v_mfma_f32_32x32x16_bf16 v[76:91], v[116:119], v[92:95], v[76:91]
    ds_read_b128 v[116:119], v237 offset:1280
    v_exp_f32 v40, v40
    v_exp_f32 v41, v41
    v_exp_f32 v42, v42
    v_exp_f32 v43, v43
    v_cvt_pk_bf16_f32 v98, v40, v41
    v_cvt_pk_bf16_f32 v99, v42, v43
    s_waitcnt lgkmcnt(3)
    v_mfma_f32_32x32x16_bf16 v[28:43], v[108:111], v[100:103], v[60:75]
    ds_read_b128 v[108:111], v7 offset:3584
    v_exp_f32 v44, v44
    v_exp_f32 v45, v45
    v_exp_f32 v46, v46
    v_exp_f32 v47, v47
    v_cvt_pk_bf16_f32 v92, v44, v45
    v_cvt_pk_bf16_f32 v93, v46, v47
    s_waitcnt lgkmcnt(3)
    v_mfma_f32_32x32x16_bf16 v[76:91], v[120:123], v[96:99], v[76:91]
    ds_read_b128 v[120:123], v237 offset:1920
    v_exp_f32 v48, v48
    v_exp_f32 v49, v49
    v_exp_f32 v50, v50
    v_exp_f32 v51, v51
    v_cvt_pk_bf16_f32 v94, v48, v49
    v_cvt_pk_bf16_f32 v95, v50, v51
    s_waitcnt lgkmcnt(3)
    v_mfma_f32_32x32x8_bf16 v[28:43], v[112:113], v[104:105], v[28:43]
    ds_read_b64 v[112:113], v11 offset:11776
    v_exp_f32 v52, v52
    v_exp_f32 v53, v53
    v_exp_f32 v54, v54
    v_exp_f32 v55, v55
    v_cvt_pk_bf16_f32 v96, v52, v53
    v_cvt_pk_bf16_f32 v97, v54, v55
    s_waitcnt lgkmcnt(3)
    v_mfma_f32_32x32x16_bf16 v[76:91], v[116:119], v[92:95], v[76:91]
    ds_read_b128 v[116:119], v237 offset:2560
    v_exp_f32 v56, v56
    v_exp_f32 v57, v57
    v_exp_f32 v58, v58
    v_exp_f32 v59, v59
    v_cvt_pk_bf16_f32 v98, v56, v57
    v_cvt_pk_bf16_f32 v99, v58, v59
    s_waitcnt lgkmcnt(3)
    v_mfma_f32_32x32x16_bf16 v[44:59], v[108:111], v[100:103], v[60:75]
    v_exp_f32 v28, v28
    v_exp_f32 v29, v29
    v_exp_f32 v30, v30
    v_exp_f32 v31, v31
    v_cvt_pk_bf16_f32 v92, v28, v29
    v_cvt_pk_bf16_f32 v93, v30, v31
    s_waitcnt lgkmcnt(2)
    v_mfma_f32_32x32x16_bf16 v[76:91], v[120:123], v[96:99], v[76:91]
    ds_read_b128 v[120:123], v237 offset:3200
    v_exp_f32 v32, v32
    v_exp_f32 v33, v33
    v_exp_f32 v34, v34
    v_exp_f32 v35, v35
    v_cvt_pk_bf16_f32 v94, v32, v33
    v_cvt_pk_bf16_f32 v95, v34, v35
    s_waitcnt lgkmcnt(2)
    v_mfma_f32_32x32x8_bf16 v[44:59], v[112:113], v[104:105], v[44:59]
    v_exp_f32 v36, v36
    v_exp_f32 v37, v37
    v_exp_f32 v38, v38
    v_exp_f32 v39, v39
    v_cvt_pk_bf16_f32 v96, v36, v37
    v_cvt_pk_bf16_f32 v97, v38, v39
    s_waitcnt lgkmcnt(1)
    v_mfma_f32_32x32x16_bf16 v[76:91], v[116:119], v[92:95], v[76:91]
    ds_read_b128 v[116:119], v237 offset:3840
    v_exp_f32 v40, v40
    v_exp_f32 v41, v41
    v_exp_f32 v42, v42
    v_exp_f32 v43, v43
    v_cvt_pk_bf16_f32 v98, v40, v41
    v_cvt_pk_bf16_f32 v99, v42, v43
    s_waitcnt vmcnt(0)
    v_exp_f32 v44, v44
    v_exp_f32 v45, v45
    v_exp_f32 v46, v46
    v_exp_f32 v47, v47
    v_cvt_pk_bf16_f32 v92, v44, v45
    v_cvt_pk_bf16_f32 v93, v46, v47
    s_waitcnt lgkmcnt(1)
    v_mfma_f32_32x32x16_bf16 v[76:91], v[120:123], v[96:99], v[76:91]
    ds_read_b128 v[120:123], v237 offset:4480
    v_exp_f32 v48, v48
    v_exp_f32 v49, v49
    v_exp_f32 v50, v50
    v_exp_f32 v51, v51
    v_cvt_pk_bf16_f32 v94, v48, v49
    v_cvt_pk_bf16_f32 v95, v50, v51
    v_exp_f32 v52, v52
    v_exp_f32 v53, v53
    v_exp_f32 v54, v54
    v_exp_f32 v55, v55
    v_cvt_pk_bf16_f32 v96, v52, v53
    v_cvt_pk_bf16_f32 v97, v54, v55
    s_waitcnt lgkmcnt(1)
    v_mfma_f32_32x32x16_bf16 v[76:91], v[116:119], v[92:95], v[76:91]
    v_exp_f32 v56, v56
    v_exp_f32 v57, v57
    v_exp_f32 v58, v58
    v_exp_f32 v59, v59
    v_cvt_pk_bf16_f32 v98, v56, v57
    v_cvt_pk_bf16_f32 v99, v58, v59
    s_waitcnt lgkmcnt(0)
    s_nop 1
    v_mfma_f32_32x32x16_bf16 v[76:91], v[120:123], v[96:99], v[76:91]
    v_add_u32 v25, 0x10000, v229
    v_add_u32 v26, 0x20000, v229
    v_mov_b32 v23, 0x5f800000
    s_nop 7
    s_nop 3
    v_mov_b32 v20, v84
    v_mov_b32 v21, v84
    s_nop 1
    v_permlane32_swap_b32 v20, v21
    v_mul_f32 v22, 0, v76
    v_fma_f32 v22, v77, 0, v22
    v_fma_f32 v22, v78, 0, v22
    v_fma_f32 v22, v79, 0, v22
    v_fma_f32 v22, v80, 0, v22
    v_fma_f32 v22, v81, 0, v22
    v_fma_f32 v22, v82, 0, v22
    v_fma_f32 v22, v83, 0, v22
    v_fma_f32 v22, v84, 0, v22
    v_fma_f32 v22, v85, 0, v22
    v_fma_f32 v22, v86, 0, v22
    v_fma_f32 v22, v87, 0, v22
    v_add_f32 v22, v22, v21
    v_cmp_lt_f32 vcc, v22, v23
    s_nop 4
    s_cmp_eq_u64 vcc, exec
    s_cbranch_scc0 L_fallback
L_finish:
    v_rcp_f32 v22, v21
    s_lshl_b32 s32, s29, 4
    s_add_u32 s32, s32, 15728640
    v_mul_f32 v22, v22, v17
    v_mov_b32 v23, v22
    v_pk_mul_f32 v[76:77], v[76:77], v[22:23]
    v_pk_mul_f32 v[78:79], v[78:79], v[22:23]
    v_pk_mul_f32 v[80:81], v[80:81], v[22:23]
    v_pk_mul_f32 v[82:83], v[82:83], v[22:23]
    v_pk_mul_f32 v[84:85], v[84:85], v[22:23]
    v_pk_mul_f32 v[86:87], v[86:87], v[22:23]
    v_cvt_pk_bf16_f32 v76, v76, v77
    v_cvt_pk_bf16_f32 v77, v78, v79
    v_cvt_pk_bf16_f32 v78, v80, v81
    v_cvt_pk_bf16_f32 v79, v82, v83
    v_cvt_pk_bf16_f32 v84, v84, v85
    v_cvt_pk_bf16_f32 v85, v86, v87
    v_permlane32_swap_b32 v76, v78
    v_permlane32_swap_b32 v77, v79
    buffer_store_dwordx4 v[76:79], v252, s[8:11], s32 offen sc1
    s_mov_b32 exec_hi, 0
    buffer_store_dwordx2 v[84:85], v254, s[8:11], s32 offen sc1
    s_mov_b64 exec, -1
    v_add_u32 v25, 0x10000, v229
    v_add_u32 v26, 0x20000, v229
    s_barrier
    s_cmp_eq_u32 s28, 1
    s_cbranch_scc1 L_op1_g1
    ds_read_b128 v[28:31], v25 offset:35328
    ds_read_b128 v[32:35], v25 offset:35584
    ds_read_b128 v[36:39], v25 offset:35840
    ds_read_b128 v[40:43], v25 offset:36096
    ds_read_b128 v[44:47], v25 offset:36352
    ds_read_b128 v[48:51], v25 offset:40448
    s_waitcnt lgkmcnt(5)
    v_mfma_f32_16x16x32_bf16 v[204:207], v[28:31], v[124:127], 0
    ds_read_b128 v[52:55], v25 offset:40704
    s_waitcnt lgkmcnt(5)
    v_mfma_f32_16x16x32_bf16 v[208:211], v[32:35], v[124:127], 0
    ds_read_b128 v[56:59], v25 offset:40960
    s_waitcnt lgkmcnt(5)
    v_mfma_f32_16x16x32_bf16 v[212:215], v[36:39], v[124:127], 0
    ds_read_b128 v[28:31], v25 offset:41216
    s_waitcnt lgkmcnt(5)
    v_mfma_f32_16x16x32_bf16 v[216:219], v[40:43], v[124:127], 0
    ds_read_b128 v[32:35], v25 offset:41472
    s_waitcnt lgkmcnt(5)
    v_mfma_f32_16x16x32_bf16 v[220:223], v[44:47], v[124:127], 0
    ds_read_b128 v[36:39], v25 offset:45568
    s_waitcnt lgkmcnt(5)
    v_mfma_f32_16x16x32_bf16 v[204:207], v[48:51], v[128:131], v[204:207]
    ds_read_b128 v[40:43], v25 offset:45824
    s_waitcnt lgkmcnt(5)
    v_mfma_f32_16x16x32_bf16 v[208:211], v[52:55], v[128:131], v[208:211]
    ds_read_b128 v[44:47], v25 offset:46080
    s_waitcnt lgkmcnt(5)
    v_mfma_f32_16x16x32_bf16 v[212:215], v[56:59], v[128:131], v[212:215]
    ds_read_b128 v[48:51], v25 offset:46336
    s_waitcnt lgkmcnt(5)
    v_mfma_f32_16x16x32_bf16 v[216:219], v[28:31], v[128:131], v[216:219]
    ds_read_b128 v[52:55], v25 offset:46592
    s_waitcnt lgkmcnt(5)
    v_mfma_f32_16x16x32_bf16 v[220:223], v[32:35], v[128:131], v[220:223]
    ds_read_b128 v[56:59], v25 offset:50688
    s_waitcnt vmcnt(0)
    v_mov_b32 v20, s17
    v_mov_b32 v21, 0
    s_add_u32 s32, s26, 22618112
    s_mov_b64 exec, 1
    buffer_store_dword v20, v21, s[8:11], s32 offen sc1
    s_mov_b64 exec, -1
    s_add_u32 m0, s22, 45056
    s_add_u32 s32, s23, 0
    buffer_load_dwordx4 v225, s[8:11], s32 offen sc1 lds
    s_waitcnt lgkmcnt(5)
    v_mfma_f32_16x16x32_bf16 v[204:207], v[36:39], v[132:135], v[204:207]
    ds_read_b128 v[28:31], v25 offset:50944
    s_waitcnt lgkmcnt(5)
    v_mfma_f32_16x16x32_bf16 v[208:211], v[40:43], v[132:135], v[208:211]
    ds_read_b128 v[32:35], v25 offset:51200
    s_waitcnt lgkmcnt(5)
    v_mfma_f32_16x16x32_bf16 v[212:215], v[44:47], v[132:135], v[212:215]
    ds_read_b128 v[36:39], v25 offset:51456
    s_waitcnt lgkmcnt(5)
    v_mfma_f32_16x16x32_bf16 v[216:219], v[48:51], v[132:135], v[216:219]
    ds_read_b128 v[40:43], v25 offset:51712
    s_waitcnt lgkmcnt(5)
    v_mfma_f32_16x16x32_bf16 v[220:223], v[52:55], v[132:135], v[220:223]
    ds_read_b128 v[44:47], v25 offset:55808
    s_add_u32 m0, s22, 46080
    s_add_u32 s32, s23, 0
    buffer_load_dwordx4 v226, s[8:11], s32 offen sc1 lds
    s_waitcnt lgkmcnt(5)
    v_mfma_f32_16x16x32_bf16 v[204:207], v[56:59], v[136:139], v[204:207]
    ds_read_b128 v[48:51], v25 offset:56064
    s_waitcnt lgkmcnt(5)
    v_mfma_f32_16x16x32_bf16 v[208:211], v[28:31], v[136:139], v[208:211]
    ds_read_b128 v[52:55], v25 offset:56320
    s_waitcnt lgkmcnt(5)
    v_mfma_f32_16x16x32_bf16 v[212:215], v[32:35], v[136:139], v[212:215]
    ds_read_b128 v[56:59], v25 offset:56576
    s_waitcnt lgkmcnt(5)
    v_mfma_f32_16x16x32_bf16 v[216:219], v[36:39], v[136:139], v[216:219]
    ds_read_b128 v[28:31], v25 offset:56832
    s_waitcnt lgkmcnt(5)
    v_mfma_f32_16x16x32_bf16 v[220:223], v[40:43], v[136:139], v[220:223]
    ds_read_b128 v[32:35], v25 offset:60928
    s_add_u32 m0, s22, 47104
    s_add_u32 s32, s23, 0
    s_mov_b32 exec_hi, 0
    buffer_load_dwordx4 v227, s[8:11], s32 offen sc1 lds
    s_mov_b32 exec_hi, -1
    s_waitcnt lgkmcnt(5)
    v_mfma_f32_16x16x32_bf16 v[204:207], v[44:47], v[140:143], v[204:207]
    ds_read_b128 v[36:39], v25 offset:61184
    s_waitcnt lgkmcnt(5)
    v_mfma_f32_16x16x32_bf16 v[208:211], v[48:51], v[140:143], v[208:211]
    ds_read_b128 v[40:43], v25 offset:61440
    s_waitcnt lgkmcnt(5)
    v_mfma_f32_16x16x32_bf16 v[212:215], v[52:55], v[140:143], v[212:215]
    ds_read_b128 v[44:47], v25 offset:61696
    s_waitcnt lgkmcnt(5)
    v_mfma_f32_16x16x32_bf16 v[216:219], v[56:59], v[140:143], v[216:219]
    ds_read_b128 v[48:51], v25 offset:61952
    s_waitcnt lgkmcnt(5)
    v_mfma_f32_16x16x32_bf16 v[220:223], v[28:31], v[140:143], v[220:223]
    ds_read_b128 v[52:55], v26 offset:512
    s_add_u32 m0, s22, 67584
    s_add_u32 s32, s23, 163840
    buffer_load_dwordx4 v225, s[8:11], s32 offen sc1 lds
    s_waitcnt lgkmcnt(5)
    v_mfma_f32_16x16x32_bf16 v[204:207], v[32:35], v[144:147], v[204:207]
    ds_read_b128 v[56:59], v26 offset:768
    s_waitcnt lgkmcnt(5)
    v_mfma_f32_16x16x32_bf16 v[208:211], v[36:39], v[144:147], v[208:211]
    ds_read_b128 v[28:31], v26 offset:1024
    s_waitcnt lgkmcnt(5)
    v_mfma_f32_16x16x32_bf16 v[212:215], v[40:43], v[144:147], v[212:215]
    ds_read_b128 v[32:35], v26 offset:1280
    s_waitcnt lgkmcnt(5)
    v_mfma_f32_16x16x32_bf16 v[216:219], v[44:47], v[144:147], v[216:219]
    ds_read_b128 v[36:39], v26 offset:1536
    s_waitcnt lgkmcnt(5)
    v_mfma_f32_16x16x32_bf16 v[220:223], v[48:51], v[144:147], v[220:223]
    ds_read_b128 v[40:43], v26 offset:5632
    s_add_u32 m0, s22, 68608
    s_add_u32 s32, s23, 163840
    buffer_load_dwordx4 v226, s[8:11], s32 offen sc1 lds
    s_waitcnt lgkmcnt(5)
    v_mfma_f32_16x16x32_bf16 v[204:207], v[52:55], v[148:151], v[204:207]
    ds_read_b128 v[44:47], v26 offset:5888
    s_waitcnt lgkmcnt(5)
    v_mfma_f32_16x16x32_bf16 v[208:211], v[56:59], v[148:151], v[208:211]
    ds_read_b128 v[48:51], v26 offset:6144
    s_waitcnt lgkmcnt(5)
    v_mfma_f32_16x16x32_bf16 v[212:215], v[28:31], v[148:151], v[212:215]
    ds_read_b128 v[52:55], v26 offset:6400
    s_waitcnt lgkmcnt(5)
    v_mfma_f32_16x16x32_bf16 v[216:219], v[32:35], v[148:151], v[216:219]
    ds_read_b128 v[56:59], v26 offset:6656
    s_waitcnt lgkmcnt(5)
    v_mfma_f32_16x16x32_bf16 v[220:223], v[36:39], v[148:151], v[220:223]
    ds_read_b128 v[28:31], v26 offset:10752
    s_add_u32 m0, s22, 69632
    s_add_u32 s32, s23, 163840
    s_mov_b32 exec_hi, 0
    buffer_load_dwordx4 v227, s[8:11], s32 offen sc1 lds
    s_mov_b32 exec_hi, -1
    s_waitcnt lgkmcnt(5)
    v_mfma_f32_16x16x32_bf16 v[204:207], v[40:43], v[152:155], v[204:207]
    ds_read_b128 v[32:35], v26 offset:11008
    s_waitcnt lgkmcnt(5)
    v_mfma_f32_16x16x32_bf16 v[208:211], v[44:47], v[152:155], v[208:211]
    ds_read_b128 v[36:39], v26 offset:11264
    s_waitcnt lgkmcnt(5)
    v_mfma_f32_16x16x32_bf16 v[212:215], v[48:51], v[152:155], v[212:215]
    ds_read_b128 v[40:43], v26 offset:11520
    s_waitcnt lgkmcnt(5)
    v_mfma_f32_16x16x32_bf16 v[216:219], v[52:55], v[152:155], v[216:219]
    ds_read_b128 v[44:47], v26 offset:11776
    s_waitcnt lgkmcnt(5)
    v_mfma_f32_16x16x32_bf16 v[220:223], v[56:59], v[152:155], v[220:223]
    ds_read_b128 v[48:51], v26 offset:15872
    s_waitcnt lgkmcnt(5)
    v_mfma_f32_16x16x32_bf16 v[204:207], v[28:31], v[156:159], v[204:207]
    ds_read_b128 v[52:55], v26 offset:16128
    s_waitcnt lgkmcnt(5)
    v_mfma_f32_16x16x32_bf16 v[208:211], v[32:35], v[156:159], v[208:211]
    ds_read_b128 v[56:59], v26 offset:16384
    s_waitcnt lgkmcnt(5)
    v_mfma_f32_16x16x32_bf16 v[212:215], v[36:39], v[156:159], v[212:215]
    ds_read_b128 v[28:31], v26 offset:16640
    s_waitcnt lgkmcnt(5)
    v_mfma_f32_16x16x32_bf16 v[216:219], v[40:43], v[156:159], v[216:219]
    ds_read_b128 v[32:35], v26 offset:16896
    s_waitcnt lgkmcnt(5)
    v_mfma_f32_16x16x32_bf16 v[220:223], v[44:47], v[156:159], v[220:223]
    s_waitcnt lgkmcnt(4)
    v_mfma_f32_16x16x32_bf16 v[204:207], v[48:51], v[160:163], v[204:207]
    s_waitcnt lgkmcnt(3)
    v_mfma_f32_16x16x32_bf16 v[208:211], v[52:55], v[160:163], v[208:211]
    s_waitcnt lgkmcnt(2)
    v_mfma_f32_16x16x32_bf16 v[212:215], v[56:59], v[160:163], v[212:215]
    s_waitcnt lgkmcnt(1)
    v_mfma_f32_16x16x32_bf16 v[216:219], v[28:31], v[160:163], v[216:219]
    s_waitcnt lgkmcnt(0)
    v_mfma_f32_16x16x32_bf16 v[220:223], v[32:35], v[160:163], v[220:223]
    s_branch L_op1_done
L_op1_g1:
    ds_read_b128 v[28:31], v26 offset:20992
    ds_read_b128 v[32:35], v26 offset:21248
    ds_read_b128 v[36:39], v26 offset:21504
    ds_read_b128 v[40:43], v26 offset:21760
    ds_read_b128 v[44:47], v26 offset:22016
    ds_read_b128 v[48:51], v26 offset:26112
    s_waitcnt lgkmcnt(5)
    v_mfma_f32_16x16x32_bf16 v[204:207], v[28:31], v[124:127], 0
    ds_read_b128 v[52:55], v26 offset:26368
    s_waitcnt lgkmcnt(5)
    v_mfma_f32_16x16x32_bf16 v[208:211], v[32:35], v[124:127], 0
    ds_read_b128 v[56:59], v26 offset:26624
    s_waitcnt lgkmcnt(5)
    v_mfma_f32_16x16x32_bf16 v[212:215], v[36:39], v[124:127], 0
    ds_read_b128 v[28:31], v26 offset:26880
    s_waitcnt lgkmcnt(5)
    v_mfma_f32_16x16x32_bf16 v[216:219], v[40:43], v[124:127], 0
    ds_read_b128 v[32:35], v26 offset:27136
    s_waitcnt lgkmcnt(5)
    v_mfma_f32_16x16x32_bf16 v[220:223], v[44:47], v[124:127], 0
    ds_read_b128 v[36:39], v229 offset:0
    s_waitcnt lgkmcnt(5)
    v_mfma_f32_16x16x32_bf16 v[204:207], v[48:51], v[128:131], v[204:207]
    ds_read_b128 v[40:43], v229 offset:256
    s_waitcnt lgkmcnt(5)
    v_mfma_f32_16x16x32_bf16 v[208:211], v[52:55], v[128:131], v[208:211]
    ds_read_b128 v[44:47], v229 offset:512
    s_waitcnt lgkmcnt(5)
    v_mfma_f32_16x16x32_bf16 v[212:215], v[56:59], v[128:131], v[212:215]
    ds_read_b128 v[48:51], v229 offset:768
    s_waitcnt lgkmcnt(5)
    v_mfma_f32_16x16x32_bf16 v[216:219], v[28:31], v[128:131], v[216:219]
    ds_read_b128 v[52:55], v229 offset:1024
    s_waitcnt lgkmcnt(5)
    v_mfma_f32_16x16x32_bf16 v[220:223], v[32:35], v[128:131], v[220:223]
    ds_read_b128 v[56:59], v229 offset:5120
    s_waitcnt vmcnt(0)
    v_mov_b32 v20, s17
    v_mov_b32 v21, 0
    s_add_u32 s32, s26, 22618112
    s_mov_b64 exec, 1
    buffer_store_dword v20, v21, s[8:11], s32 offen sc1
    s_mov_b64 exec, -1
    s_add_u32 m0, s22, 45056
    s_add_u32 s32, s23, 0
    buffer_load_dwordx4 v225, s[8:11], s32 offen sc1 lds
    s_waitcnt lgkmcnt(5)
    v_mfma_f32_16x16x32_bf16 v[204:207], v[36:39], v[132:135], v[204:207]
    ds_read_b128 v[28:31], v229 offset:5376
    s_waitcnt lgkmcnt(5)
    v_mfma_f32_16x16x32_bf16 v[208:211], v[40:43], v[132:135], v[208:211]
    ds_read_b128 v[32:35], v229 offset:5632
    s_waitcnt lgkmcnt(5)
    v_mfma_f32_16x16x32_bf16 v[212:215], v[44:47], v[132:135], v[212:215]
    ds_read_b128 v[36:39], v229 offset:5888
    s_waitcnt lgkmcnt(5)
    v_mfma_f32_16x16x32_bf16 v[216:219], v[48:51], v[132:135], v[216:219]
    ds_read_b128 v[40:43], v229 offset:6144
    s_waitcnt lgkmcnt(5)
    v_mfma_f32_16x16x32_bf16 v[220:223], v[52:55], v[132:135], v[220:223]
    ds_read_b128 v[44:47], v229 offset:10240
    s_add_u32 m0, s22, 46080
    s_add_u32 s32, s23, 0
    buffer_load_dwordx4 v226, s[8:11], s32 offen sc1 lds
    s_waitcnt lgkmcnt(5)
    v_mfma_f32_16x16x32_bf16 v[204:207], v[56:59], v[136:139], v[204:207]
    ds_read_b128 v[48:51], v229 offset:10496
    s_waitcnt lgkmcnt(5)
    v_mfma_f32_16x16x32_bf16 v[208:211], v[28:31], v[136:139], v[208:211]
    ds_read_b128 v[52:55], v229 offset:10752
    s_waitcnt lgkmcnt(5)
    v_mfma_f32_16x16x32_bf16 v[212:215], v[32:35], v[136:139], v[212:215]
    ds_read_b128 v[56:59], v229 offset:11008
    s_waitcnt lgkmcnt(5)
    v_mfma_f32_16x16x32_bf16 v[216:219], v[36:39], v[136:139], v[216:219]
    ds_read_b128 v[28:31], v229 offset:11264
    s_waitcnt lgkmcnt(5)
    v_mfma_f32_16x16x32_bf16 v[220:223], v[40:43], v[136:139], v[220:223]
    ds_read_b128 v[32:35], v229 offset:15360
    s_add_u32 m0, s22, 47104
    s_add_u32 s32, s23, 0
    s_mov_b32 exec_hi, 0
    buffer_load_dwordx4 v227, s[8:11], s32 offen sc1 lds
    s_mov_b32 exec_hi, -1
    s_waitcnt lgkmcnt(5)
    v_mfma_f32_16x16x32_bf16 v[204:207], v[44:47], v[140:143], v[204:207]
    ds_read_b128 v[36:39], v229 offset:15616
    s_waitcnt lgkmcnt(5)
    v_mfma_f32_16x16x32_bf16 v[208:211], v[48:51], v[140:143], v[208:211]
    ds_read_b128 v[40:43], v229 offset:15872
    s_waitcnt lgkmcnt(5)
    v_mfma_f32_16x16x32_bf16 v[212:215], v[52:55], v[140:143], v[212:215]
    ds_read_b128 v[44:47], v229 offset:16128
    s_waitcnt lgkmcnt(5)
    v_mfma_f32_16x16x32_bf16 v[216:219], v[56:59], v[140:143], v[216:219]
    ds_read_b128 v[48:51], v229 offset:16384
    s_waitcnt lgkmcnt(5)
    v_mfma_f32_16x16x32_bf16 v[220:223], v[28:31], v[140:143], v[220:223]
    ds_read_b128 v[52:55], v229 offset:22528
    s_add_u32 m0, s22, 67584
    s_add_u32 s32, s23, 163840
    buffer_load_dwordx4 v225, s[8:11], s32 offen sc1 lds
    s_waitcnt lgkmcnt(5)
    v_mfma_f32_16x16x32_bf16 v[204:207], v[32:35], v[144:147], v[204:207]
    ds_read_b128 v[56:59], v229 offset:22784
    s_waitcnt lgkmcnt(5)
    v_mfma_f32_16x16x32_bf16 v[208:211], v[36:39], v[144:147], v[208:211]
    ds_read_b128 v[28:31], v229 offset:23040
    s_waitcnt lgkmcnt(5)
    v_mfma_f32_16x16x32_bf16 v[212:215], v[40:43], v[144:147], v[212:215]
    ds_read_b128 v[32:35], v229 offset:23296
    s_waitcnt lgkmcnt(5)
    v_mfma_f32_16x16x32_bf16 v[216:219], v[44:47], v[144:147], v[216:219]
    ds_read_b128 v[36:39], v229 offset:23552
    s_waitcnt lgkmcnt(5)
    v_mfma_f32_16x16x32_bf16 v[220:223], v[48:51], v[144:147], v[220:223]
    ds_read_b128 v[40:43], v229 offset:27648
    s_add_u32 m0, s22, 68608
    s_add_u32 s32, s23, 163840
    buffer_load_dwordx4 v226, s[8:11], s32 offen sc1 lds
    s_waitcnt lgkmcnt(5)
    v_mfma_f32_16x16x32_bf16 v[204:207], v[52:55], v[148:151], v[204:207]
    ds_read_b128 v[44:47], v229 offset:27904
    s_waitcnt lgkmcnt(5)
    v_mfma_f32_16x16x32_bf16 v[208:211], v[56:59], v[148:151], v[208:211]
    ds_read_b128 v[48:51], v229 offset:28160
    s_waitcnt lgkmcnt(5)
    v_mfma_f32_16x16x32_bf16 v[212:215], v[28:31], v[148:151], v[212:215]
    ds_read_b128 v[52:55], v229 offset:28416
    s_waitcnt lgkmcnt(5)
    v_mfma_f32_16x16x32_bf16 v[216:219], v[32:35], v[148:151], v[216:219]
    ds_read_b128 v[56:59], v229 offset:28672
    s_waitcnt lgkmcnt(5)
    v_mfma_f32_16x16x32_bf16 v[220:223], v[36:39], v[148:151], v[220:223]
    ds_read_b128 v[28:31], v229 offset:32768
    s_add_u32 m0, s22, 69632
    s_add_u32 s32, s23, 163840
    s_mov_b32 exec_hi, 0
    buffer_load_dwordx4 v227, s[8:11], s32 offen sc1 lds
    s_mov_b32 exec_hi, -1
    s_waitcnt lgkmcnt(5)
    v_mfma_f32_16x16x32_bf16 v[204:207], v[40:43], v[152:155], v[204:207]
    ds_read_b128 v[32:35], v229 offset:33024
    s_waitcnt lgkmcnt(5)
    v_mfma_f32_16x16x32_bf16 v[208:211], v[44:47], v[152:155], v[208:211]
    ds_read_b128 v[36:39], v229 offset:33280
    s_waitcnt lgkmcnt(5)
    v_mfma_f32_16x16x32_bf16 v[212:215], v[48:51], v[152:155], v[212:215]
    ds_read_b128 v[40:43], v229 offset:33536
    s_waitcnt lgkmcnt(5)
    v_mfma_f32_16x16x32_bf16 v[216:219], v[52:55], v[152:155], v[216:219]
    ds_read_b128 v[44:47], v229 offset:33792
    s_waitcnt lgkmcnt(5)
    v_mfma_f32_16x16x32_bf16 v[220:223], v[56:59], v[152:155], v[220:223]
    ds_read_b128 v[48:51], v229 offset:37888
    s_waitcnt lgkmcnt(5)
    v_mfma_f32_16x16x32_bf16 v[204:207], v[28:31], v[156:159], v[204:207]
    ds_read_b128 v[52:55], v229 offset:38144
    s_waitcnt lgkmcnt(5)
    v_mfma_f32_16x16x32_bf16 v[208:211], v[32:35], v[156:159], v[208:211]
    ds_read_b128 v[56:59], v229 offset:38400
    s_waitcnt lgkmcnt(5)
    v_mfma_f32_16x16x32_bf16 v[212:215], v[36:39], v[156:159], v[212:215]
    ds_read_b128 v[28:31], v229 offset:38656
    s_waitcnt lgkmcnt(5)
    v_mfma_f32_16x16x32_bf16 v[216:219], v[40:43], v[156:159], v[216:219]
    ds_read_b128 v[32:35], v229 offset:38912
    s_waitcnt lgkmcnt(5)
    v_mfma_f32_16x16x32_bf16 v[220:223], v[44:47], v[156:159], v[220:223]
    s_waitcnt lgkmcnt(4)
    v_mfma_f32_16x16x32_bf16 v[204:207], v[48:51], v[160:163], v[204:207]
    s_waitcnt lgkmcnt(3)
    v_mfma_f32_16x16x32_bf16 v[208:211], v[52:55], v[160:163], v[208:211]
    s_waitcnt lgkmcnt(2)
    v_mfma_f32_16x16x32_bf16 v[212:215], v[56:59], v[160:163], v[212:215]
    s_waitcnt lgkmcnt(1)
    v_mfma_f32_16x16x32_bf16 v[216:219], v[28:31], v[160:163], v[216:219]
    s_waitcnt lgkmcnt(0)
    v_mfma_f32_16x16x32_bf16 v[220:223], v[32:35], v[160:163], v[220:223]
L_op1_done:
    s_barrier
    s_add_u32 m0, s22, 100864
    s_add_u32 s32, s23, 327680
    buffer_load_dwordx4 v225, s[8:11], s32 offen sc1 lds
    s_add_u32 m0, s22, 101888
    s_add_u32 s32, s23, 327680
    buffer_load_dwordx4 v226, s[8:11], s32 offen sc1 lds
    s_add_u32 m0, s22, 102912
    s_add_u32 s32, s23, 327680
    s_mov_b32 exec_hi, 0
    buffer_load_dwordx4 v227, s[8:11], s32 offen sc1 lds
    s_mov_b32 exec_hi, -1
    s_add_u32 m0, s22, 121344
    s_add_u32 s32, s23, 491520
    buffer_load_dwordx4 v225, s[8:11], s32 offen sc1 lds
    s_add_u32 m0, s22, 122368
    s_add_u32 s32, s23, 491520
    buffer_load_dwordx4 v226, s[8:11], s32 offen sc1 lds
    s_add_u32 m0, s22, 123392
    s_add_u32 s32, s23, 491520
    s_mov_b32 exec_hi, 0
    buffer_load_dwordx4 v227, s[8:11], s32 offen sc1 lds
    s_mov_b32 exec_hi, -1
    s_add_u32 m0, s22, 141824
    s_add_u32 s32, s23, 655360
    buffer_load_dwordx4 v225, s[8:11], s32 offen sc1 lds
    s_add_u32 m0, s22, 142848
    s_add_u32 s32, s23, 655360
    buffer_load_dwordx4 v226, s[8:11], s32 offen sc1 lds
    s_add_u32 m0, s22, 143872
    s_add_u32 s32, s23, 655360
    s_mov_b32 exec_hi, 0
    buffer_load_dwordx4 v227, s[8:11], s32 offen sc1 lds
    s_mov_b32 exec_hi, -1
    s_cmp_lg_u32 s16, 0
    s_cbranch_scc1 L_w0_fa
    s_add_u32 s33, s25, 22618112
    buffer_load_dword v19, v231, s[8:11], s33 offen sc1
    s_sleep 1
    buffer_load_dword v235, v231, s[8:11], s33 offen sc1
    s_sleep 1
    buffer_load_dword v22, v231, s[8:11], s33 offen sc1
    s_sleep 1
    buffer_load_dword v23, v231, s[8:11], s33 offen sc1
    s_sleep 1
    s_mov_b32 s42, 0
L_fa_spin:
    s_waitcnt vmcnt(3)
    v_cmp_eq_u32 vcc, s17, v19
    s_nop 3
    s_cmp_eq_u64 vcc, exec
    s_cbranch_scc1 L_fa_ok
    buffer_load_dword v19, v231, s[8:11], s33 offen sc1
    s_waitcnt vmcnt(3)
    v_cmp_eq_u32 vcc, s17, v235
    s_nop 3
    s_cmp_eq_u64 vcc, exec
    s_cbranch_scc1 L_fa_ok
    buffer_load_dword v235, v231, s[8:11], s33 offen sc1
    s_waitcnt vmcnt(3)
    v_cmp_eq_u32 vcc, s17, v22
    s_nop 3
    s_cmp_eq_u64 vcc, exec
    s_cbranch_scc1 L_fa_ok
    buffer_load_dword v22, v231, s[8:11], s33 offen sc1
    s_waitcnt vmcnt(3)
    v_cmp_eq_u32 vcc, s17, v23
    s_nop 3
    s_cmp_eq_u64 vcc, exec
    s_cbranch_scc1 L_fa_ok
    buffer_load_dword v23, v231, s[8:11], s33 offen sc1
    s_add_u32 s42, s42, 1
    s_cmp_lt_u32 s42, 1048576
    s_cbranch_scc1 L_fa_spin
L_fa_ok:
L_w0_fa:
    s_waitcnt vmcnt(0)
    s_barrier
    s_add_u32 s32, s24, 0
    buffer_load_dwordx4 v[164:167], v228, s[8:11], s32 offen sc1
    s_add_u32 s32, s24, 131072
    buffer_load_dwordx4 v[168:171], v228, s[8:11], s32 offen sc1
    s_add_u32 s32, s24, 262144
    buffer_load_dwordx4 v[172:175], v228, s[8:11], s32 offen sc1
    s_add_u32 s32, s24, 393216
    buffer_load_dwordx4 v[176:179], v228, s[8:11], s32 offen sc1
    s_add_u32 s32, s24, 524288
    buffer_load_dwordx4 v[180:183], v228, s[8:11], s32 offen sc1
    s_add_u32 s32, s24, 655360
    buffer_load_dwordx4 v[184:187], v228, s[8:11], s32 offen sc1
    s_add_u32 s32, s24, 786432
    buffer_load_dwordx4 v[188:191], v228, s[8:11], s32 offen sc1
    s_add_u32 s32, s24, 917504
    buffer_load_dwordx4 v[192:195], v228, s[8:11], s32 offen sc1
    s_add_u32 s32, s24, 1048576
    buffer_load_dwordx4 v[196:199], v228, s[8:11], s32 offen sc1
    s_add_u32 s32, s24, 1179648
    buffer_load_dwordx4 v[200:203], v228, s[8:11], s32 offen sc1
    s_cmp_eq_u32 s28, 1
    s_cbranch_scc1 L_op0_g1
    ds_read_b128 v[28:31], v229 offset:45056
    ds_read_b128 v[32:35], v229 offset:45312
    ds_read_b128 v[36:39], v229 offset:45568
    ds_read_b128 v[40:43], v229 offset:45824
    ds_read_b128 v[44:47], v229 offset:46080
    ds_read_b128 v[48:51], v229 offset:50176
    s_waitcnt vmcnt(9)
    s_waitcnt lgkmcnt(5)
    v_mfma_f32_16x16x32_bf16 v[204:207], v[28:31], v[164:167], v[204:207]
    ds_read_b128 v[52:55], v229 offset:50432
    s_waitcnt lgkmcnt(5)
    v_mfma_f32_16x16x32_bf16 v[208:211], v[32:35], v[164:167], v[208:211]
    ds_read_b128 v[56:59], v229 offset:50688
    s_waitcnt lgkmcnt(5)
    v_mfma_f32_16x16x32_bf16 v[212:215], v[36:39], v[164:167], v[212:215]
    ds_read_b128 v[28:31], v229 offset:50944
    s_waitcnt lgkmcnt(5)
    v_mfma_f32_16x16x32_bf16 v[216:219], v[40:43], v[164:167], v[216:219]
    ds_read_b128 v[32:35], v229 offset:51200
    s_waitcnt lgkmcnt(5)
    v_mfma_f32_16x16x32_bf16 v[220:223], v[44:47], v[164:167], v[220:223]
    ds_read_b128 v[36:39], v229 offset:55296
    s_waitcnt vmcnt(8)
    s_waitcnt lgkmcnt(5)
    v_mfma_f32_16x16x32_bf16 v[204:207], v[48:51], v[168:171], v[204:207]
    ds_read_b128 v[40:43], v229 offset:55552
    s_waitcnt lgkmcnt(5)
    v_mfma_f32_16x16x32_bf16 v[208:211], v[52:55], v[168:171], v[208:211]
    ds_read_b128 v[44:47], v229 offset:55808
    s_waitcnt lgkmcnt(5)
    v_mfma_f32_16x16x32_bf16 v[212:215], v[56:59], v[168:171], v[212:215]
    ds_read_b128 v[48:51], v229 offset:56064
    s_waitcnt lgkmcnt(5)
    v_mfma_f32_16x16x32_bf16 v[216:219], v[28:31], v[168:171], v[216:219]
    ds_read_b128 v[52:55], v229 offset:56320
    s_waitcnt lgkmcnt(5)
    v_mfma_f32_16x16x32_bf16 v[220:223], v[32:35], v[168:171], v[220:223]
    ds_read_b128 v[56:59], v229 offset:60416
    s_waitcnt vmcnt(7)
    s_waitcnt lgkmcnt(5)
    v_mfma_f32_16x16x32_bf16 v[204:207], v[36:39], v[172:175], v[204:207]
    ds_read_b128 v[28:31], v229 offset:60672
    s_waitcnt lgkmcnt(5)
    v_mfma_f32_16x16x32_bf16 v[208:211], v[40:43], v[172:175], v[208:211]
    ds_read_b128 v[32:35], v229 offset:60928
    s_waitcnt lgkmcnt(5)
    v_mfma_f32_16x16x32_bf16 v[212:215], v[44:47], v[172:175], v[212:215]
    ds_read_b128 v[36:39], v229 offset:61184
    s_waitcnt lgkmcnt(5)
    v_mfma_f32_16x16x32_bf16 v[216:219], v[48:51], v[172:175], v[216:219]
    ds_read_b128 v[40:43], v229 offset:61440
    s_waitcnt lgkmcnt(5)
    v_mfma_f32_16x16x32_bf16 v[220:223], v[52:55], v[172:175], v[220:223]
    ds_read_b128 v[44:47], v25 offset:2048
    s_waitcnt vmcnt(6)
    s_waitcnt lgkmcnt(5)
    v_mfma_f32_16x16x32_bf16 v[204:207], v[56:59], v[176:179], v[204:207]
    ds_read_b128 v[48:51], v25 offset:2304
    s_waitcnt lgkmcnt(5)
    v_mfma_f32_16x16x32_bf16 v[208:211], v[28:31], v[176:179], v[208:211]
    ds_read_b128 v[52:55], v25 offset:2560
    s_waitcnt lgkmcnt(5)
    v_mfma_f32_16x16x32_bf16 v[212:215], v[32:35], v[176:179], v[212:215]
    ds_read_b128 v[56:59], v25 offset:2816
    s_waitcnt lgkmcnt(5)
    v_mfma_f32_16x16x32_bf16 v[216:219], v[36:39], v[176:179], v[216:219]
    ds_read_b128 v[28:31], v25 offset:3072
    s_waitcnt lgkmcnt(5)
    v_mfma_f32_16x16x32_bf16 v[220:223], v[40:43], v[176:179], v[220:223]
    ds_read_b128 v[32:35], v25 offset:7168
    s_waitcnt vmcnt(5)
    s_waitcnt lgkmcnt(5)
    v_mfma_f32_16x16x32_bf16 v[204:207], v[44:47], v[180:183], v[204:207]
    ds_read_b128 v[36:39], v25 offset:7424
    s_waitcnt lgkmcnt(5)
    v_mfma_f32_16x16x32_bf16 v[208:211], v[48:51], v[180:183], v[208:211]
    ds_read_b128 v[40:43], v25 offset:7680
    s_waitcnt lgkmcnt(5)
    v_mfma_f32_16x16x32_bf16 v[212:215], v[52:55], v[180:183], v[212:215]
    ds_read_b128 v[44:47], v25 offset:7936
    s_waitcnt lgkmcnt(5)
    v_mfma_f32_16x16x32_bf16 v[216:219], v[56:59], v[180:183], v[216:219]
    ds_read_b128 v[48:51], v25 offset:8192
    s_waitcnt lgkmcnt(5)
    v_mfma_f32_16x16x32_bf16 v[220:223], v[28:31], v[180:183], v[220:223]
    ds_read_b128 v[52:55], v25 offset:12288
    s_waitcnt vmcnt(4)
    s_waitcnt lgkmcnt(5)
    v_mfma_f32_16x16x32_bf16 v[204:207], v[32:35], v[184:187], v[204:207]
    ds_read_b128 v[56:59], v25 offset:12544
    s_waitcnt lgkmcnt(5)
    v_mfma_f32_16x16x32_bf16 v[208:211], v[36:39], v[184:187], v[208:211]
    ds_read_b128 v[28:31], v25 offset:12800
    s_waitcnt lgkmcnt(5)
    v_mfma_f32_16x16x32_bf16 v[212:215], v[40:43], v[184:187], v[212:215]
    ds_read_b128 v[32:35], v25 offset:13056
    s_waitcnt lgkmcnt(5)
    v_mfma_f32_16x16x32_bf16 v[216:219], v[44:47], v[184:187], v[216:219]
    ds_read_b128 v[36:39], v25 offset:13312
    s_waitcnt lgkmcnt(5)
    v_mfma_f32_16x16x32_bf16 v[220:223], v[48:51], v[184:187], v[220:223]
    ds_read_b128 v[40:43], v25 offset:17408
    s_waitcnt vmcnt(3)
    s_waitcnt lgkmcnt(5)
    v_mfma_f32_16x16x32_bf16 v[204:207], v[52:55], v[188:191], v[204:207]
    ds_read_b128 v[44:47], v25 offset:17664
    s_waitcnt lgkmcnt(5)
    v_mfma_f32_16x16x32_bf16 v[208:211], v[56:59], v[188:191], v[208:211]
    ds_read_b128 v[48:51], v25 offset:17920
    s_waitcnt lgkmcnt(5)
    v_mfma_f32_16x16x32_bf16 v[212:215], v[28:31], v[188:191], v[212:215]
    ds_read_b128 v[52:55], v25 offset:18176
    s_waitcnt lgkmcnt(5)
    v_mfma_f32_16x16x32_bf16 v[216:219], v[32:35], v[188:191], v[216:219]
    ds_read_b128 v[56:59], v25 offset:18432
    s_waitcnt lgkmcnt(5)
    v_mfma_f32_16x16x32_bf16 v[220:223], v[36:39], v[188:191], v[220:223]
    ds_read_b128 v[28:31], v25 offset:35328
    s_waitcnt vmcnt(2)
    s_waitcnt lgkmcnt(5)
    v_mfma_f32_16x16x32_bf16 v[204:207], v[40:43], v[192:195], v[204:207]
    ds_read_b128 v[32:35], v25 offset:35584
    s_waitcnt lgkmcnt(5)
    v_mfma_f32_16x16x32_bf16 v[208:211], v[44:47], v[192:195], v[208:211]
    ds_read_b128 v[36:39], v25 offset:35840
    s_waitcnt lgkmcnt(5)
    v_mfma_f32_16x16x32_bf16 v[212:215], v[48:51], v[192:195], v[212:215]
    ds_read_b128 v[40:43], v25 offset:36096
    s_waitcnt lgkmcnt(5)
    v_mfma_f32_16x16x32_bf16 v[216:219], v[52:55], v[192:195], v[216:219]
    ds_read_b128 v[44:47], v25 offset:36352
    s_waitcnt lgkmcnt(5)
    v_mfma_f32_16x16x32_bf16 v[220:223], v[56:59], v[192:195], v[220:223]
    ds_read_b128 v[48:51], v25 offset:40448
    s_waitcnt vmcnt(1)
    s_waitcnt lgkmcnt(5)
    v_mfma_f32_16x16x32_bf16 v[204:207], v[28:31], v[196:199], v[204:207]
    ds_read_b128 v[52:55], v25 offset:40704
    s_waitcnt lgkmcnt(5)
    v_mfma_f32_16x16x32_bf16 v[208:211], v[32:35], v[196:199], v[208:211]
    ds_read_b128 v[56:59], v25 offset:40960
    s_waitcnt lgkmcnt(5)
    v_mfma_f32_16x16x32_bf16 v[212:215], v[36:39], v[196:199], v[212:215]
    ds_read_b128 v[28:31], v25 offset:41216
    s_waitcnt lgkmcnt(5)
    v_mfma_f32_16x16x32_bf16 v[216:219], v[40:43], v[196:199], v[216:219]
    ds_read_b128 v[32:35], v25 offset:41472
    s_waitcnt lgkmcnt(5)
    v_mfma_f32_16x16x32_bf16 v[220:223], v[44:47], v[196:199], v[220:223]
    s_waitcnt vmcnt(0)
    s_waitcnt lgkmcnt(4)
    v_mfma_f32_16x16x32_bf16 v[204:207], v[48:51], v[200:203], v[204:207]
    s_waitcnt lgkmcnt(3)
    v_mfma_f32_16x16x32_bf16 v[208:211], v[52:55], v[200:203], v[208:211]
    s_waitcnt lgkmcnt(2)
    v_mfma_f32_16x16x32_bf16 v[212:215], v[56:59], v[200:203], v[212:215]
    s_waitcnt lgkmcnt(1)
    v_mfma_f32_16x16x32_bf16 v[216:219], v[28:31], v[200:203], v[216:219]
    s_waitcnt lgkmcnt(0)
    v_mfma_f32_16x16x32_bf16 v[220:223], v[32:35], v[200:203], v[220:223]
    s_branch L_op0_done
L_op0_g1:
    ds_read_b128 v[28:31], v25 offset:45568
    ds_read_b128 v[32:35], v25 offset:45824
    ds_read_b128 v[36:39], v25 offset:46080
    ds_read_b128 v[40:43], v25 offset:46336
    ds_read_b128 v[44:47], v25 offset:46592
    ds_read_b128 v[48:51], v25 offset:50688
    s_waitcnt vmcnt(9)
    s_waitcnt lgkmcnt(5)
    v_mfma_f32_16x16x32_bf16 v[204:207], v[28:31], v[164:167], v[204:207]
    ds_read_b128 v[52:55], v25 offset:50944
    s_waitcnt lgkmcnt(5)
    v_mfma_f32_16x16x32_bf16 v[208:211], v[32:35], v[164:167], v[208:211]
    ds_read_b128 v[56:59], v25 offset:51200
    s_waitcnt lgkmcnt(5)
    v_mfma_f32_16x16x32_bf16 v[212:215], v[36:39], v[164:167], v[212:215]
    ds_read_b128 v[28:31], v25 offset:51456
    s_waitcnt lgkmcnt(5)
    v_mfma_f32_16x16x32_bf16 v[216:219], v[40:43], v[164:167], v[216:219]
    ds_read_b128 v[32:35], v25 offset:51712
    s_waitcnt lgkmcnt(5)
    v_mfma_f32_16x16x32_bf16 v[220:223], v[44:47], v[164:167], v[220:223]
    ds_read_b128 v[36:39], v25 offset:55808
    s_waitcnt vmcnt(8)
    s_waitcnt lgkmcnt(5)
    v_mfma_f32_16x16x32_bf16 v[204:207], v[48:51], v[168:171], v[204:207]
    ds_read_b128 v[40:43], v25 offset:56064
    s_waitcnt lgkmcnt(5)
    v_mfma_f32_16x16x32_bf16 v[208:211], v[52:55], v[168:171], v[208:211]
    ds_read_b128 v[44:47], v25 offset:56320
    s_waitcnt lgkmcnt(5)
    v_mfma_f32_16x16x32_bf16 v[212:215], v[56:59], v[168:171], v[212:215]
    ds_read_b128 v[48:51], v25 offset:56576
    s_waitcnt lgkmcnt(5)
    v_mfma_f32_16x16x32_bf16 v[216:219], v[28:31], v[168:171], v[216:219]
    ds_read_b128 v[52:55], v25 offset:56832
    s_waitcnt lgkmcnt(5)
    v_mfma_f32_16x16x32_bf16 v[220:223], v[32:35], v[168:171], v[220:223]
    ds_read_b128 v[56:59], v25 offset:60928
    s_waitcnt vmcnt(7)
    s_waitcnt lgkmcnt(5)
    v_mfma_f32_16x16x32_bf16 v[204:207], v[36:39], v[172:175], v[204:207]
    ds_read_b128 v[28:31], v25 offset:61184
    s_waitcnt lgkmcnt(5)
    v_mfma_f32_16x16x32_bf16 v[208:211], v[40:43], v[172:175], v[208:211]
    ds_read_b128 v[32:35], v25 offset:61440
    s_waitcnt lgkmcnt(5)
    v_mfma_f32_16x16x32_bf16 v[212:215], v[44:47], v[172:175], v[212:215]
    ds_read_b128 v[36:39], v25 offset:61696
    s_waitcnt lgkmcnt(5)
    v_mfma_f32_16x16x32_bf16 v[216:219], v[48:51], v[172:175], v[216:219]
    ds_read_b128 v[40:43], v25 offset:61952
    s_waitcnt lgkmcnt(5)
    v_mfma_f32_16x16x32_bf16 v[220:223], v[52:55], v[172:175], v[220:223]
    ds_read_b128 v[44:47], v26 offset:512
    s_waitcnt vmcnt(6)
    s_waitcnt lgkmcnt(5)
    v_mfma_f32_16x16x32_bf16 v[204:207], v[56:59], v[176:179], v[204:207]
    ds_read_b128 v[48:51], v26 offset:768
    s_waitcnt lgkmcnt(5)
    v_mfma_f32_16x16x32_bf16 v[208:211], v[28:31], v[176:179], v[208:211]
    ds_read_b128 v[52:55], v26 offset:1024
    s_waitcnt lgkmcnt(5)
    v_mfma_f32_16x16x32_bf16 v[212:215], v[32:35], v[176:179], v[212:215]
    ds_read_b128 v[56:59], v26 offset:1280
    s_waitcnt lgkmcnt(5)
    v_mfma_f32_16x16x32_bf16 v[216:219], v[36:39], v[176:179], v[216:219]
    ds_read_b128 v[28:31], v26 offset:1536
    s_waitcnt lgkmcnt(5)
    v_mfma_f32_16x16x32_bf16 v[220:223], v[40:43], v[176:179], v[220:223]
    ds_read_b128 v[32:35], v26 offset:5632
    s_waitcnt vmcnt(5)
    s_waitcnt lgkmcnt(5)
    v_mfma_f32_16x16x32_bf16 v[204:207], v[44:47], v[180:183], v[204:207]
    ds_read_b128 v[36:39], v26 offset:5888
    s_waitcnt lgkmcnt(5)
    v_mfma_f32_16x16x32_bf16 v[208:211], v[48:51], v[180:183], v[208:211]
    ds_read_b128 v[40:43], v26 offset:6144
    s_waitcnt lgkmcnt(5)
    v_mfma_f32_16x16x32_bf16 v[212:215], v[52:55], v[180:183], v[212:215]
    ds_read_b128 v[44:47], v26 offset:6400
    s_waitcnt lgkmcnt(5)
    v_mfma_f32_16x16x32_bf16 v[216:219], v[56:59], v[180:183], v[216:219]
    ds_read_b128 v[48:51], v26 offset:6656
    s_waitcnt lgkmcnt(5)
    v_mfma_f32_16x16x32_bf16 v[220:223], v[28:31], v[180:183], v[220:223]
    ds_read_b128 v[52:55], v26 offset:10752
    s_waitcnt vmcnt(4)
    s_waitcnt lgkmcnt(5)
    v_mfma_f32_16x16x32_bf16 v[204:207], v[32:35], v[184:187], v[204:207]
    ds_read_b128 v[56:59], v26 offset:11008
    s_waitcnt lgkmcnt(5)
    v_mfma_f32_16x16x32_bf16 v[208:211], v[36:39], v[184:187], v[208:211]
    ds_read_b128 v[28:31], v26 offset:11264
    s_waitcnt lgkmcnt(5)
    v_mfma_f32_16x16x32_bf16 v[212:215], v[40:43], v[184:187], v[212:215]
    ds_read_b128 v[32:35], v26 offset:11520
    s_waitcnt lgkmcnt(5)
    v_mfma_f32_16x16x32_bf16 v[216:219], v[44:47], v[184:187], v[216:219]
    ds_read_b128 v[36:39], v26 offset:11776
    s_waitcnt lgkmcnt(5)
    v_mfma_f32_16x16x32_bf16 v[220:223], v[48:51], v[184:187], v[220:223]
    ds_read_b128 v[40:43], v26 offset:15872
    s_waitcnt vmcnt(3)
    s_waitcnt lgkmcnt(5)
    v_mfma_f32_16x16x32_bf16 v[204:207], v[52:55], v[188:191], v[204:207]
    ds_read_b128 v[44:47], v26 offset:16128
    s_waitcnt lgkmcnt(5)
    v_mfma_f32_16x16x32_bf16 v[208:211], v[56:59], v[188:191], v[208:211]
    ds_read_b128 v[48:51], v26 offset:16384
    s_waitcnt lgkmcnt(5)
    v_mfma_f32_16x16x32_bf16 v[212:215], v[28:31], v[188:191], v[212:215]
    ds_read_b128 v[52:55], v26 offset:16640
    s_waitcnt lgkmcnt(5)
    v_mfma_f32_16x16x32_bf16 v[216:219], v[32:35], v[188:191], v[216:219]
    ds_read_b128 v[56:59], v26 offset:16896
    s_waitcnt lgkmcnt(5)
    v_mfma_f32_16x16x32_bf16 v[220:223], v[36:39], v[188:191], v[220:223]
    ds_read_b128 v[28:31], v26 offset:20992
    s_waitcnt vmcnt(2)
    s_waitcnt lgkmcnt(5)
    v_mfma_f32_16x16x32_bf16 v[204:207], v[40:43], v[192:195], v[204:207]
    ds_read_b128 v[32:35], v26 offset:21248
    s_waitcnt lgkmcnt(5)
    v_mfma_f32_16x16x32_bf16 v[208:211], v[44:47], v[192:195], v[208:211]
    ds_read_b128 v[36:39], v26 offset:21504
    s_waitcnt lgkmcnt(5)
    v_mfma_f32_16x16x32_bf16 v[212:215], v[48:51], v[192:195], v[212:215]
    ds_read_b128 v[40:43], v26 offset:21760
    s_waitcnt lgkmcnt(5)
    v_mfma_f32_16x16x32_bf16 v[216:219], v[52:55], v[192:195], v[216:219]
    ds_read_b128 v[44:47], v26 offset:22016
    s_waitcnt lgkmcnt(5)
    v_mfma_f32_16x16x32_bf16 v[220:223], v[56:59], v[192:195], v[220:223]
    ds_read_b128 v[48:51], v26 offset:26112
    s_waitcnt vmcnt(1)
    s_waitcnt lgkmcnt(5)
    v_mfma_f32_16x16x32_bf16 v[204:207], v[28:31], v[196:199], v[204:207]
    ds_read_b128 v[52:55], v26 offset:26368
    s_waitcnt lgkmcnt(5)
    v_mfma_f32_16x16x32_bf16 v[208:211], v[32:35], v[196:199], v[208:211]
    ds_read_b128 v[56:59], v26 offset:26624
    s_waitcnt lgkmcnt(5)
    v_mfma_f32_16x16x32_bf16 v[212:215], v[36:39], v[196:199], v[212:215]
    ds_read_b128 v[28:31], v26 offset:26880
    s_waitcnt lgkmcnt(5)
    v_mfma_f32_16x16x32_bf16 v[216:219], v[40:43], v[196:199], v[216:219]
    ds_read_b128 v[32:35], v26 offset:27136
    s_waitcnt lgkmcnt(5)
    v_mfma_f32_16x16x32_bf16 v[220:223], v[44:47], v[196:199], v[220:223]
    s_waitcnt vmcnt(0)
    s_waitcnt lgkmcnt(4)
    v_mfma_f32_16x16x32_bf16 v[204:207], v[48:51], v[200:203], v[204:207]
    s_waitcnt lgkmcnt(3)
    v_mfma_f32_16x16x32_bf16 v[208:211], v[52:55], v[200:203], v[208:211]
    s_waitcnt lgkmcnt(2)
    v_mfma_f32_16x16x32_bf16 v[212:215], v[56:59], v[200:203], v[212:215]
    s_waitcnt lgkmcnt(1)
    v_mfma_f32_16x16x32_bf16 v[216:219], v[28:31], v[200:203], v[216:219]
    s_waitcnt lgkmcnt(0)
    v_mfma_f32_16x16x32_bf16 v[220:223], v[32:35], v[200:203], v[220:223]
L_op0_done:
    s_and_b32 s32, s16, 3
    s_mul_i32 s32, s32, 5120
    v_add_u32 v20, s32, v16
    s_cmp_eq_u32 s28, 0
    s_cbranch_scc1 L_red_a
    s_nop 5
    ds_write_b128 v20, v[204:207] offset:0
    ds_write_b128 v20, v[208:211] offset:1024
    ds_write_b128 v20, v[212:215] offset:2048
    s_waitcnt lgkmcnt(0)
    s_barrier
    ds_read_b128 v[40:43], v20 offset:3072
    ds_read_b128 v[44:47], v20 offset:4096
    s_waitcnt lgkmcnt(1)
    v_add_f32 v216, v216, v40
    v_add_f32 v217, v217, v41
    v_add_f32 v218, v218, v42
    v_add_f32 v219, v219, v43
    v_cvt_pk_bf16_f32 v216, v216, v217
    v_cvt_pk_bf16_f32 v217, v218, v219
    buffer_store_dwordx2 v[216:217], v230, s[12:15], s27 offen offset:96
    s_waitcnt lgkmcnt(0)
    v_add_f32 v220, v220, v44
    v_add_f32 v221, v221, v45
    v_add_f32 v222, v222, v46
    v_add_f32 v223, v223, v47
    v_cvt_pk_bf16_f32 v220, v220, v221
    v_cvt_pk_bf16_f32 v221, v222, v223
    buffer_store_dwordx2 v[220:221], v230, s[12:15], s27 offen offset:128
    s_endpgm
L_red_a:
    s_nop 5
    ds_write_b128 v20, v[216:219] offset:3072
    ds_write_b128 v20, v[220:223] offset:4096
    s_waitcnt lgkmcnt(0)
    s_barrier
    ds_read_b128 v[28:31], v20 offset:0
    ds_read_b128 v[32:35], v20 offset:1024
    ds_read_b128 v[36:39], v20 offset:2048
    s_waitcnt lgkmcnt(2)
    v_add_f32 v204, v204, v28
    v_add_f32 v205, v205, v29
    v_add_f32 v206, v206, v30
    v_add_f32 v207, v207, v31
    v_cvt_pk_bf16_f32 v204, v204, v205
    v_cvt_pk_bf16_f32 v205, v206, v207
    buffer_store_dwordx2 v[204:205], v230, s[12:15], s27 offen offset:0
    s_waitcnt lgkmcnt(1)
    v_add_f32 v208, v208, v32
    v_add_f32 v209, v209, v33
    v_add_f32 v210, v210, v34
    v_add_f32 v211, v211, v35
    v_cvt_pk_bf16_f32 v208, v208, v209
    v_cvt_pk_bf16_f32 v209, v210, v211
    buffer_store_dwordx2 v[208:209], v230, s[12:15], s27 offen offset:32
    s_waitcnt lgkmcnt(0)
    v_add_f32 v212, v212, v36
    v_add_f32 v213, v213, v37
    v_add_f32 v214, v214, v38
    v_add_f32 v215, v215, v39
    v_cvt_pk_bf16_f32 v212, v212, v213
    v_cvt_pk_bf16_f32 v213, v214, v215
    buffer_store_dwordx2 v[212:213], v230, s[12:15], s27 offen offset:64
    s_endpgm
L_fallback:
    s_waitcnt vmcnt(0) lgkmcnt(0)
    v_lshlrev_b32 v24, 15, v3
    v_lshl_add_u32 v24, v2, 4, v24
    v_lshlrev_b32 v25, 4, v2
    v_mul_u32_u24 v26, 320, v3
    v_lshl_add_u32 v26, v2, 4, v26
    v_mov_b32 v27, 0xff61b1e6
    s_mov_b32 s42, 0
L_fb1:
    s_lshl_b32 s32, s42, 9
    s_lshl_b32 s33, s20, 15
    s_add_u32 s33, s33, s32
    s_add_u32 s33, s33, 5242880
    s_lshl_b32 s34, s43, 15
    s_add_u32 s34, s34, s32
    s_and_b32 s35, s18, 1
    s_lshl_b32 s35, s35, 3
    s_add_u32 s34, s34, s35
    s_add_u32 s34, s34, 5242880
    s_mul_i32 s35, s42, 1280
    s_add_u32 s35, s35, s57
    s_add_u32 s35, s35, 10485760
    buffer_load_dwordx4 v[108:111], v24, s[8:11], s33 offen sc1
    buffer_load_dwordx2 v[112:113], v25, s[8:11], s34 offen sc1
    s_waitcnt vmcnt(0)
    v_mfma_f32_32x32x16_bf16 v[28:43], v[108:111], v[100:103], 0
    v_mfma_f32_32x32x8_bf16 v[28:43], v[112:113], v[104:105], v[28:43]
    s_nop 7
    s_nop 7
    v_max3_f32 v27, v27, v28, v29
    v_max3_f32 v27, v27, v30, v31
    v_max3_f32 v27, v27, v32, v33
    v_max3_f32 v27, v27, v34, v35
    v_max3_f32 v27, v27, v36, v37
    v_max3_f32 v27, v27, v38, v39
    v_max3_f32 v27, v27, v40, v41
    v_max3_f32 v27, v27, v42, v43
    s_add_u32 s42, s42, 1
    s_cmp_lt_u32 s42, 64
    s_cbranch_scc1 L_fb1
    v_mov_b32 v20, v27
    s_nop 1
    v_permlane32_swap_b32 v27, v20
    s_nop 1
    v_max_f32 v27, v27, v20
    v_sub_f32 v60, 0, v27
    v_mov_b32 v76, 0
    v_sub_f32 v61, 0, v27
    v_mov_b32 v77, 0
    v_sub_f32 v62, 0, v27
    v_mov_b32 v78, 0
    v_sub_f32 v63, 0, v27
    v_mov_b32 v79, 0
    v_sub_f32 v64, 0, v27
    v_mov_b32 v80, 0
    v_sub_f32 v65, 0, v27
    v_mov_b32 v81, 0
    v_sub_f32 v66, 0, v27
    v_mov_b32 v82, 0
    v_sub_f32 v67, 0, v27
    v_mov_b32 v83, 0
    v_sub_f32 v68, 0, v27
    v_mov_b32 v84, 0
    v_sub_f32 v69, 0, v27
    v_mov_b32 v85, 0
    v_sub_f32 v70, 0, v27
    v_mov_b32 v86, 0
    v_sub_f32 v71, 0, v27
    v_mov_b32 v87, 0
    v_sub_f32 v72, 0, v27
    v_mov_b32 v88, 0
    v_sub_f32 v73, 0, v27
    v_mov_b32 v89, 0
    v_sub_f32 v74, 0, v27
    v_mov_b32 v90, 0
    v_sub_f32 v75, 0, v27
    v_mov_b32 v91, 0
    v_cmp_eq_u32 vcc, 20, v2
    v_mov_b32 v20, 0
    v_mov_b32 v21, 0x3f803f80
    v_cndmask_b32 v20, v20, v21, vcc
    v_mov_b32 v116, v20
    v_mov_b32 v120, v20
    v_mov_b32 v117, v20
    v_mov_b32 v121, v20
    v_mov_b32 v118, v20
    v_mov_b32 v122, v20
    v_mov_b32 v119, v20
    v_mov_b32 v123, v20
    s_mov_b32 s42, 0
L_fb2:
    s_lshl_b32 s32, s42, 9
    s_lshl_b32 s33, s20, 15
    s_add_u32 s33, s33, s32
    s_add_u32 s33, s33, 5242880
    s_lshl_b32 s34, s43, 15
    s_add_u32 s34, s34, s32
    s_and_b32 s35, s18, 1
    s_lshl_b32 s35, s35, 3
    s_add_u32 s34, s34, s35
    s_add_u32 s34, s34, 5242880
    s_mul_i32 s35, s42, 1280
    s_add_u32 s35, s35, s57
    s_add_u32 s35, s35, 10485760
    buffer_load_dwordx4 v[108:111], v24, s[8:11], s33 offen sc1
    buffer_load_dwordx2 v[112:113], v25, s[8:11], s34 offen sc1
    s_mov_b64 exec, s[40:41]
    buffer_load_dwordx4 v[116:119], v26, s[8:11], s35 offen sc1
    buffer_load_dwordx4 v[120:123], v26, s[8:11], s35 offen offset:640 sc1
    s_mov_b64 exec, -1
    s_waitcnt vmcnt(0)
    v_mfma_f32_32x32x16_bf16 v[28:43], v[108:111], v[100:103], v[60:75]
    v_mfma_f32_32x32x8_bf16 v[28:43], v[112:113], v[104:105], v[28:43]
    s_nop 7
    s_nop 7
    v_exp_f32 v28, v28
    v_exp_f32 v29, v29
    v_exp_f32 v30, v30
    v_exp_f32 v31, v31
    v_cvt_pk_bf16_f32 v92, v28, v29
    v_cvt_pk_bf16_f32 v93, v30, v31
    v_exp_f32 v32, v32
    v_exp_f32 v33, v33
    v_exp_f32 v34, v34
    v_exp_f32 v35, v35
    v_cvt_pk_bf16_f32 v94, v32, v33
    v_cvt_pk_bf16_f32 v95, v34, v35
    v_exp_f32 v36, v36
    v_exp_f32 v37, v37
    v_exp_f32 v38, v38
    v_exp_f32 v39, v39
    v_cvt_pk_bf16_f32 v96, v36, v37
    v_cvt_pk_bf16_f32 v97, v38, v39
    v_exp_f32 v40, v40
    v_exp_f32 v41, v41
    v_exp_f32 v42, v42
    v_exp_f32 v43, v43
    v_cvt_pk_bf16_f32 v98, v40, v41
    v_cvt_pk_bf16_f32 v99, v42, v43
    s_nop 1
    v_mfma_f32_32x32x16_bf16 v[76:91], v[116:119], v[92:95], v[76:91]
    v_mfma_f32_32x32x16_bf16 v[76:91], v[120:123], v[96:99], v[76:91]
    s_add_u32 s42, s42, 1
    s_cmp_lt_u32 s42, 64
    s_cbranch_scc1 L_fb2
    s_nop 7
    s_nop 7
    v_mov_b32 v20, v84
    v_mov_b32 v21, v84
    s_nop 1
    v_permlane32_swap_b32 v20, v21
    s_nop 1
    s_branch L_finish
L_spare:
    s_load_dwordx2 s[4:5], s[0:1], 16
    s_load_dwordx2 s[6:7], s[0:1], 40
    s_load_dwordx2 s[92:93], s[0:1], 48
    s_waitcnt lgkmcnt(0)
    s_cmp_lt_u32 s72, 8
    s_cbranch_scc1 L_sp_a
    s_mov_b32 s4, s6
    s_mov_b32 s5, s7
L_sp_a:
    s_mov_b32 s64, s4
    s_and_b32 s65, s5, 0xffff
    s_mov_b32 s66, 819200
    s_mov_b32 s67, 0x20000
    s_mov_b32 s68, s92
    s_and_b32 s69, s93, 0xffff
    s_mov_b32 s70, 1280
    s_mov_b32 s71, 0x20000
    s_and_b32 s33, s72, 7
    s_mul_i32 s33, s33, 102400
    s_lshl_b32 s78, s16, 10
    s_add_u32 s33, s33, s78
    s_add_u32 m0, s78, 0
    s_add_u32 s32, s33, 0
    buffer_load_dwordx4 v16, s[64:67], s32 offen lds
    s_add_u32 m0, s78, 8192
    s_add_u32 s32, s33, 8192
    buffer_load_dwordx4 v16, s[64:67], s32 offen lds
    s_add_u32 m0, s78, 16384
    s_add_u32 s32, s33, 16384
    buffer_load_dwordx4 v16, s[64:67], s32 offen lds
    s_add_u32 m0, s78, 24576
    s_add_u32 s32, s33, 24576
    buffer_load_dwordx4 v16, s[64:67], s32 offen lds
    s_add_u32 m0, s78, 32768
    s_add_u32 s32, s33, 32768
    buffer_load_dwordx4 v16, s[64:67], s32 offen lds
    s_add_u32 m0, s78, 40960
    s_add_u32 s32, s33, 40960
    buffer_load_dwordx4 v16, s[64:67], s32 offen lds
    s_add_u32 m0, s78, 49152
    s_add_u32 s32, s33, 49152
    buffer_load_dwordx4 v16, s[64:67], s32 offen lds
    s_add_u32 m0, s78, 57344
    s_add_u32 s32, s33, 57344
    buffer_load_dwordx4 v16, s[64:67], s32 offen lds
    s_add_u32 m0, s78, 65536
    s_add_u32 s32, s33, 65536
    buffer_load_dwordx4 v16, s[64:67], s32 offen lds
    s_add_u32 m0, s78, 73728
    s_add_u32 s32, s33, 73728
    buffer_load_dwordx4 v16, s[64:67], s32 offen lds
    s_add_u32 m0, s78, 81920
    s_add_u32 s32, s33, 81920
    buffer_load_dwordx4 v16, s[64:67], s32 offen lds
    s_add_u32 m0, s78, 90112
    s_add_u32 s32, s33, 90112
    buffer_load_dwordx4 v16, s[64:67], s32 offen lds
    s_cmp_ge_u32 s16, 4
    s_cbranch_scc1 L_sp_dma_done
    s_add_u32 m0, s78, 98304
    s_add_u32 s32, s33, 98304
    buffer_load_dwordx4 v16, s[64:67], s32 offen lds
L_sp_dma_done:
    s_cmp_ge_u32 s16, 2
    s_cbranch_scc1 L_sp_gw_done
    s_add_u32 m0, s78, 102400
    s_nop 0
    buffer_load_dwordx4 v16, s[68:71], s78 offen lds
L_sp_gw_done:
    v_lshrrev_b32 v21, 2, v1
    s_lshl_b32 s32, s16, 4
    v_add_u32 v21, s32, v21
    v_and_b32 v22, 3, v1
    v_lshlrev_b32 v22, 4, v22
    v_mul_u32_u24 v23, 1280, v21
    v_add_u32 v23, v23, v22
    v_mov_b32 v24, 0
    buffer_load_dwordx4 v[28:31], v23, s[60:63], s76 offen offset:0
    buffer_load_dwordx4 v[32:35], v23, s[60:63], s76 offen offset:64
    buffer_load_dwordx4 v[36:39], v23, s[60:63], s76 offen offset:128
    buffer_load_dwordx4 v[40:43], v23, s[60:63], s76 offen offset:192
    buffer_load_dwordx4 v[44:47], v23, s[60:63], s76 offen offset:256
    buffer_load_dwordx4 v[48:51], v23, s[60:63], s76 offen offset:320
    buffer_load_dwordx4 v[52:55], v23, s[60:63], s76 offen offset:384
    buffer_load_dwordx4 v[56:59], v23, s[60:63], s76 offen offset:448
    buffer_load_dwordx4 v[60:63], v23, s[60:63], s76 offen offset:512
    buffer_load_dwordx4 v[64:67], v23, s[60:63], s76 offen offset:576
    buffer_load_dwordx4 v[68:71], v23, s[60:63], s76 offen offset:640
    buffer_load_dwordx4 v[72:75], v23, s[60:63], s76 offen offset:704
    buffer_load_dwordx4 v[76:79], v23, s[60:63], s76 offen offset:768
    buffer_load_dwordx4 v[80:83], v23, s[60:63], s76 offen offset:832
    buffer_load_dwordx4 v[84:87], v23, s[60:63], s76 offen offset:896
    buffer_load_dwordx4 v[88:91], v23, s[60:63], s76 offen offset:960
    buffer_load_dwordx4 v[92:95], v23, s[60:63], s76 offen offset:1024
    buffer_load_dwordx4 v[96:99], v23, s[60:63], s76 offen offset:1088
    buffer_load_dwordx4 v[100:103], v23, s[60:63], s76 offen offset:1152
    buffer_load_dwordx4 v[104:107], v23, s[60:63], s76 offen offset:1216
    v_add_u32 v22, 102400, v22
    s_waitcnt vmcnt(0)
    s_barrier
    ds_read_b128 v[108:111], v22 offset:0
    ds_read_b128 v[112:115], v22 offset:64
    ds_read_b128 v[116:119], v22 offset:128
    ds_read_b128 v[120:123], v22 offset:192
    s_waitcnt lgkmcnt(3)
    v_dot2_f32_bf16 v24, v28, v108, v24
    v_dot2_f32_bf16 v24, v29, v109, v24
    v_dot2_f32_bf16 v24, v30, v110, v24
    v_dot2_f32_bf16 v24, v31, v111, v24
    ds_read_b128 v[108:111], v22 offset:256
    s_waitcnt lgkmcnt(3)
    v_dot2_f32_bf16 v24, v32, v112, v24
    v_dot2_f32_bf16 v24, v33, v113, v24
    v_dot2_f32_bf16 v24, v34, v114, v24
    v_dot2_f32_bf16 v24, v35, v115, v24
    ds_read_b128 v[112:115], v22 offset:320
    s_waitcnt lgkmcnt(3)
    v_dot2_f32_bf16 v24, v36, v116, v24
    v_dot2_f32_bf16 v24, v37, v117, v24
    v_dot2_f32_bf16 v24, v38, v118, v24
    v_dot2_f32_bf16 v24, v39, v119, v24
    ds_read_b128 v[116:119], v22 offset:384
    s_waitcnt lgkmcnt(3)
    v_dot2_f32_bf16 v24, v40, v120, v24
    v_dot2_f32_bf16 v24, v41, v121, v24
    v_dot2_f32_bf16 v24, v42, v122, v24
    v_dot2_f32_bf16 v24, v43, v123, v24
    ds_read_b128 v[120:123], v22 offset:448
    s_waitcnt lgkmcnt(3)
    v_dot2_f32_bf16 v24, v44, v108, v24
    v_dot2_f32_bf16 v24, v45, v109, v24
    v_dot2_f32_bf16 v24, v46, v110, v24
    v_dot2_f32_bf16 v24, v47, v111, v24
    ds_read_b128 v[108:111], v22 offset:512
    s_waitcnt lgkmcnt(3)
    v_dot2_f32_bf16 v24, v48, v112, v24
    v_dot2_f32_bf16 v24, v49, v113, v24
    v_dot2_f32_bf16 v24, v50, v114, v24
    v_dot2_f32_bf16 v24, v51, v115, v24
    ds_read_b128 v[112:115], v22 offset:576
    s_waitcnt lgkmcnt(3)
    v_dot2_f32_bf16 v24, v52, v116, v24
    v_dot2_f32_bf16 v24, v53, v117, v24
    v_dot2_f32_bf16 v24, v54, v118, v24
    v_dot2_f32_bf16 v24, v55, v119, v24
    ds_read_b128 v[116:119], v22 offset:640
    s_waitcnt lgkmcnt(3)
    v_dot2_f32_bf16 v24, v56, v120, v24
    v_dot2_f32_bf16 v24, v57, v121, v24
    v_dot2_f32_bf16 v24, v58, v122, v24
    v_dot2_f32_bf16 v24, v59, v123, v24
    ds_read_b128 v[120:123], v22 offset:704
    s_waitcnt lgkmcnt(3)
    v_dot2_f32_bf16 v24, v60, v108, v24
    v_dot2_f32_bf16 v24, v61, v109, v24
    v_dot2_f32_bf16 v24, v62, v110, v24
    v_dot2_f32_bf16 v24, v63, v111, v24
    ds_read_b128 v[108:111], v22 offset:768
    s_waitcnt lgkmcnt(3)
    v_dot2_f32_bf16 v24, v64, v112, v24
    v_dot2_f32_bf16 v24, v65, v113, v24
    v_dot2_f32_bf16 v24, v66, v114, v24
    v_dot2_f32_bf16 v24, v67, v115, v24
    ds_read_b128 v[112:115], v22 offset:832
    s_waitcnt lgkmcnt(3)
    v_dot2_f32_bf16 v24, v68, v116, v24
    v_dot2_f32_bf16 v24, v69, v117, v24
    v_dot2_f32_bf16 v24, v70, v118, v24
    v_dot2_f32_bf16 v24, v71, v119, v24
    ds_read_b128 v[116:119], v22 offset:896
    s_waitcnt lgkmcnt(3)
    v_dot2_f32_bf16 v24, v72, v120, v24
    v_dot2_f32_bf16 v24, v73, v121, v24
    v_dot2_f32_bf16 v24, v74, v122, v24
    v_dot2_f32_bf16 v24, v75, v123, v24
    ds_read_b128 v[120:123], v22 offset:960
    s_waitcnt lgkmcnt(3)
    v_dot2_f32_bf16 v24, v76, v108, v24
    v_dot2_f32_bf16 v24, v77, v109, v24
    v_dot2_f32_bf16 v24, v78, v110, v24
    v_dot2_f32_bf16 v24, v79, v111, v24
    ds_read_b128 v[108:111], v22 offset:1024
    s_waitcnt lgkmcnt(3)
    v_dot2_f32_bf16 v24, v80, v112, v24
    v_dot2_f32_bf16 v24, v81, v113, v24
    v_dot2_f32_bf16 v24, v82, v114, v24
    v_dot2_f32_bf16 v24, v83, v115, v24
    ds_read_b128 v[112:115], v22 offset:1088
    s_waitcnt lgkmcnt(3)
    v_dot2_f32_bf16 v24, v84, v116, v24
    v_dot2_f32_bf16 v24, v85, v117, v24
    v_dot2_f32_bf16 v24, v86, v118, v24
    v_dot2_f32_bf16 v24, v87, v119, v24
    ds_read_b128 v[116:119], v22 offset:1152
    s_waitcnt lgkmcnt(3)
    v_dot2_f32_bf16 v24, v88, v120, v24
    v_dot2_f32_bf16 v24, v89, v121, v24
    v_dot2_f32_bf16 v24, v90, v122, v24
    v_dot2_f32_bf16 v24, v91, v123, v24
    ds_read_b128 v[120:123], v22 offset:1216
    s_waitcnt lgkmcnt(3)
    v_dot2_f32_bf16 v24, v92, v108, v24
    v_dot2_f32_bf16 v24, v93, v109, v24
    v_dot2_f32_bf16 v24, v94, v110, v24
    v_dot2_f32_bf16 v24, v95, v111, v24
    s_waitcnt lgkmcnt(2)
    v_dot2_f32_bf16 v24, v96, v112, v24
    v_dot2_f32_bf16 v24, v97, v113, v24
    v_dot2_f32_bf16 v24, v98, v114, v24
    v_dot2_f32_bf16 v24, v99, v115, v24
    s_waitcnt lgkmcnt(1)
    v_dot2_f32_bf16 v24, v100, v116, v24
    v_dot2_f32_bf16 v24, v101, v117, v24
    v_dot2_f32_bf16 v24, v102, v118, v24
    v_dot2_f32_bf16 v24, v103, v119, v24
    s_waitcnt lgkmcnt(0)
    v_dot2_f32_bf16 v24, v104, v120, v24
    v_dot2_f32_bf16 v24, v105, v121, v24
    v_dot2_f32_bf16 v24, v106, v122, v24
    v_dot2_f32_bf16 v24, v107, v123, v24
    s_nop 2
    v_add_f32_dpp v24, v24, v24 quad_perm:[1,0,3,2] row_mask:0xf bank_mask:0xf
    s_nop 1
    v_add_f32_dpp v24, v24, v24 quad_perm:[2,3,0,1] row_mask:0xf bank_mask:0xf
    v_mul_f32 v24, 0xbfb8aa3b, v24
    v_exp_f32 v24, v24
    s_nop 0
    v_add_f32 v24, 1.0, v24
    v_rcp_f32 v24, v24
    s_lshl_b32 s32, s72, 9
    s_add_u32 s32, s32, 22609920
    v_lshlrev_b32 v21, 2, v21
    s_mov_b32 exec_lo, 0x11111111
    s_mov_b32 exec_hi, 0x11111111
    buffer_store_dword v24, v21, s[8:11], s32 offen sc1
    s_mov_b64 exec, -1
    v_bfe_u32 v21, v1, 2, 2
    v_mul_u32_u24 v21, 1280, v21
    v_lshrrev_b32 v22, 4, v1
    v_lshl_add_u32 v21, v22, 5, v21
    v_and_b32 v22, 3, v1
    v_lshl_add_u32 v21, v22, 3, v21
    s_mul_i32 s35, s72, 102400
    s_add_u32 s35, s35, 20971520
    s_mov_b32 s33, s16
L_sp_loop:
    s_mul_hi_u32 s34, s33, 0x1999999a
    s_mul_i32 s32, s34, 10
    s_sub_u32 s32, s33, s32
    s_mul_hi_u32 s42, s34, 0x33333334
    s_mul_i32 s36, s42, 5
    s_sub_u32 s36, s34, s36
    s_mul_i32 s42, s42, 40
    s_lshl_b32 s37, s36, 3
    s_cmp_ge_u32 s36, 2
    s_cselect_b32 s38, 4, 0
    s_add_u32 s37, s37, s38
    s_cmp_eq_u32 s36, 4
    s_cselect_b32 s37, 16, s37
    s_cselect_b32 s38, 20, 4
    s_add_u32 s37, s37, s42
    s_mul_i32 s36, s37, 1280
    s_mul_i32 s38, s38, 1280
    s_lshl_b32 s37, s32, 7
    s_add_u32 s36, s36, s37
    v_add_u32 v23, s36, v21
    v_add_u32 v24, s38, v23
    ds_read_b64_tr_b16 v[28:29], v23
    ds_read_b64_tr_b16 v[30:31], v24
    s_mul_i32 s36, s34, 10240
    s_lshl_b32 s37, s32, 10
    s_add_u32 s36, s36, s37
    s_add_u32 s36, s36, s35
    s_waitcnt lgkmcnt(0)
    buffer_store_dwordx4 v[28:31], v16, s[8:11], s36 offen sc1
    s_add_u32 s33, s33, 8
    s_cmp_lt_u32 s33, 100
    s_nop 1
    s_cbranch_scc1 L_sp_loop
    v_mov_b32 v20, 0
    buffer_load_dword v19, v20, s[44:47], 0 offen sc1
    s_waitcnt vmcnt(0)
    s_nop 0
    v_readfirstlane_b32 s17, v19
    s_nop 3
    s_cmp_lg_u32 s17, 0
    s_cbranch_scc1 L_noncesp_ok
    s_mov_b32 s42, 0
L_noncesp_spin:
    s_sleep 1
    v_mov_b32 v20, 0
    buffer_load_dword v19, v20, s[44:47], 0 offen sc1
    s_add_u32 s42, s42, 1
    s_cmp_ge_u32 s42, 1048576
    s_cbranch_scc1 L_noncesp_ok
    s_waitcnt vmcnt(0)
    v_readfirstlane_b32 s17, v19
    s_nop 3
    s_cmp_eq_u32 s17, 0
    s_cbranch_scc1 L_noncesp_spin
L_noncesp_ok:
    s_waitcnt vmcnt(0)
    s_barrier
    s_cmp_lg_u32 s16, 0
    s_cbranch_scc1 L_w0_pubsp
    v_mov_b32 v20, s17
    v_mov_b32 v21, 0
    s_add_u32 s32, s91, 22634496
    s_mov_b64 exec, 1
    buffer_store_dword v20, v21, s[8:11], s32 offen sc1
    s_mov_b64 exec, -1
L_w0_pubsp:
    s_cmp_lg_u32 s16, 0
    s_cbranch_scc1 L_w0_f1sp_i
    s_mov_b32 s32, 22634496
    buffer_load_dword v19, v232, s[8:11], s32 offen sc1
    s_mov_b32 s32, 22634496
    buffer_load_dword v235, v233, s[8:11], s32 offen sc1
L_w0_f1sp_i:
    s_cmp_lg_u32 s16, 0
    s_cbranch_scc1 L_w0_f1sp_c
    s_waitcnt vmcnt(0)
    v_cmp_eq_u32 vcc, s17, v19
    v_cmp_eq_u32 s[36:37], s17, v235
    s_nop 3
    s_and_b64 vcc, vcc, s[36:37]
    s_nop 3
    s_cmp_eq_u64 vcc, exec
    s_cbranch_scc1 L_f1sp_ok
    s_mov_b32 s42, 0
L_f1sp_spin:
    s_sleep 2
    s_mov_b32 s32, 22634496
    buffer_load_dword v19, v232, s[8:11], s32 offen sc1
    s_mov_b32 s32, 22634496
    buffer_load_dword v235, v233, s[8:11], s32 offen sc1
    s_add_u32 s42, s42, 1
    s_cmp_ge_u32 s42, 1048576
    s_cbranch_scc1 L_f1sp_ok
    s_waitcnt vmcnt(0)
    v_cmp_eq_u32 vcc, s17, v19
    v_cmp_eq_u32 s[36:37], s17, v235
    s_nop 3
    s_and_b64 vcc, vcc, s[36:37]
    s_nop 3
    s_cmp_eq_u64 vcc, exec
    s_cbranch_scc0 L_f1sp_spin
L_f1sp_ok:
L_w0_f1sp_c:
    s_barrier
    s_add_u32 m0, s21, 0
    v_mad_u32_u24 v250, v247, 0, v244
    buffer_load_dwordx4 v250, s[8:11], 0 offen sc1 lds
    s_add_u32 m0, s21, 1024
    v_mad_u32_u24 v250, v248, 0, v245
    buffer_load_dwordx4 v250, s[8:11], 0 offen sc1 lds
    s_add_u32 m0, s21, 2048
    v_mad_u32_u24 v250, v249, 0, v246
    s_mov_b32 exec_hi, 0xffff
    buffer_load_dwordx4 v250, s[8:11], 0 offen sc1 lds
    s_mov_b32 exec_hi, -1
    buffer_load_dwordx4 v[100:103], v236, s[8:11], s88 offen sc1
    v_mov_b32 v104, 0
    v_mov_b32 v105, 0
    s_mov_b32 exec_hi, 0
    buffer_load_dwordx2 v[104:105], v237, s[8:11], s89 offen sc1
    s_mov_b32 exec_hi, -1
    s_add_u32 m0, s21, 22528
    v_mad_u32_u24 v250, v247, 1, v244
    buffer_load_dwordx4 v250, s[8:11], 0 offen sc1 lds
    s_add_u32 m0, s21, 23552
    v_mad_u32_u24 v250, v248, 1, v245
    buffer_load_dwordx4 v250, s[8:11], 0 offen sc1 lds
    s_add_u32 m0, s21, 24576
    v_mad_u32_u24 v250, v249, 1, v246
    s_mov_b32 exec_hi, 0xffff
    buffer_load_dwordx4 v250, s[8:11], 0 offen sc1 lds
    s_mov_b32 exec_hi, -1
    s_add_u32 m0, s21, 45056
    v_mad_u32_u24 v250, v247, 2, v244
    buffer_load_dwordx4 v250, s[8:11], 0 offen sc1 lds
    s_add_u32 m0, s21, 46080
    v_mad_u32_u24 v250, v248, 2, v245
    buffer_load_dwordx4 v250, s[8:11], 0 offen sc1 lds
    s_add_u32 m0, s21, 47104
    v_mad_u32_u24 v250, v249, 2, v246
    s_mov_b32 exec_hi, 0xffff
    buffer_load_dwordx4 v250, s[8:11], 0 offen sc1 lds
    s_mov_b32 exec_hi, -1
    s_cmp_ge_u32 s16, 4
    s_cbranch_scc1 L_sp_nopat
    v_and_b32 v20, 255, v0
    v_mul_u32_u24 v21, 3277, v20
    v_lshrrev_b32 v21, 16, v21
    v_mul_u32_u24 v21, 20, v21
    v_cmp_eq_u32 vcc, v21, v20
    v_mov_b32 v24, 0
    v_mov_b32 v25, 0x3f803f80
    v_cndmask_b32 v24, v24, v25, vcc
    v_mov_b32 v25, v24
    v_mov_b32 v26, v24
    v_mov_b32 v27, v24
    v_lshlrev_b32 v20, 4, v20
    v_add_u32 v20, 90112, v20
    ds_write_b128 v20, v[24:27]
    v_and_b32 v20, 255, v0
    v_add_u32 v20, 256, v20
    v_mul_u32_u24 v21, 3277, v20
    v_lshrrev_b32 v21, 16, v21
    v_mul_u32_u24 v21, 20, v21
    v_cmp_eq_u32 vcc, v21, v20
    v_mov_b32 v24, 0
    v_mov_b32 v25, 0x3f803f80
    v_cndmask_b32 v24, v24, v25, vcc
    v_mov_b32 v25, v24
    v_mov_b32 v26, v24
    v_mov_b32 v27, v24
    v_cmp_gt_u32 vcc, 336, v20
    v_lshlrev_b32 v20, 4, v20
    v_add_u32 v20, 90112, v20
    s_and_saveexec_b64 s[36:37], vcc
    s_cbranch_execz L_pat_donesp
    ds_write_b128 v20, v[24:27]
L_pat_donesp:
    s_mov_b64 exec, -1
    s_waitcnt lgkmcnt(0)
L_sp_nopat:
    s_waitcnt vmcnt(0)
    s_barrier
    s_branch L_attn
L_end:
    s_endpgm
.section .rodata,"a"
.p2align 6
.amdhsa_kernel gated_mix__softmax_full_mha__sliding_local_dilated__prompt_kernel
  .amdhsa_next_free_vgpr 256
  .amdhsa_next_free_sgpr 96
  .amdhsa_accum_offset 256
  .amdhsa_group_segment_fixed_size 0
  .amdhsa_kernarg_size 80
  .amdhsa_user_sgpr_count 2
  .amdhsa_user_sgpr_kernarg_segment_ptr 1
  .amdhsa_system_sgpr_workgroup_id_x 1
  .amdhsa_float_denorm_mode_32 3
.end_amdhsa_kernel
```
